```python
import torch

def _softmax(x, axis=-1):
    return torch.softmax(x, dim=axis)

def _gelu(x):
    return torch.nn.functional.gelu(x, approximate='tanh')

def _silu(x):
    return torch.nn.functional.silu(x)

def _sigmoid(x):
    return torch.sigmoid(x)

def _layernorm(x, axis=-1, eps=1e-05):
    m = x.mean(dim=axis, keepdim=True)
    v = x.var(dim=axis, keepdim=True, unbiased=False)
    return (x - m) / torch.sqrt(v + eps)

def _scatter_add(tgt, idx, src, axis=0):
    return tgt.clone().index_add_(axis, idx, src)

def _segment_sum(src, seg, n):
    out = torch.zeros((n,) + src.shape[1:], dtype=src.dtype)
    return out.index_add_(0, seg, src)

def _pad(x, pw):
    flat = tuple((v for pair in reversed(pw) for v in pair))
    return torch.nn.functional.pad(x, flat)
kernel_name = 'recurrent_scan__ssm_conv_s4d__mixer_gmlp__prompt'

def setup_inputs():

    _w = lambda a: (lambda t: t.to(torch.bfloat16) if t.is_floating_point() else t)(torch.as_tensor(a))

    def _A_setup():
        Bsz, L, D, N = (1, 2048, 576, 128)
        return {'u': _w((lambda *s: torch.randn(*s, dtype=torch.bfloat16) * 0.05)(Bsz, L, D)), 'log_A_real': _w((lambda *s: torch.randn(*s, dtype=torch.bfloat16) * 6.4)(D, N) * 0.5), 'A_imag': _w((lambda *s: torch.randn(*s, dtype=torch.bfloat16) * 0.05)(D, N) * 3.14), 'C_real': _w((lambda *s: torch.randn(*s, dtype=torch.bfloat16) * 0.05)(D, N) / N ** 0.5), 'C_imag': _w((lambda *s: torch.randn(*s, dtype=torch.bfloat16) * 0.05)(D, N) / N ** 0.5), 'log_dt': _w((lambda *s: torch.randn(*s, dtype=torch.bfloat16) * 0.05)(D) * 0.5 - 4.0), 'D_skip': _w((lambda *s: torch.randn(*s, dtype=torch.bfloat16) * 0.05)(D))}
    _A_in = _A_setup()

    def _B_setup():
        B, S, D, F = (1, 2048, 576, 4608)
        Fh = F // 2
        return {'x': _w((lambda *s: torch.randn(*s, dtype=torch.bfloat16) * 0.05)(B, S, D)), 'w_in': _w((lambda *s: torch.randn(*s, dtype=torch.bfloat16) * 0.4)(D, 2 * Fh)), 'w_sp': _w(0.01 * (lambda *s: torch.randn(*s, dtype=torch.bfloat16) * 0.4)(S, S)), 'b_sp': _w(1.0 + 0.01 * (lambda *s: torch.randn(*s, dtype=torch.bfloat16) * 0.05)(S)), 'w_out': _w((lambda *s: torch.randn(*s, dtype=torch.bfloat16) * 0.05)(Fh, D))}
    _B_in = _B_setup()
    return {'A_u': _A_in['u'], 'A_log_A_real': _A_in['log_A_real'], 'A_A_imag': _A_in['A_imag'], 'A_C_real': _A_in['C_real'], 'A_C_imag': _A_in['C_imag'], 'A_log_dt': _A_in['log_dt'], 'A_D_skip': _A_in['D_skip'], 'B_x': _B_in['x'], 'B_w_in': _B_in['w_in'], 'B_w_sp': _B_in['w_sp'], 'B_b_sp': _B_in['b_sp'], 'B_w_out': _B_in['w_out']}

def reference(A_u, A_log_A_real, A_A_imag, A_C_real, A_C_imag, A_log_dt, A_D_skip, B_x, B_w_in, B_w_sp, B_b_sp, B_w_out):

    def _A_ref(u, log_A_real, A_imag, C_real, C_imag, log_dt, D_skip):
        L = u.shape[1]
        dt = torch.exp(log_dt)
        A = -torch.exp(log_A_real) + 1j * A_imag
        C = (C_real + 1j * C_imag) * dt[:, None]
        pos = (lambda x, dt: x.to(dt))(torch.arange(L), log_dt.dtype)
        P = torch.exp((A * dt[:, None])[:, :, None] * pos[None, None, :])
        K = 2.0 * torch.einsum('dn,dnl->dl', C, P).real
        L2 = 2 * L
        u_t = (lambda x, *d: x.permute(*d))(u, 0, 2, 1)
        Kf = (lambda x, *a, **k: torch.fft.rfft(x.float(), *a, **k))(K, L2)
        Uf = (lambda x, *a, **k: torch.fft.rfft(x.float(), *a, **k))(u_t, L2)
        y = (lambda x, *a, **k: torch.fft.irfft(x, *a, **k).to(torch.bfloat16))(Uf * Kf[None, :, :], L2)[:, :, :L]
        y = (lambda x, *d: x.permute(*d))(y, 0, 2, 1)
        return y + u * D_skip[None, None, :]

    def _B_ref(x, w_in, w_sp, b_sp, w_out):
        B, S, D = x.shape
        F = w_in.shape[-1]
        Fh = F // 2
        z = _gelu(torch.einsum('bsd,df->bsf', x, w_in))
        z1 = z[..., :Fh].clone()
        z2 = _layernorm(z[..., Fh:], axis=-1)
        g = torch.einsum('ts,bsf->btf', w_sp, z2) + b_sp[None, :, None]
        return torch.einsum('bsf,fd->bsd', z1 * g, w_out)
    x = A_u
    xn = _layernorm(x, axis=-1)
    s = _A_ref(xn, A_log_A_real, A_A_imag, A_C_real, A_C_imag, A_log_dt, A_D_skip)
    g = _silu(_B_ref(xn, B_w_in, B_w_sp, B_b_sp, B_w_out))
    return x + s * g
```

```asm
; @launch kernel=k0_kernel grid=(512,1,1) block=(256,1,1) lds=10240
; @launch kernel=km_kernel grid=(512,1,1) block=(256,1,1) lds=76800
.amdgcn_target "amdgcn-amd-amdhsa--gfx950"
.text
.globl k0_kernel
.p2align 8
.type k0_kernel,@function
k0_kernel:
  s_load_dwordx2 s[6:7], s[0:1], 112
  s_cmp_lt_u32 s2, 256
  s_cbranch_scc1 k0_kernel_ln
  s_cmp_lt_u32 s2, 512
  s_cbranch_scc1 k0_kernel_pf
  s_endpgm
k0_kernel_ln:
  s_load_dwordx2 s[4:5], s[0:1], 0
  s_sub_u32 s3, s2, 0
  s_waitcnt lgkmcnt(0)
  s_mov_b32 s8, s4
  s_mov_b32 s9, s5
  s_mov_b32 s10, 0x240000
  s_mov_b32 s11, 0x20000
  v_and_b32 v1, 31, v0
  v_lshrrev_b32 v5, 5, v0
  s_lshl_b32 s30, s3, 3
  v_add_u32 v5, s30, v5
  v_mul_u32_u24 v6, 1152, v5
  v_lshl_add_u32 v6, v1, 4, v6
  buffer_load_dwordx4 v[12:15], v6, s[8:11], 0 offen
  buffer_load_dwordx4 v[16:19], v6, s[8:11], 0 offen offset:512
  v_mov_b32 v20, 0
  v_mov_b32 v21, 0
  v_mov_b32 v22, 0
  v_mov_b32 v23, 0
  s_mov_b32 s30, 0xff
  s_mov_b32 s31, 0xff
  s_mov_b64 exec, s[30:31]
  buffer_load_dwordx4 v[20:23], v6, s[8:11], 0 offen offset:1024
  s_mov_b64 exec, -1
  s_add_u32 s12, s6, 0x27c4000
  s_addc_u32 s13, s7, 0
  s_mov_b32 s14, 0x240000
  s_mov_b32 s15, 0x20000
  s_add_u32 s16, s6, 0x1b00000
  s_addc_u32 s17, s7, 0
  s_mov_b32 s18, 0x240000
  s_mov_b32 s19, 0x20000
  s_add_u32 s20, s6, 0x1f84000
  s_addc_u32 s21, s7, 0
  s_mov_b32 s22, 0x40000
  s_mov_b32 s23, 0x20000
  s_lshl_b32 s24, s3, 10
  v_lshlrev_b32 v8, 2, v0
  v_mov_b32 v9, -1
  buffer_store_dword v9, v8, s[20:23], s24 offen
  s_add_u32 s20, s6, 0x2f15000
  s_addc_u32 s21, s7, 0
  s_mov_b32 s22, 0x4000
  s_mov_b32 s23, 0x20000
  v_mov_b32 v10, 0
  buffer_store_dword v10, v8, s[20:23], s24 offen
  s_waitcnt vmcnt(2)
  v_lshlrev_b32 v24, 16, v12
  v_and_b32 v25, 0xffff0000, v12
  v_lshlrev_b32 v26, 16, v13
  v_and_b32 v27, 0xffff0000, v13
  v_lshlrev_b32 v28, 16, v14
  v_and_b32 v29, 0xffff0000, v14
  v_lshlrev_b32 v30, 16, v15
  v_and_b32 v31, 0xffff0000, v15
  v_lshlrev_b32 v32, 16, v16
  v_and_b32 v33, 0xffff0000, v16
  v_lshlrev_b32 v34, 16, v17
  v_and_b32 v35, 0xffff0000, v17
  v_lshlrev_b32 v36, 16, v18
  v_and_b32 v37, 0xffff0000, v18
  v_lshlrev_b32 v38, 16, v19
  v_and_b32 v39, 0xffff0000, v19
  v_lshlrev_b32 v40, 16, v20
  v_and_b32 v41, 0xffff0000, v20
  v_lshlrev_b32 v42, 16, v21
  v_and_b32 v43, 0xffff0000, v21
  v_lshlrev_b32 v44, 16, v22
  v_and_b32 v45, 0xffff0000, v22
  v_lshlrev_b32 v46, 16, v23
  v_and_b32 v47, 0xffff0000, v23
  v_pk_add_f32 v[48:49], v[24:25], v[26:27]
  v_pk_add_f32 v[48:49], v[48:49], v[28:29]
  v_pk_add_f32 v[48:49], v[48:49], v[30:31]
  v_pk_add_f32 v[48:49], v[48:49], v[32:33]
  v_pk_add_f32 v[48:49], v[48:49], v[34:35]
  v_pk_add_f32 v[48:49], v[48:49], v[36:37]
  v_pk_add_f32 v[48:49], v[48:49], v[38:39]
  v_pk_add_f32 v[48:49], v[48:49], v[40:41]
  v_pk_add_f32 v[48:49], v[48:49], v[42:43]
  v_pk_add_f32 v[48:49], v[48:49], v[44:45]
  v_pk_add_f32 v[48:49], v[48:49], v[46:47]
  v_add_f32 v48, v48, v49
  s_nop 1
  v_add_f32_dpp v48, v48, v48 row_ror:8 row_mask:0xf bank_mask:0xf
  s_nop 1
  v_add_f32_dpp v48, v48, v48 row_ror:4 row_mask:0xf bank_mask:0xf
  s_nop 1
  v_add_f32_dpp v48, v48, v48 row_ror:2 row_mask:0xf bank_mask:0xf
  s_nop 1
  v_add_f32_dpp v48, v48, v48 row_ror:1 row_mask:0xf bank_mask:0xf
  v_mov_b32 v49, v48
  s_nop 1
  v_permlane16_swap_b32 v48, v49
  s_nop 1
  v_add_f32 v48, v48, v49
  v_mul_f32 v48, 0x3ae38e39, v48
  v_mov_b32 v49, v48
  v_mov_b32 v50, 0
  v_mov_b32 v51, 0
  v_pk_add_f32 v[52:53], v[24:25], v[48:49] neg_lo:[0,1] neg_hi:[0,1]
  v_pk_fma_f32 v[50:51], v[52:53], v[52:53], v[50:51]
  v_pk_add_f32 v[54:55], v[26:27], v[48:49] neg_lo:[0,1] neg_hi:[0,1]
  v_pk_fma_f32 v[50:51], v[54:55], v[54:55], v[50:51]
  v_pk_add_f32 v[52:53], v[28:29], v[48:49] neg_lo:[0,1] neg_hi:[0,1]
  v_pk_fma_f32 v[50:51], v[52:53], v[52:53], v[50:51]
  v_pk_add_f32 v[54:55], v[30:31], v[48:49] neg_lo:[0,1] neg_hi:[0,1]
  v_pk_fma_f32 v[50:51], v[54:55], v[54:55], v[50:51]
  v_pk_add_f32 v[52:53], v[32:33], v[48:49] neg_lo:[0,1] neg_hi:[0,1]
  v_pk_fma_f32 v[50:51], v[52:53], v[52:53], v[50:51]
  v_pk_add_f32 v[54:55], v[34:35], v[48:49] neg_lo:[0,1] neg_hi:[0,1]
  v_pk_fma_f32 v[50:51], v[54:55], v[54:55], v[50:51]
  v_pk_add_f32 v[52:53], v[36:37], v[48:49] neg_lo:[0,1] neg_hi:[0,1]
  v_pk_fma_f32 v[50:51], v[52:53], v[52:53], v[50:51]
  v_pk_add_f32 v[54:55], v[38:39], v[48:49] neg_lo:[0,1] neg_hi:[0,1]
  v_pk_fma_f32 v[50:51], v[54:55], v[54:55], v[50:51]
  s_mov_b64 exec, s[30:31]
  v_pk_add_f32 v[52:53], v[40:41], v[48:49] neg_lo:[0,1] neg_hi:[0,1]
  v_pk_fma_f32 v[50:51], v[52:53], v[52:53], v[50:51]
  v_pk_add_f32 v[54:55], v[42:43], v[48:49] neg_lo:[0,1] neg_hi:[0,1]
  v_pk_fma_f32 v[50:51], v[54:55], v[54:55], v[50:51]
  v_pk_add_f32 v[52:53], v[44:45], v[48:49] neg_lo:[0,1] neg_hi:[0,1]
  v_pk_fma_f32 v[50:51], v[52:53], v[52:53], v[50:51]
  v_pk_add_f32 v[54:55], v[46:47], v[48:49] neg_lo:[0,1] neg_hi:[0,1]
  v_pk_fma_f32 v[50:51], v[54:55], v[54:55], v[50:51]
  s_mov_b64 exec, -1
  v_add_f32 v50, v50, v51
  s_nop 1
  v_add_f32_dpp v50, v50, v50 row_ror:8 row_mask:0xf bank_mask:0xf
  s_nop 1
  v_add_f32_dpp v50, v50, v50 row_ror:4 row_mask:0xf bank_mask:0xf
  s_nop 1
  v_add_f32_dpp v50, v50, v50 row_ror:2 row_mask:0xf bank_mask:0xf
  s_nop 1
  v_add_f32_dpp v50, v50, v50 row_ror:1 row_mask:0xf bank_mask:0xf
  v_mov_b32 v51, v50
  s_nop 1
  v_permlane16_swap_b32 v50, v51
  s_nop 1
  v_add_f32 v50, v50, v51
  v_mul_f32 v50, 0x3ae38e39, v50
  v_cvt_pk_bf16_f32 v50, v50, v50
  v_and_b32 v50, 0xffff0000, v50
  v_add_f32 v50, 0x3727c5ac, v50
  v_cvt_pk_bf16_f32 v50, v50, v50
  v_and_b32 v50, 0xffff0000, v50
  v_sqrt_f32 v50, v50
  v_cvt_pk_bf16_f32 v48, v48, v48
  v_and_b32 v48, 0xffff0000, v48
  v_mov_b32 v49, v48
  v_cvt_pk_bf16_f32 v50, v50, v50
  v_and_b32 v50, 0xffff0000, v50
  v_rcp_f32 v50, v50
  v_pk_add_f32 v[24:25], v[24:25], v[48:49] neg_lo:[0,1] neg_hi:[0,1]
  v_pk_add_f32 v[26:27], v[26:27], v[48:49] neg_lo:[0,1] neg_hi:[0,1]
  v_pk_add_f32 v[28:29], v[28:29], v[48:49] neg_lo:[0,1] neg_hi:[0,1]
  v_pk_add_f32 v[30:31], v[30:31], v[48:49] neg_lo:[0,1] neg_hi:[0,1]
  v_pk_add_f32 v[32:33], v[32:33], v[48:49] neg_lo:[0,1] neg_hi:[0,1]
  v_pk_add_f32 v[34:35], v[34:35], v[48:49] neg_lo:[0,1] neg_hi:[0,1]
  v_pk_add_f32 v[36:37], v[36:37], v[48:49] neg_lo:[0,1] neg_hi:[0,1]
  v_pk_add_f32 v[38:39], v[38:39], v[48:49] neg_lo:[0,1] neg_hi:[0,1]
  v_pk_add_f32 v[40:41], v[40:41], v[48:49] neg_lo:[0,1] neg_hi:[0,1]
  v_pk_add_f32 v[42:43], v[42:43], v[48:49] neg_lo:[0,1] neg_hi:[0,1]
  v_pk_add_f32 v[44:45], v[44:45], v[48:49] neg_lo:[0,1] neg_hi:[0,1]
  v_pk_add_f32 v[46:47], v[46:47], v[48:49] neg_lo:[0,1] neg_hi:[0,1]
  v_mov_b32 v51, v50
  v_cvt_pk_bf16_f32 v12, v24, v25
  v_cvt_pk_bf16_f32 v13, v26, v27
  v_cvt_pk_bf16_f32 v14, v28, v29
  v_cvt_pk_bf16_f32 v15, v30, v31
  v_cvt_pk_bf16_f32 v16, v32, v33
  v_cvt_pk_bf16_f32 v17, v34, v35
  v_cvt_pk_bf16_f32 v18, v36, v37
  v_cvt_pk_bf16_f32 v19, v38, v39
  v_cvt_pk_bf16_f32 v20, v40, v41
  v_cvt_pk_bf16_f32 v21, v42, v43
  v_cvt_pk_bf16_f32 v22, v44, v45
  v_cvt_pk_bf16_f32 v23, v46, v47
  v_lshlrev_b32 v24, 16, v12
  v_and_b32 v25, 0xffff0000, v12
  v_lshlrev_b32 v26, 16, v13
  v_and_b32 v27, 0xffff0000, v13
  v_lshlrev_b32 v28, 16, v14
  v_and_b32 v29, 0xffff0000, v14
  v_lshlrev_b32 v30, 16, v15
  v_and_b32 v31, 0xffff0000, v15
  v_lshlrev_b32 v32, 16, v16
  v_and_b32 v33, 0xffff0000, v16
  v_lshlrev_b32 v34, 16, v17
  v_and_b32 v35, 0xffff0000, v17
  v_lshlrev_b32 v36, 16, v18
  v_and_b32 v37, 0xffff0000, v18
  v_lshlrev_b32 v38, 16, v19
  v_and_b32 v39, 0xffff0000, v19
  v_lshlrev_b32 v40, 16, v20
  v_and_b32 v41, 0xffff0000, v20
  v_lshlrev_b32 v42, 16, v21
  v_and_b32 v43, 0xffff0000, v21
  v_lshlrev_b32 v44, 16, v22
  v_and_b32 v45, 0xffff0000, v22
  v_lshlrev_b32 v46, 16, v23
  v_and_b32 v47, 0xffff0000, v23
  v_pk_mul_f32 v[24:25], v[24:25], v[50:51]
  v_pk_mul_f32 v[26:27], v[26:27], v[50:51]
  v_pk_mul_f32 v[28:29], v[28:29], v[50:51]
  v_pk_mul_f32 v[30:31], v[30:31], v[50:51]
  v_pk_mul_f32 v[32:33], v[32:33], v[50:51]
  v_pk_mul_f32 v[34:35], v[34:35], v[50:51]
  v_pk_mul_f32 v[36:37], v[36:37], v[50:51]
  v_pk_mul_f32 v[38:39], v[38:39], v[50:51]
  v_pk_mul_f32 v[40:41], v[40:41], v[50:51]
  v_pk_mul_f32 v[42:43], v[42:43], v[50:51]
  v_pk_mul_f32 v[44:45], v[44:45], v[50:51]
  v_pk_mul_f32 v[46:47], v[46:47], v[50:51]
  v_cvt_pk_bf16_f32 v12, v24, v25
  v_cvt_pk_bf16_f32 v13, v26, v27
  v_cvt_pk_bf16_f32 v14, v28, v29
  v_cvt_pk_bf16_f32 v15, v30, v31
  v_cvt_pk_bf16_f32 v16, v32, v33
  v_cvt_pk_bf16_f32 v17, v34, v35
  v_cvt_pk_bf16_f32 v18, v36, v37
  v_cvt_pk_bf16_f32 v19, v38, v39
  v_cvt_pk_bf16_f32 v20, v40, v41
  v_cvt_pk_bf16_f32 v21, v42, v43
  v_cvt_pk_bf16_f32 v22, v44, v45
  v_cvt_pk_bf16_f32 v23, v46, v47
  v_lshrrev_b32 v6, 5, v0
  v_mul_u32_u24 v6, 1152, v6
  v_lshl_add_u32 v6, v1, 4, v6
  v_add_u32 v6, 0, v6
  ds_write_b128 v6, v[12:15]
  ds_write_b128 v6, v[16:19] offset:512
  s_mov_b64 exec, s[30:31]
  ds_write_b128 v6, v[20:23] offset:1024
  s_mov_b64 exec, -1
  s_waitcnt lgkmcnt(0)
  s_barrier
  v_and_b32 v6, 7, v0
  v_lshrrev_b32 v7, 3, v0
  v_mul_u32_u24 v56, 1152, v6
  v_lshl_add_u32 v56, v7, 4, v56
  v_add_u32 v56, 0, v56
  ds_read_b128 v[60:63], v56
  ds_read_b128 v[64:67], v56 offset:512
  v_cmp_gt_u32 vcc, 64, v0
  s_and_saveexec_b64 s[56:57], vcc
  ds_read_b128 v[68:71], v56 offset:1024
  s_mov_b64 exec, s[56:57]
  s_lshr_b32 s38, s3, 1
  s_mul_i32 s38, s38, 18432
  s_and_b32 s39, s3, 1
  s_lshl_b32 s39, s39, 7
  s_add_u32 s38, s38, s39
  v_lshrrev_b32 v57, 2, v7
  v_lshlrev_b32 v57, 10, v57
  v_and_b32 v7, 3, v7
  v_lshl_add_u32 v57, v7, 8, v57
  v_lshl_add_u32 v57, v6, 4, v57
  s_waitcnt lgkmcnt(0)
  buffer_store_dwordx4 v[60:63], v57, s[12:15], s38 offen
  s_add_u32 s38, s38, 8192
  buffer_store_dwordx4 v[64:67], v57, s[12:15], s38 offen
  s_add_u32 s38, s38, 8192
  s_and_saveexec_b64 s[56:57], vcc
  buffer_store_dwordx4 v[68:71], v57, s[12:15], s38 offen
  s_mov_b64 exec, s[56:57]
  s_mul_i32 s31, s3, 9216
  v_lshlrev_b32 v6, 1, v0
  v_add_u32 v6, 0, v6
  v_lshlrev_b32 v7, 4, v0
  v_cmp_gt_u32 vcc, 64, v0
  ds_read_u16 v24, v6 offset:0
  ds_read_u16 v25, v6 offset:1152
  ds_read_u16 v26, v6 offset:2304
  ds_read_u16 v27, v6 offset:3456
  ds_read_u16 v28, v6 offset:4608
  ds_read_u16 v29, v6 offset:5760
  ds_read_u16 v30, v6 offset:6912
  ds_read_u16 v31, v6 offset:8064
  ds_read_u16 v32, v6 offset:512
  ds_read_u16 v33, v6 offset:1664
  ds_read_u16 v34, v6 offset:2816
  ds_read_u16 v35, v6 offset:3968
  ds_read_u16 v36, v6 offset:5120
  ds_read_u16 v37, v6 offset:6272
  ds_read_u16 v38, v6 offset:7424
  ds_read_u16 v39, v6 offset:8576
  s_and_saveexec_b64 s[56:57], vcc
  ds_read_u16 v40, v6 offset:1024
  ds_read_u16 v41, v6 offset:2176
  ds_read_u16 v42, v6 offset:3328
  ds_read_u16 v43, v6 offset:4480
  ds_read_u16 v44, v6 offset:5632
  ds_read_u16 v45, v6 offset:6784
  ds_read_u16 v46, v6 offset:7936
  ds_read_u16 v47, v6 offset:9088
  s_mov_b64 exec, s[56:57]
  s_waitcnt lgkmcnt(0)
  v_lshlrev_b32 v24, 16, v24
  v_lshlrev_b32 v25, 16, v25
  v_lshlrev_b32 v26, 16, v26
  v_lshlrev_b32 v27, 16, v27
  v_lshlrev_b32 v28, 16, v28
  v_lshlrev_b32 v29, 16, v29
  v_lshlrev_b32 v30, 16, v30
  v_lshlrev_b32 v31, 16, v31
  v_cvt_pk_f16_f32 v12, v24, v25
  v_cvt_pk_f16_f32 v13, v26, v27
  v_cvt_pk_f16_f32 v14, v28, v29
  v_cvt_pk_f16_f32 v15, v30, v31
  buffer_store_dwordx4 v[12:15], v7, s[16:19], s31 offen
  s_add_u32 s31, s31, 4096
  v_lshlrev_b32 v32, 16, v32
  v_lshlrev_b32 v33, 16, v33
  v_lshlrev_b32 v34, 16, v34
  v_lshlrev_b32 v35, 16, v35
  v_lshlrev_b32 v36, 16, v36
  v_lshlrev_b32 v37, 16, v37
  v_lshlrev_b32 v38, 16, v38
  v_lshlrev_b32 v39, 16, v39
  v_cvt_pk_f16_f32 v16, v32, v33
  v_cvt_pk_f16_f32 v17, v34, v35
  v_cvt_pk_f16_f32 v18, v36, v37
  v_cvt_pk_f16_f32 v19, v38, v39
  buffer_store_dwordx4 v[16:19], v7, s[16:19], s31 offen
  s_add_u32 s31, s31, 4096
  v_lshlrev_b32 v40, 16, v40
  v_lshlrev_b32 v41, 16, v41
  v_lshlrev_b32 v42, 16, v42
  v_lshlrev_b32 v43, 16, v43
  v_lshlrev_b32 v44, 16, v44
  v_lshlrev_b32 v45, 16, v45
  v_lshlrev_b32 v46, 16, v46
  v_lshlrev_b32 v47, 16, v47
  v_cvt_pk_f16_f32 v20, v40, v41
  v_cvt_pk_f16_f32 v21, v42, v43
  v_cvt_pk_f16_f32 v22, v44, v45
  v_cvt_pk_f16_f32 v23, v46, v47
  s_and_saveexec_b64 s[56:57], vcc
  buffer_store_dwordx4 v[20:23], v7, s[16:19], s31 offen
  s_mov_b64 exec, s[56:57]
  s_add_u32 s31, s31, 4096
  s_endpgm
k0_kernel_pf:
  s_load_dwordx2 s[4:5], s[0:1], 64
  s_sub_u32 s3, s2, 256
  s_waitcnt lgkmcnt(0)
  s_mov_b32 s8, s4
  s_mov_b32 s9, s5
  s_mov_b32 s10, 0x510000
  s_mov_b32 s11, 0x20000
  s_mul_i32 s20, s3, 20736
  v_lshlrev_b32 v1, 4, v0
  buffer_load_dwordx4 v[8:11], v1, s[8:11], s20 offen
  s_add_u32 s20, s20, 4096
  buffer_load_dwordx4 v[12:15], v1, s[8:11], s20 offen
  s_add_u32 s20, s20, 4096
  buffer_load_dwordx4 v[16:19], v1, s[8:11], s20 offen
  s_add_u32 s20, s20, 4096
  buffer_load_dwordx4 v[20:23], v1, s[8:11], s20 offen
  s_add_u32 s20, s20, 4096
  buffer_load_dwordx4 v[24:27], v1, s[8:11], s20 offen
  s_add_u32 s20, s20, 4096
  buffer_load_dwordx4 v[28:31], v1, s[8:11], s20 offen
  s_add_u32 s20, s20, 4096
  s_waitcnt vmcnt(0)
  s_endpgm
.text
.globl km_kernel
.p2align 8
.type km_kernel,@function
km_kernel:
  s_cmp_ge_u32 s2, 512
  s_cbranch_scc1 km_kernel_end
  s_cmp_ge_u32 s2, 256
  s_cbranch_scc1 km_kernel_cv
  s_load_dwordx2 s[4:5], s[0:1], 64
  s_load_dwordx2 s[6:7], s[0:1], 112
  s_load_dwordx2 s[60:61], s[0:1], 80
  s_load_dwordx2 s[62:63], s[0:1], 0
  s_load_dwordx2 s[64:65], s[0:1], 96
  s_lshr_b32 s36, s2, 4
  s_and_b32 s31, s2, 7
  s_lshl_b32 s37, s31, 1
  s_lshr_b32 s31, s2, 3
  s_and_b32 s31, s31, 1
  s_add_u32 s37, s37, s31
  s_and_b32 s30, s2, 7
  s_lshr_b32 s31, s2, 3
  s_and_b32 s36, s30, 1
  s_lshl_b32 s36, s36, 3
  s_and_b32 s39, s31, 7
  s_add_u32 s36, s36, s39
  s_lshr_b32 s37, s30, 1
  s_lshl_b32 s37, s37, 2
  s_lshr_b32 s39, s31, 3
  s_add_u32 s37, s37, s39
  v_lshrrev_b32 v1, 6, v0
  v_and_b32 v2, 63, v0
  v_readfirstlane_b32 s35, v1
  v_and_b32 v3, 15, v2
  v_lshrrev_b32 v4, 4, v2
  s_lshl_b32 s39, s36, 3
  s_lshl_b32 s31, s35, 1
  s_add_u32 s39, s39, s31
  s_mul_i32 s39, s39, 18432
  v_lshl_add_u32 v236, v2, 4, s39
  v_add_u32 v237, 18432, v236
  s_mul_i32 s30, s37, 288
  s_add_u32 s30, s30, 4608
  s_mul_i32 s31, s35, 147456
  s_add_u32 s30, s30, s31
  v_add_u32 v5, 0, v2
  v_mul_u32_u24 v6, 3641, v5
  v_lshrrev_b32 v6, 16, v6
  v_mul_u32_u24 v7, 18, v6
  v_sub_u32 v7, v5, v7
  v_and_b32 v5, 3, v6
  v_bfe_u32 v1, v6, 2, 1
  v_lshl_or_b32 v5, v1, 3, v5
  v_bfe_u32 v1, v6, 3, 1
  v_lshl_or_b32 v5, v1, 2, v5
  v_mul_u32_u24 v5, 9216, v5
  v_lshl_add_u32 v5, v7, 4, v5
  v_add_u32 v5, s30, v5
  v_mov_b32 v238, v5
  v_add_u32 v5, 32, v2
  v_mul_u32_u24 v6, 3641, v5
  v_lshrrev_b32 v6, 16, v6
  v_mul_u32_u24 v7, 18, v6
  v_sub_u32 v7, v5, v7
  v_and_b32 v5, 3, v6
  v_bfe_u32 v1, v6, 2, 1
  v_lshl_or_b32 v5, v1, 3, v5
  v_bfe_u32 v1, v6, 3, 1
  v_lshl_or_b32 v5, v1, 2, v5
  v_mul_u32_u24 v5, 9216, v5
  v_lshl_add_u32 v5, v7, 4, v5
  v_add_u32 v5, s30, v5
  v_subrev_u32 v239, 512, v5
  v_add_u32 v5, 96, v2
  v_mul_u32_u24 v6, 3641, v5
  v_lshrrev_b32 v6, 16, v6
  v_mul_u32_u24 v7, 18, v6
  v_sub_u32 v7, v5, v7
  v_and_b32 v5, 3, v6
  v_bfe_u32 v1, v6, 2, 1
  v_lshl_or_b32 v5, v1, 3, v5
  v_bfe_u32 v1, v6, 3, 1
  v_lshl_or_b32 v5, v1, 2, v5
  v_mul_u32_u24 v5, 9216, v5
  v_lshl_add_u32 v5, v7, 4, v5
  v_add_u32 v5, s30, v5
  v_subrev_u32 v240, 1536, v5
  v_add_u32 v5, 160, v2
  v_mul_u32_u24 v6, 3641, v5
  v_lshrrev_b32 v6, 16, v6
  v_mul_u32_u24 v7, 18, v6
  v_sub_u32 v7, v5, v7
  v_and_b32 v5, 3, v6
  v_bfe_u32 v1, v6, 2, 1
  v_lshl_or_b32 v5, v1, 3, v5
  v_bfe_u32 v1, v6, 3, 1
  v_lshl_or_b32 v5, v1, 2, v5
  v_mul_u32_u24 v5, 9216, v5
  v_lshl_add_u32 v5, v7, 4, v5
  v_add_u32 v5, s30, v5
  v_subrev_u32 v241, 2560, v5
  v_add_u32 v5, 224, v2
  v_mul_u32_u24 v6, 3641, v5
  v_lshrrev_b32 v6, 16, v6
  v_mul_u32_u24 v7, 18, v6
  v_sub_u32 v7, v5, v7
  v_and_b32 v5, 3, v6
  v_bfe_u32 v1, v6, 2, 1
  v_lshl_or_b32 v5, v1, 3, v5
  v_bfe_u32 v1, v6, 3, 1
  v_lshl_or_b32 v5, v1, 2, v5
  v_mul_u32_u24 v5, 9216, v5
  v_lshl_add_u32 v5, v7, 4, v5
  v_add_u32 v5, s30, v5
  v_subrev_u32 v242, 3584, v5
  v_lshrrev_b32 v5, 1, v4
  v_lshlrev_b32 v5, 4, v5
  v_and_b32 v6, 1, v4
  v_lshl_add_u32 v5, v6, 2, v5
  v_lshrrev_b32 v6, 2, v3
  v_add_u32 v5, v5, v6
  v_mul_u32_u24 v5, 288, v5
  v_and_b32 v6, 3, v2
  v_lshl_add_u32 v243, v6, 3, v5
  v_add_u32 v244, 36864, v243
  s_mul_i32 s34, s35, 4608
  s_mov_b32 s40, -1
  s_mov_b32 s41, 0
  s_mov_b32 s42, 0xbdd2d3e8
  s_mov_b32 s43, s42
  s_mov_b32 s52, 1.0
  s_mov_b32 s53, 1.0
  v_mov_b32 v246, 0xc0135761
  v_mov_b32 v247, 0xc0135761
  s_waitcnt lgkmcnt(0)
  s_add_u32 s8, s6, 0x27c4000
  s_addc_u32 s9, s7, 0
  s_mov_b32 s10, 0x240000
  s_mov_b32 s11, 0x20000
  s_mov_b32 s12, s4
  s_mov_b32 s13, s5
  s_mov_b32 s14, 0x510000
  s_mov_b32 s15, 0x20000
  s_add_u32 s16, s6, 0x1f84000
  s_addc_u32 s17, s7, 0
  s_mov_b32 s18, 0x40000
  s_mov_b32 s19, 0x20000
  s_add_u32 s20, s6, 0x900000
  s_addc_u32 s21, s7, 0
  s_mov_b32 s22, 0x900000
  s_mov_b32 s23, 0x20000
  s_add_u32 s24, s6, 0x1fc4000
  s_addc_u32 s25, s7, 0
  s_mov_b32 s26, 0x800000
  s_mov_b32 s27, 0x20000
  s_add_u32 s72, s6, 0x1200000
  s_addc_u32 s73, s7, 0
  s_mov_b32 s74, 0x900000
  s_mov_b32 s75, 0x20000
  s_add_u32 s44, s6, 0x2f15000
  s_addc_u32 s45, s7, 0
  s_mov_b32 s46, 0x8000
  s_mov_b32 s47, 0x20000
  s_mov_b32 s48, s60
  s_mov_b32 s49, s61
  s_mov_b32 s50, 0x1000
  s_mov_b32 s51, 0x20000
  s_mov_b32 s32, 0
  s_mov_b32 s33, 0
  buffer_load_dwordx4 v[152:155], v236, s[8:11], s32 offen offset:0
  buffer_load_dwordx4 v[156:159], v237, s[8:11], s32 offen offset:0
  buffer_load_dwordx4 v[160:163], v236, s[8:11], s32 offen offset:1024
  buffer_load_dwordx4 v[164:167], v237, s[8:11], s32 offen offset:1024
  s_add_u32 s32, s32, 2048
  s_add_u32 m0, s34, 0
  s_mov_b64 exec, s[40:41]
  buffer_load_dwordx4 v238, s[12:15], s33 offen lds
  s_mov_b64 exec, -1
  buffer_load_dwordx4 v239, s[12:15], s33 offen offset:512 lds
  buffer_load_dwordx4 v240, s[12:15], s33 offen offset:1536 lds
  buffer_load_dwordx4 v241, s[12:15], s33 offen offset:2560 lds
  buffer_load_dwordx4 v242, s[12:15], s33 offen offset:3584 lds
  s_add_u32 s33, s33, 589824
  buffer_load_dwordx4 v[168:171], v236, s[8:11], s32 offen offset:0
  buffer_load_dwordx4 v[172:175], v237, s[8:11], s32 offen offset:0
  buffer_load_dwordx4 v[176:179], v236, s[8:11], s32 offen offset:1024
  buffer_load_dwordx4 v[180:183], v237, s[8:11], s32 offen offset:1024
  s_add_u32 s32, s32, 2048
  s_add_u32 m0, s34, 18432
  s_mov_b64 exec, s[40:41]
  buffer_load_dwordx4 v238, s[12:15], s33 offen lds
  s_mov_b64 exec, -1
  buffer_load_dwordx4 v239, s[12:15], s33 offen offset:512 lds
  buffer_load_dwordx4 v240, s[12:15], s33 offen offset:1536 lds
  buffer_load_dwordx4 v241, s[12:15], s33 offen offset:2560 lds
  buffer_load_dwordx4 v242, s[12:15], s33 offen offset:3584 lds
  s_add_u32 s33, s33, 589824
  s_add_u32 m0, s34, 36864
  s_mov_b64 exec, s[40:41]
  buffer_load_dwordx4 v238, s[12:15], s33 offen lds
  s_mov_b64 exec, -1
  buffer_load_dwordx4 v239, s[12:15], s33 offen offset:512 lds
  buffer_load_dwordx4 v240, s[12:15], s33 offen offset:1536 lds
  buffer_load_dwordx4 v241, s[12:15], s33 offen offset:2560 lds
  buffer_load_dwordx4 v242, s[12:15], s33 offen offset:3584 lds
  s_add_u32 s33, s33, 589824
  v_mov_b32 v8, 0
  v_mov_b32 v9, 0
  v_mov_b32 v10, 0
  v_mov_b32 v11, 0
  v_mov_b32 v12, 0
  v_mov_b32 v13, 0
  v_mov_b32 v14, 0
  v_mov_b32 v15, 0
  v_mov_b32 v16, 0
  v_mov_b32 v17, 0
  v_mov_b32 v18, 0
  v_mov_b32 v19, 0
  v_mov_b32 v20, 0
  v_mov_b32 v21, 0
  v_mov_b32 v22, 0
  v_mov_b32 v23, 0
  v_mov_b32 v24, 0
  v_mov_b32 v25, 0
  v_mov_b32 v26, 0
  v_mov_b32 v27, 0
  v_mov_b32 v28, 0
  v_mov_b32 v29, 0
  v_mov_b32 v30, 0
  v_mov_b32 v31, 0
  v_mov_b32 v32, 0
  v_mov_b32 v33, 0
  v_mov_b32 v34, 0
  v_mov_b32 v35, 0
  v_mov_b32 v36, 0
  v_mov_b32 v37, 0
  v_mov_b32 v38, 0
  v_mov_b32 v39, 0
  v_mov_b32 v40, 0
  v_mov_b32 v41, 0
  v_mov_b32 v42, 0
  v_mov_b32 v43, 0
  v_mov_b32 v44, 0
  v_mov_b32 v45, 0
  v_mov_b32 v46, 0
  v_mov_b32 v47, 0
  v_mov_b32 v48, 0
  v_mov_b32 v49, 0
  v_mov_b32 v50, 0
  v_mov_b32 v51, 0
  v_mov_b32 v52, 0
  v_mov_b32 v53, 0
  v_mov_b32 v54, 0
  v_mov_b32 v55, 0
  v_mov_b32 v56, 0
  v_mov_b32 v57, 0
  v_mov_b32 v58, 0
  v_mov_b32 v59, 0
  v_mov_b32 v60, 0
  v_mov_b32 v61, 0
  v_mov_b32 v62, 0
  v_mov_b32 v63, 0
  v_mov_b32 v64, 0
  v_mov_b32 v65, 0
  v_mov_b32 v66, 0
  v_mov_b32 v67, 0
  v_mov_b32 v68, 0
  v_mov_b32 v69, 0
  v_mov_b32 v70, 0
  v_mov_b32 v71, 0
  v_mov_b32 v72, 0
  v_mov_b32 v73, 0
  v_mov_b32 v74, 0
  v_mov_b32 v75, 0
  v_mov_b32 v76, 0
  v_mov_b32 v77, 0
  v_mov_b32 v78, 0
  v_mov_b32 v79, 0
  s_waitcnt vmcnt(14)
  s_barrier
  ds_read_b64_tr_b16 v[80:81], v243 offset:0
  ds_read_b64_tr_b16 v[82:83], v243 offset:2304
  ds_read_b64_tr_b16 v[84:85], v243 offset:32
  ds_read_b64_tr_b16 v[86:87], v243 offset:2336
  ds_read_b64_tr_b16 v[88:89], v243 offset:64
  ds_read_b64_tr_b16 v[90:91], v243 offset:2368
  ds_read_b64_tr_b16 v[92:93], v243 offset:96
  ds_read_b64_tr_b16 v[94:95], v243 offset:2400
  ds_read_b64_tr_b16 v[96:97], v243 offset:128
  ds_read_b64_tr_b16 v[98:99], v243 offset:2432
  ds_read_b64_tr_b16 v[100:101], v243 offset:160
  ds_read_b64_tr_b16 v[102:103], v243 offset:2464
  ds_read_b64_tr_b16 v[104:105], v243 offset:192
  ds_read_b64_tr_b16 v[106:107], v243 offset:2496
  ds_read_b64_tr_b16 v[108:109], v243 offset:224
  ds_read_b64_tr_b16 v[110:111], v243 offset:2528
  ds_read_b64_tr_b16 v[112:113], v243 offset:256
  ds_read_b64_tr_b16 v[114:115], v243 offset:2560
  s_waitcnt vmcnt(19)
  s_waitcnt lgkmcnt(12)
  v_mfma_f32_16x16x32_bf16 v[8:11], v[152:155], v[80:83], v[8:11]
  ds_read_b64_tr_b16 v[116:117], v243 offset:9216
  ds_read_b64_tr_b16 v[118:119], v243 offset:11520
  v_mfma_f32_16x16x32_bf16 v[12:15], v[156:159], v[80:83], v[12:15]
  v_mfma_f32_16x16x32_bf16 v[16:19], v[152:155], v[84:87], v[16:19]
  ds_read_b64_tr_b16 v[120:121], v243 offset:9248
  ds_read_b64_tr_b16 v[122:123], v243 offset:11552
  v_mfma_f32_16x16x32_bf16 v[20:23], v[156:159], v[84:87], v[20:23]
  buffer_load_dwordx4 v[184:187], v236, s[8:11], s32 offen offset:0
  v_mfma_f32_16x16x32_bf16 v[24:27], v[152:155], v[88:91], v[24:27]
  ds_read_b64_tr_b16 v[124:125], v243 offset:9280
  ds_read_b64_tr_b16 v[126:127], v243 offset:11584
  v_mfma_f32_16x16x32_bf16 v[28:31], v[156:159], v[88:91], v[28:31]
  s_waitcnt lgkmcnt(12)
  v_mfma_f32_16x16x32_bf16 v[32:35], v[152:155], v[92:95], v[32:35]
  ds_read_b64_tr_b16 v[128:129], v243 offset:9312
  ds_read_b64_tr_b16 v[130:131], v243 offset:11616
  v_mfma_f32_16x16x32_bf16 v[36:39], v[156:159], v[92:95], v[36:39]
  buffer_load_dwordx4 v[188:191], v237, s[8:11], s32 offen offset:0
  v_mfma_f32_16x16x32_bf16 v[40:43], v[152:155], v[96:99], v[40:43]
  ds_read_b64_tr_b16 v[132:133], v243 offset:9344
  ds_read_b64_tr_b16 v[134:135], v243 offset:11648
  v_mfma_f32_16x16x32_bf16 v[44:47], v[156:159], v[96:99], v[44:47]
  v_mfma_f32_16x16x32_bf16 v[48:51], v[152:155], v[100:103], v[48:51]
  ds_read_b64_tr_b16 v[136:137], v243 offset:9376
  ds_read_b64_tr_b16 v[138:139], v243 offset:11680
  v_mfma_f32_16x16x32_bf16 v[52:55], v[156:159], v[100:103], v[52:55]
  buffer_load_dwordx4 v[192:195], v236, s[8:11], s32 offen offset:1024
  s_waitcnt lgkmcnt(12)
  v_mfma_f32_16x16x32_bf16 v[56:59], v[152:155], v[104:107], v[56:59]
  ds_read_b64_tr_b16 v[140:141], v243 offset:9408
  ds_read_b64_tr_b16 v[142:143], v243 offset:11712
  v_mfma_f32_16x16x32_bf16 v[60:63], v[156:159], v[104:107], v[60:63]
  v_mfma_f32_16x16x32_bf16 v[64:67], v[152:155], v[108:111], v[64:67]
  ds_read_b64_tr_b16 v[144:145], v243 offset:9440
  ds_read_b64_tr_b16 v[146:147], v243 offset:11744
  v_mfma_f32_16x16x32_bf16 v[68:71], v[156:159], v[108:111], v[68:71]
  buffer_load_dwordx4 v[196:199], v237, s[8:11], s32 offen offset:1024
  s_add_u32 s32, s32, 2048
  v_mfma_f32_16x16x32_bf16 v[72:75], v[152:155], v[112:115], v[72:75]
  ds_read_b64_tr_b16 v[148:149], v243 offset:9472
  ds_read_b64_tr_b16 v[150:151], v243 offset:11776
  v_mfma_f32_16x16x32_bf16 v[76:79], v[156:159], v[112:115], v[76:79]
  s_waitcnt lgkmcnt(12)
  v_mfma_f32_16x16x32_bf16 v[8:11], v[160:163], v[116:119], v[8:11]
  s_waitcnt vmcnt(9)
  s_barrier
  ds_read_b64_tr_b16 v[80:81], v243 offset:18432
  ds_read_b64_tr_b16 v[82:83], v243 offset:20736
  v_mfma_f32_16x16x32_bf16 v[12:15], v[164:167], v[116:119], v[12:15]
  v_mfma_f32_16x16x32_bf16 v[16:19], v[160:163], v[120:123], v[16:19]
  ds_read_b64_tr_b16 v[84:85], v243 offset:18464
  ds_read_b64_tr_b16 v[86:87], v243 offset:20768
  v_mfma_f32_16x16x32_bf16 v[20:23], v[164:167], v[120:123], v[20:23]
  s_add_u32 m0, s34, 55296
  s_mov_b64 exec, s[40:41]
  buffer_load_dwordx4 v238, s[12:15], s33 offen lds
  s_mov_b64 exec, -1
  v_mfma_f32_16x16x32_bf16 v[24:27], v[160:163], v[124:127], v[24:27]
  ds_read_b64_tr_b16 v[88:89], v243 offset:18496
  ds_read_b64_tr_b16 v[90:91], v243 offset:20800
  v_mfma_f32_16x16x32_bf16 v[28:31], v[164:167], v[124:127], v[28:31]
  s_waitcnt lgkmcnt(12)
  v_mfma_f32_16x16x32_bf16 v[32:35], v[160:163], v[128:131], v[32:35]
  ds_read_b64_tr_b16 v[92:93], v243 offset:18528
  ds_read_b64_tr_b16 v[94:95], v243 offset:20832
  v_mfma_f32_16x16x32_bf16 v[36:39], v[164:167], v[128:131], v[36:39]
  buffer_load_dwordx4 v239, s[12:15], s33 offen offset:512 lds
  v_mfma_f32_16x16x32_bf16 v[40:43], v[160:163], v[132:135], v[40:43]
  ds_read_b64_tr_b16 v[96:97], v243 offset:18560
  ds_read_b64_tr_b16 v[98:99], v243 offset:20864
  v_mfma_f32_16x16x32_bf16 v[44:47], v[164:167], v[132:135], v[44:47]
  v_mfma_f32_16x16x32_bf16 v[48:51], v[160:163], v[136:139], v[48:51]
  ds_read_b64_tr_b16 v[100:101], v243 offset:18592
  ds_read_b64_tr_b16 v[102:103], v243 offset:20896
  v_mfma_f32_16x16x32_bf16 v[52:55], v[164:167], v[136:139], v[52:55]
  buffer_load_dwordx4 v240, s[12:15], s33 offen offset:1536 lds
  s_waitcnt lgkmcnt(12)
  v_mfma_f32_16x16x32_bf16 v[56:59], v[160:163], v[140:143], v[56:59]
  ds_read_b64_tr_b16 v[104:105], v243 offset:18624
  ds_read_b64_tr_b16 v[106:107], v243 offset:20928
  v_mfma_f32_16x16x32_bf16 v[60:63], v[164:167], v[140:143], v[60:63]
  v_mfma_f32_16x16x32_bf16 v[64:67], v[160:163], v[144:147], v[64:67]
  ds_read_b64_tr_b16 v[108:109], v243 offset:18656
  ds_read_b64_tr_b16 v[110:111], v243 offset:20960
  v_mfma_f32_16x16x32_bf16 v[68:71], v[164:167], v[144:147], v[68:71]
  buffer_load_dwordx4 v241, s[12:15], s33 offen offset:2560 lds
  v_mfma_f32_16x16x32_bf16 v[72:75], v[160:163], v[148:151], v[72:75]
  ds_read_b64_tr_b16 v[112:113], v243 offset:18688
  ds_read_b64_tr_b16 v[114:115], v243 offset:20992
  v_mfma_f32_16x16x32_bf16 v[76:79], v[164:167], v[148:151], v[76:79]
  buffer_load_dwordx4 v242, s[12:15], s33 offen offset:3584 lds
  s_add_u32 s33, s33, 589824
  s_waitcnt vmcnt(19)
  s_waitcnt lgkmcnt(12)
  v_mfma_f32_16x16x32_bf16 v[8:11], v[168:171], v[80:83], v[8:11]
  ds_read_b64_tr_b16 v[116:117], v243 offset:27648
  ds_read_b64_tr_b16 v[118:119], v243 offset:29952
  v_mfma_f32_16x16x32_bf16 v[12:15], v[172:175], v[80:83], v[12:15]
  v_mfma_f32_16x16x32_bf16 v[16:19], v[168:171], v[84:87], v[16:19]
  ds_read_b64_tr_b16 v[120:121], v243 offset:27680
  ds_read_b64_tr_b16 v[122:123], v243 offset:29984
  v_mfma_f32_16x16x32_bf16 v[20:23], v[172:175], v[84:87], v[20:23]
  buffer_load_dwordx4 v[152:155], v236, s[8:11], s32 offen offset:0
  v_mfma_f32_16x16x32_bf16 v[24:27], v[168:171], v[88:91], v[24:27]
  ds_read_b64_tr_b16 v[124:125], v243 offset:27712
  ds_read_b64_tr_b16 v[126:127], v243 offset:30016
  v_mfma_f32_16x16x32_bf16 v[28:31], v[172:175], v[88:91], v[28:31]
  s_waitcnt lgkmcnt(12)
  v_mfma_f32_16x16x32_bf16 v[32:35], v[168:171], v[92:95], v[32:35]
  ds_read_b64_tr_b16 v[128:129], v243 offset:27744
  ds_read_b64_tr_b16 v[130:131], v243 offset:30048
  v_mfma_f32_16x16x32_bf16 v[36:39], v[172:175], v[92:95], v[36:39]
  buffer_load_dwordx4 v[156:159], v237, s[8:11], s32 offen offset:0
  v_mfma_f32_16x16x32_bf16 v[40:43], v[168:171], v[96:99], v[40:43]
  ds_read_b64_tr_b16 v[132:133], v243 offset:27776
  ds_read_b64_tr_b16 v[134:135], v243 offset:30080
  v_mfma_f32_16x16x32_bf16 v[44:47], v[172:175], v[96:99], v[44:47]
  v_mfma_f32_16x16x32_bf16 v[48:51], v[168:171], v[100:103], v[48:51]
  ds_read_b64_tr_b16 v[136:137], v243 offset:27808
  ds_read_b64_tr_b16 v[138:139], v243 offset:30112
  v_mfma_f32_16x16x32_bf16 v[52:55], v[172:175], v[100:103], v[52:55]
  buffer_load_dwordx4 v[160:163], v236, s[8:11], s32 offen offset:1024
  s_waitcnt lgkmcnt(12)
  v_mfma_f32_16x16x32_bf16 v[56:59], v[168:171], v[104:107], v[56:59]
  ds_read_b64_tr_b16 v[140:141], v243 offset:27840
  ds_read_b64_tr_b16 v[142:143], v243 offset:30144
  v_mfma_f32_16x16x32_bf16 v[60:63], v[172:175], v[104:107], v[60:63]
  v_mfma_f32_16x16x32_bf16 v[64:67], v[168:171], v[108:111], v[64:67]
  ds_read_b64_tr_b16 v[144:145], v243 offset:27872
  ds_read_b64_tr_b16 v[146:147], v243 offset:30176
  v_mfma_f32_16x16x32_bf16 v[68:71], v[172:175], v[108:111], v[68:71]
  buffer_load_dwordx4 v[164:167], v237, s[8:11], s32 offen offset:1024
  s_add_u32 s32, s32, 2048
  v_mfma_f32_16x16x32_bf16 v[72:75], v[168:171], v[112:115], v[72:75]
  ds_read_b64_tr_b16 v[148:149], v243 offset:27904
  ds_read_b64_tr_b16 v[150:151], v243 offset:30208
  v_mfma_f32_16x16x32_bf16 v[76:79], v[172:175], v[112:115], v[76:79]
  s_waitcnt lgkmcnt(12)
  v_mfma_f32_16x16x32_bf16 v[8:11], v[176:179], v[116:119], v[8:11]
  s_waitcnt vmcnt(13)
  s_barrier
  ds_read_b64_tr_b16 v[80:81], v244 offset:0
  ds_read_b64_tr_b16 v[82:83], v244 offset:2304
  v_mfma_f32_16x16x32_bf16 v[12:15], v[180:183], v[116:119], v[12:15]
  v_mfma_f32_16x16x32_bf16 v[16:19], v[176:179], v[120:123], v[16:19]
  ds_read_b64_tr_b16 v[84:85], v244 offset:32
  ds_read_b64_tr_b16 v[86:87], v244 offset:2336
  v_mfma_f32_16x16x32_bf16 v[20:23], v[180:183], v[120:123], v[20:23]
  s_add_u32 m0, s34, 0
  s_mov_b64 exec, s[40:41]
  buffer_load_dwordx4 v238, s[12:15], s33 offen lds
  s_mov_b64 exec, -1
  v_mfma_f32_16x16x32_bf16 v[24:27], v[176:179], v[124:127], v[24:27]
  ds_read_b64_tr_b16 v[88:89], v244 offset:64
  ds_read_b64_tr_b16 v[90:91], v244 offset:2368
  v_mfma_f32_16x16x32_bf16 v[28:31], v[180:183], v[124:127], v[28:31]
  s_waitcnt lgkmcnt(12)
  v_mfma_f32_16x16x32_bf16 v[32:35], v[176:179], v[128:131], v[32:35]
  ds_read_b64_tr_b16 v[92:93], v244 offset:96
  ds_read_b64_tr_b16 v[94:95], v244 offset:2400
  v_mfma_f32_16x16x32_bf16 v[36:39], v[180:183], v[128:131], v[36:39]
  buffer_load_dwordx4 v239, s[12:15], s33 offen offset:512 lds
  v_mfma_f32_16x16x32_bf16 v[40:43], v[176:179], v[132:135], v[40:43]
  ds_read_b64_tr_b16 v[96:97], v244 offset:128
  ds_read_b64_tr_b16 v[98:99], v244 offset:2432
  v_mfma_f32_16x16x32_bf16 v[44:47], v[180:183], v[132:135], v[44:47]
  v_mfma_f32_16x16x32_bf16 v[48:51], v[176:179], v[136:139], v[48:51]
  ds_read_b64_tr_b16 v[100:101], v244 offset:160
  ds_read_b64_tr_b16 v[102:103], v244 offset:2464
  v_mfma_f32_16x16x32_bf16 v[52:55], v[180:183], v[136:139], v[52:55]
  buffer_load_dwordx4 v240, s[12:15], s33 offen offset:1536 lds
  s_waitcnt lgkmcnt(12)
  v_mfma_f32_16x16x32_bf16 v[56:59], v[176:179], v[140:143], v[56:59]
  ds_read_b64_tr_b16 v[104:105], v244 offset:192
  ds_read_b64_tr_b16 v[106:107], v244 offset:2496
  v_mfma_f32_16x16x32_bf16 v[60:63], v[180:183], v[140:143], v[60:63]
  v_mfma_f32_16x16x32_bf16 v[64:67], v[176:179], v[144:147], v[64:67]
  ds_read_b64_tr_b16 v[108:109], v244 offset:224
  ds_read_b64_tr_b16 v[110:111], v244 offset:2528
  v_mfma_f32_16x16x32_bf16 v[68:71], v[180:183], v[144:147], v[68:71]
  buffer_load_dwordx4 v241, s[12:15], s33 offen offset:2560 lds
  v_mfma_f32_16x16x32_bf16 v[72:75], v[176:179], v[148:151], v[72:75]
  ds_read_b64_tr_b16 v[112:113], v244 offset:256
  ds_read_b64_tr_b16 v[114:115], v244 offset:2560
  v_mfma_f32_16x16x32_bf16 v[76:79], v[180:183], v[148:151], v[76:79]
  buffer_load_dwordx4 v242, s[12:15], s33 offen offset:3584 lds
  s_add_u32 s33, s33, 589824
  s_waitcnt vmcnt(14)
  s_waitcnt lgkmcnt(12)
  v_mfma_f32_16x16x32_bf16 v[8:11], v[184:187], v[80:83], v[8:11]
  ds_read_b64_tr_b16 v[116:117], v244 offset:9216
  ds_read_b64_tr_b16 v[118:119], v244 offset:11520
  v_mfma_f32_16x16x32_bf16 v[12:15], v[188:191], v[80:83], v[12:15]
  v_mfma_f32_16x16x32_bf16 v[16:19], v[184:187], v[84:87], v[16:19]
  ds_read_b64_tr_b16 v[120:121], v244 offset:9248
  ds_read_b64_tr_b16 v[122:123], v244 offset:11552
  v_mfma_f32_16x16x32_bf16 v[20:23], v[188:191], v[84:87], v[20:23]
  buffer_load_dwordx4 v[168:171], v236, s[8:11], s32 offen offset:0
  v_mfma_f32_16x16x32_bf16 v[24:27], v[184:187], v[88:91], v[24:27]
  ds_read_b64_tr_b16 v[124:125], v244 offset:9280
  ds_read_b64_tr_b16 v[126:127], v244 offset:11584
  v_mfma_f32_16x16x32_bf16 v[28:31], v[188:191], v[88:91], v[28:31]
  s_waitcnt lgkmcnt(12)
  v_mfma_f32_16x16x32_bf16 v[32:35], v[184:187], v[92:95], v[32:35]
  ds_read_b64_tr_b16 v[128:129], v244 offset:9312
  ds_read_b64_tr_b16 v[130:131], v244 offset:11616
  v_mfma_f32_16x16x32_bf16 v[36:39], v[188:191], v[92:95], v[36:39]
  buffer_load_dwordx4 v[172:175], v237, s[8:11], s32 offen offset:0
  v_mfma_f32_16x16x32_bf16 v[40:43], v[184:187], v[96:99], v[40:43]
  ds_read_b64_tr_b16 v[132:133], v244 offset:9344
  ds_read_b64_tr_b16 v[134:135], v244 offset:11648
  v_mfma_f32_16x16x32_bf16 v[44:47], v[188:191], v[96:99], v[44:47]
  v_mfma_f32_16x16x32_bf16 v[48:51], v[184:187], v[100:103], v[48:51]
  ds_read_b64_tr_b16 v[136:137], v244 offset:9376
  ds_read_b64_tr_b16 v[138:139], v244 offset:11680
  v_mfma_f32_16x16x32_bf16 v[52:55], v[188:191], v[100:103], v[52:55]
  buffer_load_dwordx4 v[176:179], v236, s[8:11], s32 offen offset:1024
  s_waitcnt lgkmcnt(12)
  v_mfma_f32_16x16x32_bf16 v[56:59], v[184:187], v[104:107], v[56:59]
  ds_read_b64_tr_b16 v[140:141], v244 offset:9408
  ds_read_b64_tr_b16 v[142:143], v244 offset:11712
  v_mfma_f32_16x16x32_bf16 v[60:63], v[188:191], v[104:107], v[60:63]
  v_mfma_f32_16x16x32_bf16 v[64:67], v[184:187], v[108:111], v[64:67]
  ds_read_b64_tr_b16 v[144:145], v244 offset:9440
  ds_read_b64_tr_b16 v[146:147], v244 offset:11744
  v_mfma_f32_16x16x32_bf16 v[68:71], v[188:191], v[108:111], v[68:71]
  buffer_load_dwordx4 v[180:183], v237, s[8:11], s32 offen offset:1024
  s_add_u32 s32, s32, 2048
  v_mfma_f32_16x16x32_bf16 v[72:75], v[184:187], v[112:115], v[72:75]
  ds_read_b64_tr_b16 v[148:149], v244 offset:9472
  ds_read_b64_tr_b16 v[150:151], v244 offset:11776
  v_mfma_f32_16x16x32_bf16 v[76:79], v[188:191], v[112:115], v[76:79]
  s_waitcnt lgkmcnt(12)
  v_mfma_f32_16x16x32_bf16 v[8:11], v[192:195], v[116:119], v[8:11]
  s_waitcnt vmcnt(13)
  s_barrier
  ds_read_b64_tr_b16 v[80:81], v244 offset:18432
  ds_read_b64_tr_b16 v[82:83], v244 offset:20736
  v_mfma_f32_16x16x32_bf16 v[12:15], v[196:199], v[116:119], v[12:15]
  v_mfma_f32_16x16x32_bf16 v[16:19], v[192:195], v[120:123], v[16:19]
  ds_read_b64_tr_b16 v[84:85], v244 offset:18464
  ds_read_b64_tr_b16 v[86:87], v244 offset:20768
  v_mfma_f32_16x16x32_bf16 v[20:23], v[196:199], v[120:123], v[20:23]
  s_add_u32 m0, s34, 18432
  s_mov_b64 exec, s[40:41]
  buffer_load_dwordx4 v238, s[12:15], s33 offen lds
  s_mov_b64 exec, -1
  v_mfma_f32_16x16x32_bf16 v[24:27], v[192:195], v[124:127], v[24:27]
  ds_read_b64_tr_b16 v[88:89], v244 offset:18496
  ds_read_b64_tr_b16 v[90:91], v244 offset:20800
  v_mfma_f32_16x16x32_bf16 v[28:31], v[196:199], v[124:127], v[28:31]
  s_waitcnt lgkmcnt(12)
  v_mfma_f32_16x16x32_bf16 v[32:35], v[192:195], v[128:131], v[32:35]
  ds_read_b64_tr_b16 v[92:93], v244 offset:18528
  ds_read_b64_tr_b16 v[94:95], v244 offset:20832
  v_mfma_f32_16x16x32_bf16 v[36:39], v[196:199], v[128:131], v[36:39]
  buffer_load_dwordx4 v239, s[12:15], s33 offen offset:512 lds
  v_mfma_f32_16x16x32_bf16 v[40:43], v[192:195], v[132:135], v[40:43]
  ds_read_b64_tr_b16 v[96:97], v244 offset:18560
  ds_read_b64_tr_b16 v[98:99], v244 offset:20864
  v_mfma_f32_16x16x32_bf16 v[44:47], v[196:199], v[132:135], v[44:47]
  v_mfma_f32_16x16x32_bf16 v[48:51], v[192:195], v[136:139], v[48:51]
  ds_read_b64_tr_b16 v[100:101], v244 offset:18592
  ds_read_b64_tr_b16 v[102:103], v244 offset:20896
  v_mfma_f32_16x16x32_bf16 v[52:55], v[196:199], v[136:139], v[52:55]
  buffer_load_dwordx4 v240, s[12:15], s33 offen offset:1536 lds
  s_waitcnt lgkmcnt(12)
  v_mfma_f32_16x16x32_bf16 v[56:59], v[192:195], v[140:143], v[56:59]
  ds_read_b64_tr_b16 v[104:105], v244 offset:18624
  ds_read_b64_tr_b16 v[106:107], v244 offset:20928
  v_mfma_f32_16x16x32_bf16 v[60:63], v[196:199], v[140:143], v[60:63]
  v_mfma_f32_16x16x32_bf16 v[64:67], v[192:195], v[144:147], v[64:67]
  ds_read_b64_tr_b16 v[108:109], v244 offset:18656
  ds_read_b64_tr_b16 v[110:111], v244 offset:20960
  v_mfma_f32_16x16x32_bf16 v[68:71], v[196:199], v[144:147], v[68:71]
  buffer_load_dwordx4 v241, s[12:15], s33 offen offset:2560 lds
  v_mfma_f32_16x16x32_bf16 v[72:75], v[192:195], v[148:151], v[72:75]
  ds_read_b64_tr_b16 v[112:113], v244 offset:18688
  ds_read_b64_tr_b16 v[114:115], v244 offset:20992
  v_mfma_f32_16x16x32_bf16 v[76:79], v[196:199], v[148:151], v[76:79]
  buffer_load_dwordx4 v242, s[12:15], s33 offen offset:3584 lds
  s_add_u32 s33, s33, 589824
  s_waitcnt vmcnt(14)
  s_waitcnt lgkmcnt(12)
  v_mfma_f32_16x16x32_bf16 v[8:11], v[152:155], v[80:83], v[8:11]
  ds_read_b64_tr_b16 v[116:117], v244 offset:27648
  ds_read_b64_tr_b16 v[118:119], v244 offset:29952
  v_mfma_f32_16x16x32_bf16 v[12:15], v[156:159], v[80:83], v[12:15]
  v_mfma_f32_16x16x32_bf16 v[16:19], v[152:155], v[84:87], v[16:19]
  ds_read_b64_tr_b16 v[120:121], v244 offset:27680
  ds_read_b64_tr_b16 v[122:123], v244 offset:29984
  v_mfma_f32_16x16x32_bf16 v[20:23], v[156:159], v[84:87], v[20:23]
  buffer_load_dwordx4 v[184:187], v236, s[8:11], s32 offen offset:0
  v_mfma_f32_16x16x32_bf16 v[24:27], v[152:155], v[88:91], v[24:27]
  ds_read_b64_tr_b16 v[124:125], v244 offset:27712
  ds_read_b64_tr_b16 v[126:127], v244 offset:30016
  v_mfma_f32_16x16x32_bf16 v[28:31], v[156:159], v[88:91], v[28:31]
  s_waitcnt lgkmcnt(12)
  v_mfma_f32_16x16x32_bf16 v[32:35], v[152:155], v[92:95], v[32:35]
  ds_read_b64_tr_b16 v[128:129], v244 offset:27744
  ds_read_b64_tr_b16 v[130:131], v244 offset:30048
  v_mfma_f32_16x16x32_bf16 v[36:39], v[156:159], v[92:95], v[36:39]
  buffer_load_dwordx4 v[188:191], v237, s[8:11], s32 offen offset:0
  v_mfma_f32_16x16x32_bf16 v[40:43], v[152:155], v[96:99], v[40:43]
  ds_read_b64_tr_b16 v[132:133], v244 offset:27776
  ds_read_b64_tr_b16 v[134:135], v244 offset:30080
  v_mfma_f32_16x16x32_bf16 v[44:47], v[156:159], v[96:99], v[44:47]
  v_mfma_f32_16x16x32_bf16 v[48:51], v[152:155], v[100:103], v[48:51]
  ds_read_b64_tr_b16 v[136:137], v244 offset:27808
  ds_read_b64_tr_b16 v[138:139], v244 offset:30112
  v_mfma_f32_16x16x32_bf16 v[52:55], v[156:159], v[100:103], v[52:55]
  buffer_load_dwordx4 v[192:195], v236, s[8:11], s32 offen offset:1024
  s_waitcnt lgkmcnt(12)
  v_mfma_f32_16x16x32_bf16 v[56:59], v[152:155], v[104:107], v[56:59]
  ds_read_b64_tr_b16 v[140:141], v244 offset:27840
  ds_read_b64_tr_b16 v[142:143], v244 offset:30144
  v_mfma_f32_16x16x32_bf16 v[60:63], v[156:159], v[104:107], v[60:63]
  v_mfma_f32_16x16x32_bf16 v[64:67], v[152:155], v[108:111], v[64:67]
  ds_read_b64_tr_b16 v[144:145], v244 offset:27872
  ds_read_b64_tr_b16 v[146:147], v244 offset:30176
  v_mfma_f32_16x16x32_bf16 v[68:71], v[156:159], v[108:111], v[68:71]
  buffer_load_dwordx4 v[196:199], v237, s[8:11], s32 offen offset:1024
  s_add_u32 s32, s32, 2048
  v_mfma_f32_16x16x32_bf16 v[72:75], v[152:155], v[112:115], v[72:75]
  ds_read_b64_tr_b16 v[148:149], v244 offset:27904
  ds_read_b64_tr_b16 v[150:151], v244 offset:30208
  v_mfma_f32_16x16x32_bf16 v[76:79], v[156:159], v[112:115], v[76:79]
  s_waitcnt lgkmcnt(12)
  v_mfma_f32_16x16x32_bf16 v[8:11], v[160:163], v[116:119], v[8:11]
  s_waitcnt vmcnt(13)
  s_barrier
  ds_read_b64_tr_b16 v[80:81], v243 offset:0
  ds_read_b64_tr_b16 v[82:83], v243 offset:2304
  v_mfma_f32_16x16x32_bf16 v[12:15], v[164:167], v[116:119], v[12:15]
  v_mfma_f32_16x16x32_bf16 v[16:19], v[160:163], v[120:123], v[16:19]
  ds_read_b64_tr_b16 v[84:85], v243 offset:32
  ds_read_b64_tr_b16 v[86:87], v243 offset:2336
  v_mfma_f32_16x16x32_bf16 v[20:23], v[164:167], v[120:123], v[20:23]
  s_add_u32 m0, s34, 36864
  s_mov_b64 exec, s[40:41]
  buffer_load_dwordx4 v238, s[12:15], s33 offen lds
  s_mov_b64 exec, -1
  v_mfma_f32_16x16x32_bf16 v[24:27], v[160:163], v[124:127], v[24:27]
  ds_read_b64_tr_b16 v[88:89], v243 offset:64
  ds_read_b64_tr_b16 v[90:91], v243 offset:2368
  v_mfma_f32_16x16x32_bf16 v[28:31], v[164:167], v[124:127], v[28:31]
  s_waitcnt lgkmcnt(12)
  v_mfma_f32_16x16x32_bf16 v[32:35], v[160:163], v[128:131], v[32:35]
  ds_read_b64_tr_b16 v[92:93], v243 offset:96
  ds_read_b64_tr_b16 v[94:95], v243 offset:2400
  v_mfma_f32_16x16x32_bf16 v[36:39], v[164:167], v[128:131], v[36:39]
  buffer_load_dwordx4 v239, s[12:15], s33 offen offset:512 lds
  v_mfma_f32_16x16x32_bf16 v[40:43], v[160:163], v[132:135], v[40:43]
  ds_read_b64_tr_b16 v[96:97], v243 offset:128
  ds_read_b64_tr_b16 v[98:99], v243 offset:2432
  v_mfma_f32_16x16x32_bf16 v[44:47], v[164:167], v[132:135], v[44:47]
  v_mfma_f32_16x16x32_bf16 v[48:51], v[160:163], v[136:139], v[48:51]
  ds_read_b64_tr_b16 v[100:101], v243 offset:160
  ds_read_b64_tr_b16 v[102:103], v243 offset:2464
  v_mfma_f32_16x16x32_bf16 v[52:55], v[164:167], v[136:139], v[52:55]
  buffer_load_dwordx4 v240, s[12:15], s33 offen offset:1536 lds
  s_waitcnt lgkmcnt(12)
  v_mfma_f32_16x16x32_bf16 v[56:59], v[160:163], v[140:143], v[56:59]
  ds_read_b64_tr_b16 v[104:105], v243 offset:192
  ds_read_b64_tr_b16 v[106:107], v243 offset:2496
  v_mfma_f32_16x16x32_bf16 v[60:63], v[164:167], v[140:143], v[60:63]
  v_mfma_f32_16x16x32_bf16 v[64:67], v[160:163], v[144:147], v[64:67]
  ds_read_b64_tr_b16 v[108:109], v243 offset:224
  ds_read_b64_tr_b16 v[110:111], v243 offset:2528
  v_mfma_f32_16x16x32_bf16 v[68:71], v[164:167], v[144:147], v[68:71]
  buffer_load_dwordx4 v241, s[12:15], s33 offen offset:2560 lds
  v_mfma_f32_16x16x32_bf16 v[72:75], v[160:163], v[148:151], v[72:75]
  ds_read_b64_tr_b16 v[112:113], v243 offset:256
  ds_read_b64_tr_b16 v[114:115], v243 offset:2560
  v_mfma_f32_16x16x32_bf16 v[76:79], v[164:167], v[148:151], v[76:79]
  buffer_load_dwordx4 v242, s[12:15], s33 offen offset:3584 lds
  s_add_u32 s33, s33, 589824
  s_waitcnt vmcnt(14)
  s_waitcnt lgkmcnt(12)
  v_mfma_f32_16x16x32_bf16 v[8:11], v[168:171], v[80:83], v[8:11]
  ds_read_b64_tr_b16 v[116:117], v243 offset:9216
  ds_read_b64_tr_b16 v[118:119], v243 offset:11520
  v_mfma_f32_16x16x32_bf16 v[12:15], v[172:175], v[80:83], v[12:15]
  v_mfma_f32_16x16x32_bf16 v[16:19], v[168:171], v[84:87], v[16:19]
  ds_read_b64_tr_b16 v[120:121], v243 offset:9248
  ds_read_b64_tr_b16 v[122:123], v243 offset:11552
  v_mfma_f32_16x16x32_bf16 v[20:23], v[172:175], v[84:87], v[20:23]
  buffer_load_dwordx4 v[152:155], v236, s[8:11], s32 offen offset:0
  v_mfma_f32_16x16x32_bf16 v[24:27], v[168:171], v[88:91], v[24:27]
  ds_read_b64_tr_b16 v[124:125], v243 offset:9280
  ds_read_b64_tr_b16 v[126:127], v243 offset:11584
  v_mfma_f32_16x16x32_bf16 v[28:31], v[172:175], v[88:91], v[28:31]
  s_waitcnt lgkmcnt(12)
  v_mfma_f32_16x16x32_bf16 v[32:35], v[168:171], v[92:95], v[32:35]
  ds_read_b64_tr_b16 v[128:129], v243 offset:9312
  ds_read_b64_tr_b16 v[130:131], v243 offset:11616
  v_mfma_f32_16x16x32_bf16 v[36:39], v[172:175], v[92:95], v[36:39]
  buffer_load_dwordx4 v[156:159], v237, s[8:11], s32 offen offset:0
  v_mfma_f32_16x16x32_bf16 v[40:43], v[168:171], v[96:99], v[40:43]
  ds_read_b64_tr_b16 v[132:133], v243 offset:9344
  ds_read_b64_tr_b16 v[134:135], v243 offset:11648
  v_mfma_f32_16x16x32_bf16 v[44:47], v[172:175], v[96:99], v[44:47]
  v_mfma_f32_16x16x32_bf16 v[48:51], v[168:171], v[100:103], v[48:51]
  ds_read_b64_tr_b16 v[136:137], v243 offset:9376
  ds_read_b64_tr_b16 v[138:139], v243 offset:11680
  v_mfma_f32_16x16x32_bf16 v[52:55], v[172:175], v[100:103], v[52:55]
  buffer_load_dwordx4 v[160:163], v236, s[8:11], s32 offen offset:1024
  s_waitcnt lgkmcnt(12)
  v_mfma_f32_16x16x32_bf16 v[56:59], v[168:171], v[104:107], v[56:59]
  ds_read_b64_tr_b16 v[140:141], v243 offset:9408
  ds_read_b64_tr_b16 v[142:143], v243 offset:11712
  v_mfma_f32_16x16x32_bf16 v[60:63], v[172:175], v[104:107], v[60:63]
  v_mfma_f32_16x16x32_bf16 v[64:67], v[168:171], v[108:111], v[64:67]
  ds_read_b64_tr_b16 v[144:145], v243 offset:9440
  ds_read_b64_tr_b16 v[146:147], v243 offset:11744
  v_mfma_f32_16x16x32_bf16 v[68:71], v[172:175], v[108:111], v[68:71]
  buffer_load_dwordx4 v[164:167], v237, s[8:11], s32 offen offset:1024
  s_add_u32 s32, s32, 2048
  v_mfma_f32_16x16x32_bf16 v[72:75], v[168:171], v[112:115], v[72:75]
  ds_read_b64_tr_b16 v[148:149], v243 offset:9472
  ds_read_b64_tr_b16 v[150:151], v243 offset:11776
  v_mfma_f32_16x16x32_bf16 v[76:79], v[172:175], v[112:115], v[76:79]
  s_waitcnt lgkmcnt(12)
  v_mfma_f32_16x16x32_bf16 v[8:11], v[176:179], v[116:119], v[8:11]
  s_waitcnt vmcnt(13)
  s_barrier
  ds_read_b64_tr_b16 v[80:81], v243 offset:18432
  ds_read_b64_tr_b16 v[82:83], v243 offset:20736
  v_mfma_f32_16x16x32_bf16 v[12:15], v[180:183], v[116:119], v[12:15]
  v_mfma_f32_16x16x32_bf16 v[16:19], v[176:179], v[120:123], v[16:19]
  ds_read_b64_tr_b16 v[84:85], v243 offset:18464
  ds_read_b64_tr_b16 v[86:87], v243 offset:20768
  v_mfma_f32_16x16x32_bf16 v[20:23], v[180:183], v[120:123], v[20:23]
  s_add_u32 m0, s34, 55296
  s_mov_b64 exec, s[40:41]
  buffer_load_dwordx4 v238, s[12:15], s33 offen lds
  s_mov_b64 exec, -1
  v_mfma_f32_16x16x32_bf16 v[24:27], v[176:179], v[124:127], v[24:27]
  ds_read_b64_tr_b16 v[88:89], v243 offset:18496
  ds_read_b64_tr_b16 v[90:91], v243 offset:20800
  v_mfma_f32_16x16x32_bf16 v[28:31], v[180:183], v[124:127], v[28:31]
  s_waitcnt lgkmcnt(12)
  v_mfma_f32_16x16x32_bf16 v[32:35], v[176:179], v[128:131], v[32:35]
  ds_read_b64_tr_b16 v[92:93], v243 offset:18528
  ds_read_b64_tr_b16 v[94:95], v243 offset:20832
  v_mfma_f32_16x16x32_bf16 v[36:39], v[180:183], v[128:131], v[36:39]
  buffer_load_dwordx4 v239, s[12:15], s33 offen offset:512 lds
  v_mfma_f32_16x16x32_bf16 v[40:43], v[176:179], v[132:135], v[40:43]
  ds_read_b64_tr_b16 v[96:97], v243 offset:18560
  ds_read_b64_tr_b16 v[98:99], v243 offset:20864
  v_mfma_f32_16x16x32_bf16 v[44:47], v[180:183], v[132:135], v[44:47]
  v_mfma_f32_16x16x32_bf16 v[48:51], v[176:179], v[136:139], v[48:51]
  ds_read_b64_tr_b16 v[100:101], v243 offset:18592
  ds_read_b64_tr_b16 v[102:103], v243 offset:20896
  v_mfma_f32_16x16x32_bf16 v[52:55], v[180:183], v[136:139], v[52:55]
  buffer_load_dwordx4 v240, s[12:15], s33 offen offset:1536 lds
  s_waitcnt lgkmcnt(12)
  v_mfma_f32_16x16x32_bf16 v[56:59], v[176:179], v[140:143], v[56:59]
  ds_read_b64_tr_b16 v[104:105], v243 offset:18624
  ds_read_b64_tr_b16 v[106:107], v243 offset:20928
  v_mfma_f32_16x16x32_bf16 v[60:63], v[180:183], v[140:143], v[60:63]
  v_mfma_f32_16x16x32_bf16 v[64:67], v[176:179], v[144:147], v[64:67]
  ds_read_b64_tr_b16 v[108:109], v243 offset:18656
  ds_read_b64_tr_b16 v[110:111], v243 offset:20960
  v_mfma_f32_16x16x32_bf16 v[68:71], v[180:183], v[144:147], v[68:71]
  buffer_load_dwordx4 v241, s[12:15], s33 offen offset:2560 lds
  v_mfma_f32_16x16x32_bf16 v[72:75], v[176:179], v[148:151], v[72:75]
  ds_read_b64_tr_b16 v[112:113], v243 offset:18688
  ds_read_b64_tr_b16 v[114:115], v243 offset:20992
  v_mfma_f32_16x16x32_bf16 v[76:79], v[180:183], v[148:151], v[76:79]
  buffer_load_dwordx4 v242, s[12:15], s33 offen offset:3584 lds
  s_add_u32 s33, s33, 589824
  s_waitcnt vmcnt(14)
  s_waitcnt lgkmcnt(12)
  v_mfma_f32_16x16x32_bf16 v[8:11], v[184:187], v[80:83], v[8:11]
  ds_read_b64_tr_b16 v[116:117], v243 offset:27648
  ds_read_b64_tr_b16 v[118:119], v243 offset:29952
  v_mfma_f32_16x16x32_bf16 v[12:15], v[188:191], v[80:83], v[12:15]
  v_mfma_f32_16x16x32_bf16 v[16:19], v[184:187], v[84:87], v[16:19]
  ds_read_b64_tr_b16 v[120:121], v243 offset:27680
  ds_read_b64_tr_b16 v[122:123], v243 offset:29984
  v_mfma_f32_16x16x32_bf16 v[20:23], v[188:191], v[84:87], v[20:23]
  buffer_load_dwordx4 v[168:171], v236, s[8:11], s32 offen offset:0
  v_mfma_f32_16x16x32_bf16 v[24:27], v[184:187], v[88:91], v[24:27]
  ds_read_b64_tr_b16 v[124:125], v243 offset:27712
  ds_read_b64_tr_b16 v[126:127], v243 offset:30016
  v_mfma_f32_16x16x32_bf16 v[28:31], v[188:191], v[88:91], v[28:31]
  s_waitcnt lgkmcnt(12)
  v_mfma_f32_16x16x32_bf16 v[32:35], v[184:187], v[92:95], v[32:35]
  ds_read_b64_tr_b16 v[128:129], v243 offset:27744
  ds_read_b64_tr_b16 v[130:131], v243 offset:30048
  v_mfma_f32_16x16x32_bf16 v[36:39], v[188:191], v[92:95], v[36:39]
  buffer_load_dwordx4 v[172:175], v237, s[8:11], s32 offen offset:0
  v_mfma_f32_16x16x32_bf16 v[40:43], v[184:187], v[96:99], v[40:43]
  ds_read_b64_tr_b16 v[132:133], v243 offset:27776
  ds_read_b64_tr_b16 v[134:135], v243 offset:30080
  v_mfma_f32_16x16x32_bf16 v[44:47], v[188:191], v[96:99], v[44:47]
  v_mfma_f32_16x16x32_bf16 v[48:51], v[184:187], v[100:103], v[48:51]
  ds_read_b64_tr_b16 v[136:137], v243 offset:27808
  ds_read_b64_tr_b16 v[138:139], v243 offset:30112
  v_mfma_f32_16x16x32_bf16 v[52:55], v[188:191], v[100:103], v[52:55]
  buffer_load_dwordx4 v[176:179], v236, s[8:11], s32 offen offset:1024
  s_waitcnt lgkmcnt(12)
  v_mfma_f32_16x16x32_bf16 v[56:59], v[184:187], v[104:107], v[56:59]
  ds_read_b64_tr_b16 v[140:141], v243 offset:27840
  ds_read_b64_tr_b16 v[142:143], v243 offset:30144
  v_mfma_f32_16x16x32_bf16 v[60:63], v[188:191], v[104:107], v[60:63]
  v_mfma_f32_16x16x32_bf16 v[64:67], v[184:187], v[108:111], v[64:67]
  ds_read_b64_tr_b16 v[144:145], v243 offset:27872
  ds_read_b64_tr_b16 v[146:147], v243 offset:30176
  v_mfma_f32_16x16x32_bf16 v[68:71], v[188:191], v[108:111], v[68:71]
  buffer_load_dwordx4 v[180:183], v237, s[8:11], s32 offen offset:1024
  s_add_u32 s32, s32, 2048
  v_mfma_f32_16x16x32_bf16 v[72:75], v[184:187], v[112:115], v[72:75]
  ds_read_b64_tr_b16 v[148:149], v243 offset:27904
  ds_read_b64_tr_b16 v[150:151], v243 offset:30208
  v_mfma_f32_16x16x32_bf16 v[76:79], v[188:191], v[112:115], v[76:79]
  s_waitcnt lgkmcnt(12)
  v_mfma_f32_16x16x32_bf16 v[8:11], v[192:195], v[116:119], v[8:11]
  s_waitcnt vmcnt(13)
  s_barrier
  ds_read_b64_tr_b16 v[80:81], v244 offset:0
  ds_read_b64_tr_b16 v[82:83], v244 offset:2304
  v_mfma_f32_16x16x32_bf16 v[12:15], v[196:199], v[116:119], v[12:15]
  v_mfma_f32_16x16x32_bf16 v[16:19], v[192:195], v[120:123], v[16:19]
  ds_read_b64_tr_b16 v[84:85], v244 offset:32
  ds_read_b64_tr_b16 v[86:87], v244 offset:2336
  v_mfma_f32_16x16x32_bf16 v[20:23], v[196:199], v[120:123], v[20:23]
  s_add_u32 m0, s34, 0
  s_mov_b64 exec, s[40:41]
  buffer_load_dwordx4 v238, s[12:15], s33 offen lds
  s_mov_b64 exec, -1
  v_mfma_f32_16x16x32_bf16 v[24:27], v[192:195], v[124:127], v[24:27]
  ds_read_b64_tr_b16 v[88:89], v244 offset:64
  ds_read_b64_tr_b16 v[90:91], v244 offset:2368
  v_mfma_f32_16x16x32_bf16 v[28:31], v[196:199], v[124:127], v[28:31]
  s_waitcnt lgkmcnt(12)
  v_mfma_f32_16x16x32_bf16 v[32:35], v[192:195], v[128:131], v[32:35]
  ds_read_b64_tr_b16 v[92:93], v244 offset:96
  ds_read_b64_tr_b16 v[94:95], v244 offset:2400
  v_mfma_f32_16x16x32_bf16 v[36:39], v[196:199], v[128:131], v[36:39]
  buffer_load_dwordx4 v239, s[12:15], s33 offen offset:512 lds
  v_mfma_f32_16x16x32_bf16 v[40:43], v[192:195], v[132:135], v[40:43]
  ds_read_b64_tr_b16 v[96:97], v244 offset:128
  ds_read_b64_tr_b16 v[98:99], v244 offset:2432
  v_mfma_f32_16x16x32_bf16 v[44:47], v[196:199], v[132:135], v[44:47]
  v_mfma_f32_16x16x32_bf16 v[48:51], v[192:195], v[136:139], v[48:51]
  ds_read_b64_tr_b16 v[100:101], v244 offset:160
  ds_read_b64_tr_b16 v[102:103], v244 offset:2464
  v_mfma_f32_16x16x32_bf16 v[52:55], v[196:199], v[136:139], v[52:55]
  buffer_load_dwordx4 v240, s[12:15], s33 offen offset:1536 lds
  s_waitcnt lgkmcnt(12)
  v_mfma_f32_16x16x32_bf16 v[56:59], v[192:195], v[140:143], v[56:59]
  ds_read_b64_tr_b16 v[104:105], v244 offset:192
  ds_read_b64_tr_b16 v[106:107], v244 offset:2496
  v_mfma_f32_16x16x32_bf16 v[60:63], v[196:199], v[140:143], v[60:63]
  v_mfma_f32_16x16x32_bf16 v[64:67], v[192:195], v[144:147], v[64:67]
  ds_read_b64_tr_b16 v[108:109], v244 offset:224
  ds_read_b64_tr_b16 v[110:111], v244 offset:2528
  v_mfma_f32_16x16x32_bf16 v[68:71], v[196:199], v[144:147], v[68:71]
  buffer_load_dwordx4 v241, s[12:15], s33 offen offset:2560 lds
  v_mfma_f32_16x16x32_bf16 v[72:75], v[192:195], v[148:151], v[72:75]
  ds_read_b64_tr_b16 v[112:113], v244 offset:256
  ds_read_b64_tr_b16 v[114:115], v244 offset:2560
  v_mfma_f32_16x16x32_bf16 v[76:79], v[196:199], v[148:151], v[76:79]
  buffer_load_dwordx4 v242, s[12:15], s33 offen offset:3584 lds
  s_add_u32 s33, s33, 589824
  s_waitcnt vmcnt(14)
  s_waitcnt lgkmcnt(12)
  v_mfma_f32_16x16x32_bf16 v[8:11], v[152:155], v[80:83], v[8:11]
  ds_read_b64_tr_b16 v[116:117], v244 offset:9216
  ds_read_b64_tr_b16 v[118:119], v244 offset:11520
  v_mfma_f32_16x16x32_bf16 v[12:15], v[156:159], v[80:83], v[12:15]
  v_mfma_f32_16x16x32_bf16 v[16:19], v[152:155], v[84:87], v[16:19]
  ds_read_b64_tr_b16 v[120:121], v244 offset:9248
  ds_read_b64_tr_b16 v[122:123], v244 offset:11552
  v_mfma_f32_16x16x32_bf16 v[20:23], v[156:159], v[84:87], v[20:23]
  buffer_load_dwordx4 v[184:187], v236, s[8:11], s32 offen offset:0
  v_mfma_f32_16x16x32_bf16 v[24:27], v[152:155], v[88:91], v[24:27]
  ds_read_b64_tr_b16 v[124:125], v244 offset:9280
  ds_read_b64_tr_b16 v[126:127], v244 offset:11584
  v_mfma_f32_16x16x32_bf16 v[28:31], v[156:159], v[88:91], v[28:31]
  s_waitcnt lgkmcnt(12)
  v_mfma_f32_16x16x32_bf16 v[32:35], v[152:155], v[92:95], v[32:35]
  ds_read_b64_tr_b16 v[128:129], v244 offset:9312
  ds_read_b64_tr_b16 v[130:131], v244 offset:11616
  v_mfma_f32_16x16x32_bf16 v[36:39], v[156:159], v[92:95], v[36:39]
  buffer_load_dwordx4 v[188:191], v237, s[8:11], s32 offen offset:0
  v_mfma_f32_16x16x32_bf16 v[40:43], v[152:155], v[96:99], v[40:43]
  ds_read_b64_tr_b16 v[132:133], v244 offset:9344
  ds_read_b64_tr_b16 v[134:135], v244 offset:11648
  v_mfma_f32_16x16x32_bf16 v[44:47], v[156:159], v[96:99], v[44:47]
  v_mfma_f32_16x16x32_bf16 v[48:51], v[152:155], v[100:103], v[48:51]
  ds_read_b64_tr_b16 v[136:137], v244 offset:9376
  ds_read_b64_tr_b16 v[138:139], v244 offset:11680
  v_mfma_f32_16x16x32_bf16 v[52:55], v[156:159], v[100:103], v[52:55]
  buffer_load_dwordx4 v[192:195], v236, s[8:11], s32 offen offset:1024
  s_waitcnt lgkmcnt(12)
  v_mfma_f32_16x16x32_bf16 v[56:59], v[152:155], v[104:107], v[56:59]
  ds_read_b64_tr_b16 v[140:141], v244 offset:9408
  ds_read_b64_tr_b16 v[142:143], v244 offset:11712
  v_mfma_f32_16x16x32_bf16 v[60:63], v[156:159], v[104:107], v[60:63]
  v_mfma_f32_16x16x32_bf16 v[64:67], v[152:155], v[108:111], v[64:67]
  ds_read_b64_tr_b16 v[144:145], v244 offset:9440
  ds_read_b64_tr_b16 v[146:147], v244 offset:11744
  v_mfma_f32_16x16x32_bf16 v[68:71], v[156:159], v[108:111], v[68:71]
  buffer_load_dwordx4 v[196:199], v237, s[8:11], s32 offen offset:1024
  s_add_u32 s32, s32, 2048
  v_mfma_f32_16x16x32_bf16 v[72:75], v[152:155], v[112:115], v[72:75]
  ds_read_b64_tr_b16 v[148:149], v244 offset:9472
  ds_read_b64_tr_b16 v[150:151], v244 offset:11776
  v_mfma_f32_16x16x32_bf16 v[76:79], v[156:159], v[112:115], v[76:79]
  s_waitcnt lgkmcnt(12)
  v_mfma_f32_16x16x32_bf16 v[8:11], v[160:163], v[116:119], v[8:11]
  s_waitcnt vmcnt(13)
  s_barrier
  ds_read_b64_tr_b16 v[80:81], v244 offset:18432
  ds_read_b64_tr_b16 v[82:83], v244 offset:20736
  v_mfma_f32_16x16x32_bf16 v[12:15], v[164:167], v[116:119], v[12:15]
  v_mfma_f32_16x16x32_bf16 v[16:19], v[160:163], v[120:123], v[16:19]
  ds_read_b64_tr_b16 v[84:85], v244 offset:18464
  ds_read_b64_tr_b16 v[86:87], v244 offset:20768
  v_mfma_f32_16x16x32_bf16 v[20:23], v[164:167], v[120:123], v[20:23]
  v_mfma_f32_16x16x32_bf16 v[24:27], v[160:163], v[124:127], v[24:27]
  ds_read_b64_tr_b16 v[88:89], v244 offset:18496
  ds_read_b64_tr_b16 v[90:91], v244 offset:20800
  v_mfma_f32_16x16x32_bf16 v[28:31], v[164:167], v[124:127], v[28:31]
  s_waitcnt lgkmcnt(12)
  v_mfma_f32_16x16x32_bf16 v[32:35], v[160:163], v[128:131], v[32:35]
  ds_read_b64_tr_b16 v[92:93], v244 offset:18528
  ds_read_b64_tr_b16 v[94:95], v244 offset:20832
  v_mfma_f32_16x16x32_bf16 v[36:39], v[164:167], v[128:131], v[36:39]
  v_mfma_f32_16x16x32_bf16 v[40:43], v[160:163], v[132:135], v[40:43]
  ds_read_b64_tr_b16 v[96:97], v244 offset:18560
  ds_read_b64_tr_b16 v[98:99], v244 offset:20864
  v_mfma_f32_16x16x32_bf16 v[44:47], v[164:167], v[132:135], v[44:47]
  v_mfma_f32_16x16x32_bf16 v[48:51], v[160:163], v[136:139], v[48:51]
  ds_read_b64_tr_b16 v[100:101], v244 offset:18592
  ds_read_b64_tr_b16 v[102:103], v244 offset:20896
  v_mfma_f32_16x16x32_bf16 v[52:55], v[164:167], v[136:139], v[52:55]
  s_waitcnt lgkmcnt(12)
  v_mfma_f32_16x16x32_bf16 v[56:59], v[160:163], v[140:143], v[56:59]
  ds_read_b64_tr_b16 v[104:105], v244 offset:18624
  ds_read_b64_tr_b16 v[106:107], v244 offset:20928
  v_mfma_f32_16x16x32_bf16 v[60:63], v[164:167], v[140:143], v[60:63]
  v_mfma_f32_16x16x32_bf16 v[64:67], v[160:163], v[144:147], v[64:67]
  ds_read_b64_tr_b16 v[108:109], v244 offset:18656
  ds_read_b64_tr_b16 v[110:111], v244 offset:20960
  v_mfma_f32_16x16x32_bf16 v[68:71], v[164:167], v[144:147], v[68:71]
  v_mfma_f32_16x16x32_bf16 v[72:75], v[160:163], v[148:151], v[72:75]
  ds_read_b64_tr_b16 v[112:113], v244 offset:18688
  ds_read_b64_tr_b16 v[114:115], v244 offset:20992
  v_mfma_f32_16x16x32_bf16 v[76:79], v[164:167], v[148:151], v[76:79]
  s_waitcnt vmcnt(9)
  s_waitcnt lgkmcnt(12)
  v_mfma_f32_16x16x32_bf16 v[8:11], v[168:171], v[80:83], v[8:11]
  ds_read_b64_tr_b16 v[116:117], v244 offset:27648
  ds_read_b64_tr_b16 v[118:119], v244 offset:29952
  v_mfma_f32_16x16x32_bf16 v[12:15], v[172:175], v[80:83], v[12:15]
  v_mfma_f32_16x16x32_bf16 v[16:19], v[168:171], v[84:87], v[16:19]
  ds_read_b64_tr_b16 v[120:121], v244 offset:27680
  ds_read_b64_tr_b16 v[122:123], v244 offset:29984
  v_mfma_f32_16x16x32_bf16 v[20:23], v[172:175], v[84:87], v[20:23]
  v_mfma_f32_16x16x32_bf16 v[24:27], v[168:171], v[88:91], v[24:27]
  ds_read_b64_tr_b16 v[124:125], v244 offset:27712
  ds_read_b64_tr_b16 v[126:127], v244 offset:30016
  v_mfma_f32_16x16x32_bf16 v[28:31], v[172:175], v[88:91], v[28:31]
  s_waitcnt lgkmcnt(12)
  v_mfma_f32_16x16x32_bf16 v[32:35], v[168:171], v[92:95], v[32:35]
  ds_read_b64_tr_b16 v[128:129], v244 offset:27744
  ds_read_b64_tr_b16 v[130:131], v244 offset:30048
  v_mfma_f32_16x16x32_bf16 v[36:39], v[172:175], v[92:95], v[36:39]
  v_mfma_f32_16x16x32_bf16 v[40:43], v[168:171], v[96:99], v[40:43]
  ds_read_b64_tr_b16 v[132:133], v244 offset:27776
  ds_read_b64_tr_b16 v[134:135], v244 offset:30080
  v_mfma_f32_16x16x32_bf16 v[44:47], v[172:175], v[96:99], v[44:47]
  v_mfma_f32_16x16x32_bf16 v[48:51], v[168:171], v[100:103], v[48:51]
  ds_read_b64_tr_b16 v[136:137], v244 offset:27808
  ds_read_b64_tr_b16 v[138:139], v244 offset:30112
  v_mfma_f32_16x16x32_bf16 v[52:55], v[172:175], v[100:103], v[52:55]
  s_waitcnt lgkmcnt(12)
  v_mfma_f32_16x16x32_bf16 v[56:59], v[168:171], v[104:107], v[56:59]
  ds_read_b64_tr_b16 v[140:141], v244 offset:27840
  ds_read_b64_tr_b16 v[142:143], v244 offset:30144
  v_mfma_f32_16x16x32_bf16 v[60:63], v[172:175], v[104:107], v[60:63]
  v_mfma_f32_16x16x32_bf16 v[64:67], v[168:171], v[108:111], v[64:67]
  ds_read_b64_tr_b16 v[144:145], v244 offset:27872
  ds_read_b64_tr_b16 v[146:147], v244 offset:30176
  v_mfma_f32_16x16x32_bf16 v[68:71], v[172:175], v[108:111], v[68:71]
  v_mfma_f32_16x16x32_bf16 v[72:75], v[168:171], v[112:115], v[72:75]
  ds_read_b64_tr_b16 v[148:149], v244 offset:27904
  ds_read_b64_tr_b16 v[150:151], v244 offset:30208
  v_mfma_f32_16x16x32_bf16 v[76:79], v[172:175], v[112:115], v[76:79]
  s_waitcnt lgkmcnt(12)
  v_mfma_f32_16x16x32_bf16 v[8:11], v[176:179], v[116:119], v[8:11]
  s_waitcnt vmcnt(4)
  s_barrier
  ds_read_b64_tr_b16 v[80:81], v243 offset:0
  ds_read_b64_tr_b16 v[82:83], v243 offset:2304
  v_mfma_f32_16x16x32_bf16 v[12:15], v[180:183], v[116:119], v[12:15]
  v_mfma_f32_16x16x32_bf16 v[16:19], v[176:179], v[120:123], v[16:19]
  ds_read_b64_tr_b16 v[84:85], v243 offset:32
  ds_read_b64_tr_b16 v[86:87], v243 offset:2336
  v_mfma_f32_16x16x32_bf16 v[20:23], v[180:183], v[120:123], v[20:23]
  v_mfma_f32_16x16x32_bf16 v[24:27], v[176:179], v[124:127], v[24:27]
  ds_read_b64_tr_b16 v[88:89], v243 offset:64
  ds_read_b64_tr_b16 v[90:91], v243 offset:2368
  v_mfma_f32_16x16x32_bf16 v[28:31], v[180:183], v[124:127], v[28:31]
  s_waitcnt lgkmcnt(12)
  v_mfma_f32_16x16x32_bf16 v[32:35], v[176:179], v[128:131], v[32:35]
  ds_read_b64_tr_b16 v[92:93], v243 offset:96
  ds_read_b64_tr_b16 v[94:95], v243 offset:2400
  v_mfma_f32_16x16x32_bf16 v[36:39], v[180:183], v[128:131], v[36:39]
  v_mfma_f32_16x16x32_bf16 v[40:43], v[176:179], v[132:135], v[40:43]
  ds_read_b64_tr_b16 v[96:97], v243 offset:128
  ds_read_b64_tr_b16 v[98:99], v243 offset:2432
  v_mfma_f32_16x16x32_bf16 v[44:47], v[180:183], v[132:135], v[44:47]
  v_mfma_f32_16x16x32_bf16 v[48:51], v[176:179], v[136:139], v[48:51]
  ds_read_b64_tr_b16 v[100:101], v243 offset:160
  ds_read_b64_tr_b16 v[102:103], v243 offset:2464
  v_mfma_f32_16x16x32_bf16 v[52:55], v[180:183], v[136:139], v[52:55]
  s_waitcnt lgkmcnt(12)
  v_mfma_f32_16x16x32_bf16 v[56:59], v[176:179], v[140:143], v[56:59]
  ds_read_b64_tr_b16 v[104:105], v243 offset:192
  ds_read_b64_tr_b16 v[106:107], v243 offset:2496
  v_mfma_f32_16x16x32_bf16 v[60:63], v[180:183], v[140:143], v[60:63]
  v_mfma_f32_16x16x32_bf16 v[64:67], v[176:179], v[144:147], v[64:67]
  ds_read_b64_tr_b16 v[108:109], v243 offset:224
  ds_read_b64_tr_b16 v[110:111], v243 offset:2528
  v_mfma_f32_16x16x32_bf16 v[68:71], v[180:183], v[144:147], v[68:71]
  v_mfma_f32_16x16x32_bf16 v[72:75], v[176:179], v[148:151], v[72:75]
  ds_read_b64_tr_b16 v[112:113], v243 offset:256
  ds_read_b64_tr_b16 v[114:115], v243 offset:2560
  v_mfma_f32_16x16x32_bf16 v[76:79], v[180:183], v[148:151], v[76:79]
  s_waitcnt vmcnt(0)
  s_waitcnt lgkmcnt(12)
  v_mfma_f32_16x16x32_bf16 v[8:11], v[184:187], v[80:83], v[8:11]
  ds_read_b64_tr_b16 v[116:117], v243 offset:9216
  ds_read_b64_tr_b16 v[118:119], v243 offset:11520
  v_mfma_f32_16x16x32_bf16 v[12:15], v[188:191], v[80:83], v[12:15]
  v_mfma_f32_16x16x32_bf16 v[16:19], v[184:187], v[84:87], v[16:19]
  ds_read_b64_tr_b16 v[120:121], v243 offset:9248
  ds_read_b64_tr_b16 v[122:123], v243 offset:11552
  v_mfma_f32_16x16x32_bf16 v[20:23], v[188:191], v[84:87], v[20:23]
  v_mfma_f32_16x16x32_bf16 v[24:27], v[184:187], v[88:91], v[24:27]
  ds_read_b64_tr_b16 v[124:125], v243 offset:9280
  ds_read_b64_tr_b16 v[126:127], v243 offset:11584
  v_mfma_f32_16x16x32_bf16 v[28:31], v[188:191], v[88:91], v[28:31]
  s_waitcnt lgkmcnt(12)
  v_mfma_f32_16x16x32_bf16 v[32:35], v[184:187], v[92:95], v[32:35]
  ds_read_b64_tr_b16 v[128:129], v243 offset:9312
  ds_read_b64_tr_b16 v[130:131], v243 offset:11616
  v_mfma_f32_16x16x32_bf16 v[36:39], v[188:191], v[92:95], v[36:39]
  v_mfma_f32_16x16x32_bf16 v[40:43], v[184:187], v[96:99], v[40:43]
  ds_read_b64_tr_b16 v[132:133], v243 offset:9344
  ds_read_b64_tr_b16 v[134:135], v243 offset:11648
  v_mfma_f32_16x16x32_bf16 v[44:47], v[188:191], v[96:99], v[44:47]
  v_mfma_f32_16x16x32_bf16 v[48:51], v[184:187], v[100:103], v[48:51]
  ds_read_b64_tr_b16 v[136:137], v243 offset:9376
  ds_read_b64_tr_b16 v[138:139], v243 offset:11680
  v_mfma_f32_16x16x32_bf16 v[52:55], v[188:191], v[100:103], v[52:55]
  s_waitcnt lgkmcnt(12)
  v_mfma_f32_16x16x32_bf16 v[56:59], v[184:187], v[104:107], v[56:59]
  ds_read_b64_tr_b16 v[140:141], v243 offset:9408
  ds_read_b64_tr_b16 v[142:143], v243 offset:11712
  v_mfma_f32_16x16x32_bf16 v[60:63], v[188:191], v[104:107], v[60:63]
  v_mfma_f32_16x16x32_bf16 v[64:67], v[184:187], v[108:111], v[64:67]
  ds_read_b64_tr_b16 v[144:145], v243 offset:9440
  ds_read_b64_tr_b16 v[146:147], v243 offset:11744
  v_mfma_f32_16x16x32_bf16 v[68:71], v[188:191], v[108:111], v[68:71]
  v_mfma_f32_16x16x32_bf16 v[72:75], v[184:187], v[112:115], v[72:75]
  ds_read_b64_tr_b16 v[148:149], v243 offset:9472
  ds_read_b64_tr_b16 v[150:151], v243 offset:11776
  v_mfma_f32_16x16x32_bf16 v[76:79], v[188:191], v[112:115], v[76:79]
  s_waitcnt lgkmcnt(12)
  v_mfma_f32_16x16x32_bf16 v[8:11], v[192:195], v[116:119], v[8:11]
  v_mfma_f32_16x16x32_bf16 v[12:15], v[196:199], v[116:119], v[12:15]
  v_mfma_f32_16x16x32_bf16 v[16:19], v[192:195], v[120:123], v[16:19]
  v_mfma_f32_16x16x32_bf16 v[20:23], v[196:199], v[120:123], v[20:23]
  v_mfma_f32_16x16x32_bf16 v[24:27], v[192:195], v[124:127], v[24:27]
  v_mfma_f32_16x16x32_bf16 v[28:31], v[196:199], v[124:127], v[28:31]
  s_waitcnt lgkmcnt(6)
  v_mfma_f32_16x16x32_bf16 v[32:35], v[192:195], v[128:131], v[32:35]
  v_mfma_f32_16x16x32_bf16 v[36:39], v[196:199], v[128:131], v[36:39]
  v_mfma_f32_16x16x32_bf16 v[40:43], v[192:195], v[132:135], v[40:43]
  v_mfma_f32_16x16x32_bf16 v[44:47], v[196:199], v[132:135], v[44:47]
  v_mfma_f32_16x16x32_bf16 v[48:51], v[192:195], v[136:139], v[48:51]
  v_mfma_f32_16x16x32_bf16 v[52:55], v[196:199], v[136:139], v[52:55]
  s_waitcnt lgkmcnt(0)
  v_mfma_f32_16x16x32_bf16 v[56:59], v[192:195], v[140:143], v[56:59]
  v_mfma_f32_16x16x32_bf16 v[60:63], v[196:199], v[140:143], v[60:63]
  v_mfma_f32_16x16x32_bf16 v[64:67], v[192:195], v[144:147], v[64:67]
  v_mfma_f32_16x16x32_bf16 v[68:71], v[196:199], v[144:147], v[68:71]
  v_mfma_f32_16x16x32_bf16 v[72:75], v[192:195], v[148:151], v[72:75]
  v_mfma_f32_16x16x32_bf16 v[76:79], v[196:199], v[148:151], v[76:79]
  s_barrier
  v_subrev_u32 v238, 4608, v238
  v_subrev_u32 v239, 4608, v239
  v_subrev_u32 v240, 4608, v240
  v_subrev_u32 v241, 4608, v241
  v_subrev_u32 v242, 4608, v242
  s_mov_b32 s32, 0
  s_mov_b32 s33, 0
  v_mov_b32 v80, 0
  v_mov_b32 v81, 0
  v_mov_b32 v82, 0
  v_mov_b32 v83, 0
  v_mov_b32 v84, 0
  v_mov_b32 v85, 0
  v_mov_b32 v86, 0
  v_mov_b32 v87, 0
  v_mov_b32 v88, 0
  v_mov_b32 v89, 0
  v_mov_b32 v90, 0
  v_mov_b32 v91, 0
  v_mov_b32 v92, 0
  v_mov_b32 v93, 0
  v_mov_b32 v94, 0
  v_mov_b32 v95, 0
  v_pk_mul_f32 v[248:249], v[8:9], v[8:9]
  v_pk_mul_f32 v[250:251], v[10:11], v[10:11]
  v_pk_mul_f32 v[252:253], v[12:13], v[12:13]
  v_pk_mul_f32 v[254:255], v[14:15], v[14:15]
  v_pk_fma_f32 v[248:249], v[248:249], s[42:43], v[246:247]
  v_pk_fma_f32 v[250:251], v[250:251], s[42:43], v[246:247]
  v_pk_fma_f32 v[252:253], v[252:253], s[42:43], v[246:247]
  v_pk_fma_f32 v[254:255], v[254:255], s[42:43], v[246:247]
  v_pk_mul_f32 v[248:249], v[248:249], v[8:9]
  v_pk_mul_f32 v[250:251], v[250:251], v[10:11]
  v_pk_mul_f32 v[252:253], v[252:253], v[12:13]
  v_pk_mul_f32 v[254:255], v[254:255], v[14:15]
  v_exp_f32 v248, v248
  v_exp_f32 v249, v249
  v_exp_f32 v250, v250
  v_exp_f32 v251, v251
  v_exp_f32 v252, v252
  v_exp_f32 v253, v253
  v_exp_f32 v254, v254
  v_exp_f32 v255, v255
  v_pk_add_f32 v[248:249], v[248:249], s[52:53]
  v_pk_add_f32 v[250:251], v[250:251], s[52:53]
  v_pk_add_f32 v[252:253], v[252:253], s[52:53]
  v_pk_add_f32 v[254:255], v[254:255], s[52:53]
  v_rcp_f32 v248, v248
  v_rcp_f32 v249, v249
  v_rcp_f32 v250, v250
  v_rcp_f32 v251, v251
  v_rcp_f32 v252, v252
  v_rcp_f32 v253, v253
  v_rcp_f32 v254, v254
  v_rcp_f32 v255, v255
  s_nop 0
  v_pk_mul_f32 v[8:9], v[8:9], v[248:249]
  v_pk_mul_f32 v[10:11], v[10:11], v[250:251]
  v_pk_mul_f32 v[12:13], v[12:13], v[252:253]
  v_pk_mul_f32 v[14:15], v[14:15], v[254:255]
  v_pk_add_f32 v[80:81], v[80:81], v[8:9]
  v_pk_fma_f32 v[88:89], v[8:9], v[8:9], v[88:89]
  v_pk_add_f32 v[82:83], v[82:83], v[10:11]
  v_pk_fma_f32 v[90:91], v[10:11], v[10:11], v[90:91]
  v_cvt_pk_bf16_f32 v200, v8, v9
  v_cvt_pk_bf16_f32 v201, v10, v11
  v_pk_add_f32 v[84:85], v[84:85], v[12:13]
  v_pk_fma_f32 v[92:93], v[12:13], v[12:13], v[92:93]
  v_pk_add_f32 v[86:87], v[86:87], v[14:15]
  v_pk_fma_f32 v[94:95], v[14:15], v[14:15], v[94:95]
  v_cvt_pk_bf16_f32 v202, v12, v13
  v_cvt_pk_bf16_f32 v203, v14, v15
  buffer_load_dwordx4 v[152:155], v236, s[8:11], s32 offen offset:0
  buffer_load_dwordx4 v[156:159], v237, s[8:11], s32 offen offset:0
  buffer_load_dwordx4 v[160:163], v236, s[8:11], s32 offen offset:1024
  v_pk_mul_f32 v[248:249], v[16:17], v[16:17]
  v_pk_mul_f32 v[250:251], v[18:19], v[18:19]
  v_pk_mul_f32 v[252:253], v[20:21], v[20:21]
  v_pk_mul_f32 v[254:255], v[22:23], v[22:23]
  v_pk_fma_f32 v[248:249], v[248:249], s[42:43], v[246:247]
  v_pk_fma_f32 v[250:251], v[250:251], s[42:43], v[246:247]
  v_pk_fma_f32 v[252:253], v[252:253], s[42:43], v[246:247]
  v_pk_fma_f32 v[254:255], v[254:255], s[42:43], v[246:247]
  v_pk_mul_f32 v[248:249], v[248:249], v[16:17]
  v_pk_mul_f32 v[250:251], v[250:251], v[18:19]
  v_pk_mul_f32 v[252:253], v[252:253], v[20:21]
  v_pk_mul_f32 v[254:255], v[254:255], v[22:23]
  v_exp_f32 v248, v248
  v_exp_f32 v249, v249
  v_exp_f32 v250, v250
  v_exp_f32 v251, v251
  v_exp_f32 v252, v252
  v_exp_f32 v253, v253
  v_exp_f32 v254, v254
  v_exp_f32 v255, v255
  v_pk_add_f32 v[248:249], v[248:249], s[52:53]
  v_pk_add_f32 v[250:251], v[250:251], s[52:53]
  v_pk_add_f32 v[252:253], v[252:253], s[52:53]
  v_pk_add_f32 v[254:255], v[254:255], s[52:53]
  v_rcp_f32 v248, v248
  v_rcp_f32 v249, v249
  v_rcp_f32 v250, v250
  v_rcp_f32 v251, v251
  v_rcp_f32 v252, v252
  v_rcp_f32 v253, v253
  v_rcp_f32 v254, v254
  v_rcp_f32 v255, v255
  s_nop 0
  v_pk_mul_f32 v[16:17], v[16:17], v[248:249]
  v_pk_mul_f32 v[18:19], v[18:19], v[250:251]
  v_pk_mul_f32 v[20:21], v[20:21], v[252:253]
  v_pk_mul_f32 v[22:23], v[22:23], v[254:255]
  v_pk_add_f32 v[80:81], v[80:81], v[16:17]
  v_pk_fma_f32 v[88:89], v[16:17], v[16:17], v[88:89]
  v_pk_add_f32 v[82:83], v[82:83], v[18:19]
  v_pk_fma_f32 v[90:91], v[18:19], v[18:19], v[90:91]
  v_cvt_pk_bf16_f32 v204, v16, v17
  v_cvt_pk_bf16_f32 v205, v18, v19
  v_pk_add_f32 v[84:85], v[84:85], v[20:21]
  v_pk_fma_f32 v[92:93], v[20:21], v[20:21], v[92:93]
  v_pk_add_f32 v[86:87], v[86:87], v[22:23]
  v_pk_fma_f32 v[94:95], v[22:23], v[22:23], v[94:95]
  v_cvt_pk_bf16_f32 v206, v20, v21
  v_cvt_pk_bf16_f32 v207, v22, v23
  buffer_load_dwordx4 v[164:167], v237, s[8:11], s32 offen offset:1024
  s_add_u32 s32, s32, 2048
  s_add_u32 m0, s34, 0
  s_mov_b64 exec, s[40:41]
  buffer_load_dwordx4 v238, s[12:15], s33 offen lds
  s_mov_b64 exec, -1
  buffer_load_dwordx4 v239, s[12:15], s33 offen offset:512 lds
  v_pk_mul_f32 v[248:249], v[24:25], v[24:25]
  v_pk_mul_f32 v[250:251], v[26:27], v[26:27]
  v_pk_mul_f32 v[252:253], v[28:29], v[28:29]
  v_pk_mul_f32 v[254:255], v[30:31], v[30:31]
  v_pk_fma_f32 v[248:249], v[248:249], s[42:43], v[246:247]
  v_pk_fma_f32 v[250:251], v[250:251], s[42:43], v[246:247]
  v_pk_fma_f32 v[252:253], v[252:253], s[42:43], v[246:247]
  v_pk_fma_f32 v[254:255], v[254:255], s[42:43], v[246:247]
  v_pk_mul_f32 v[248:249], v[248:249], v[24:25]
  v_pk_mul_f32 v[250:251], v[250:251], v[26:27]
  v_pk_mul_f32 v[252:253], v[252:253], v[28:29]
  v_pk_mul_f32 v[254:255], v[254:255], v[30:31]
  v_exp_f32 v248, v248
  v_exp_f32 v249, v249
  v_exp_f32 v250, v250
  v_exp_f32 v251, v251
  v_exp_f32 v252, v252
  v_exp_f32 v253, v253
  v_exp_f32 v254, v254
  v_exp_f32 v255, v255
  v_pk_add_f32 v[248:249], v[248:249], s[52:53]
  v_pk_add_f32 v[250:251], v[250:251], s[52:53]
  v_pk_add_f32 v[252:253], v[252:253], s[52:53]
  v_pk_add_f32 v[254:255], v[254:255], s[52:53]
  v_rcp_f32 v248, v248
  v_rcp_f32 v249, v249
  v_rcp_f32 v250, v250
  v_rcp_f32 v251, v251
  v_rcp_f32 v252, v252
  v_rcp_f32 v253, v253
  v_rcp_f32 v254, v254
  v_rcp_f32 v255, v255
  s_nop 0
  v_pk_mul_f32 v[24:25], v[24:25], v[248:249]
  v_pk_mul_f32 v[26:27], v[26:27], v[250:251]
  v_pk_mul_f32 v[28:29], v[28:29], v[252:253]
  v_pk_mul_f32 v[30:31], v[30:31], v[254:255]
  v_pk_add_f32 v[80:81], v[80:81], v[24:25]
  v_pk_fma_f32 v[88:89], v[24:25], v[24:25], v[88:89]
  v_pk_add_f32 v[82:83], v[82:83], v[26:27]
  v_pk_fma_f32 v[90:91], v[26:27], v[26:27], v[90:91]
  v_cvt_pk_bf16_f32 v208, v24, v25
  v_cvt_pk_bf16_f32 v209, v26, v27
  v_pk_add_f32 v[84:85], v[84:85], v[28:29]
  v_pk_fma_f32 v[92:93], v[28:29], v[28:29], v[92:93]
  v_pk_add_f32 v[86:87], v[86:87], v[30:31]
  v_pk_fma_f32 v[94:95], v[30:31], v[30:31], v[94:95]
  v_cvt_pk_bf16_f32 v210, v28, v29
  v_cvt_pk_bf16_f32 v211, v30, v31
  buffer_load_dwordx4 v240, s[12:15], s33 offen offset:1536 lds
  buffer_load_dwordx4 v241, s[12:15], s33 offen offset:2560 lds
  buffer_load_dwordx4 v242, s[12:15], s33 offen offset:3584 lds
  s_add_u32 s33, s33, 589824
  v_pk_mul_f32 v[248:249], v[32:33], v[32:33]
  v_pk_mul_f32 v[250:251], v[34:35], v[34:35]
  v_pk_mul_f32 v[252:253], v[36:37], v[36:37]
  v_pk_mul_f32 v[254:255], v[38:39], v[38:39]
  v_pk_fma_f32 v[248:249], v[248:249], s[42:43], v[246:247]
  v_pk_fma_f32 v[250:251], v[250:251], s[42:43], v[246:247]
  v_pk_fma_f32 v[252:253], v[252:253], s[42:43], v[246:247]
  v_pk_fma_f32 v[254:255], v[254:255], s[42:43], v[246:247]
  v_pk_mul_f32 v[248:249], v[248:249], v[32:33]
  v_pk_mul_f32 v[250:251], v[250:251], v[34:35]
  v_pk_mul_f32 v[252:253], v[252:253], v[36:37]
  v_pk_mul_f32 v[254:255], v[254:255], v[38:39]
  v_exp_f32 v248, v248
  v_exp_f32 v249, v249
  v_exp_f32 v250, v250
  v_exp_f32 v251, v251
  v_exp_f32 v252, v252
  v_exp_f32 v253, v253
  v_exp_f32 v254, v254
  v_exp_f32 v255, v255
  v_pk_add_f32 v[248:249], v[248:249], s[52:53]
  v_pk_add_f32 v[250:251], v[250:251], s[52:53]
  v_pk_add_f32 v[252:253], v[252:253], s[52:53]
  v_pk_add_f32 v[254:255], v[254:255], s[52:53]
  v_rcp_f32 v248, v248
  v_rcp_f32 v249, v249
  v_rcp_f32 v250, v250
  v_rcp_f32 v251, v251
  v_rcp_f32 v252, v252
  v_rcp_f32 v253, v253
  v_rcp_f32 v254, v254
  v_rcp_f32 v255, v255
  s_nop 0
  v_pk_mul_f32 v[32:33], v[32:33], v[248:249]
  v_pk_mul_f32 v[34:35], v[34:35], v[250:251]
  v_pk_mul_f32 v[36:37], v[36:37], v[252:253]
  v_pk_mul_f32 v[38:39], v[38:39], v[254:255]
  v_pk_add_f32 v[80:81], v[80:81], v[32:33]
  v_pk_fma_f32 v[88:89], v[32:33], v[32:33], v[88:89]
  v_pk_add_f32 v[82:83], v[82:83], v[34:35]
  v_pk_fma_f32 v[90:91], v[34:35], v[34:35], v[90:91]
  v_cvt_pk_bf16_f32 v212, v32, v33
  v_cvt_pk_bf16_f32 v213, v34, v35
  v_pk_add_f32 v[84:85], v[84:85], v[36:37]
  v_pk_fma_f32 v[92:93], v[36:37], v[36:37], v[92:93]
  v_pk_add_f32 v[86:87], v[86:87], v[38:39]
  v_pk_fma_f32 v[94:95], v[38:39], v[38:39], v[94:95]
  v_cvt_pk_bf16_f32 v214, v36, v37
  v_cvt_pk_bf16_f32 v215, v38, v39
  buffer_load_dwordx4 v[168:171], v236, s[8:11], s32 offen offset:0
  buffer_load_dwordx4 v[172:175], v237, s[8:11], s32 offen offset:0
  buffer_load_dwordx4 v[176:179], v236, s[8:11], s32 offen offset:1024
  v_pk_mul_f32 v[248:249], v[40:41], v[40:41]
  v_pk_mul_f32 v[250:251], v[42:43], v[42:43]
  v_pk_mul_f32 v[252:253], v[44:45], v[44:45]
  v_pk_mul_f32 v[254:255], v[46:47], v[46:47]
  v_pk_fma_f32 v[248:249], v[248:249], s[42:43], v[246:247]
  v_pk_fma_f32 v[250:251], v[250:251], s[42:43], v[246:247]
  v_pk_fma_f32 v[252:253], v[252:253], s[42:43], v[246:247]
  v_pk_fma_f32 v[254:255], v[254:255], s[42:43], v[246:247]
  v_pk_mul_f32 v[248:249], v[248:249], v[40:41]
  v_pk_mul_f32 v[250:251], v[250:251], v[42:43]
  v_pk_mul_f32 v[252:253], v[252:253], v[44:45]
  v_pk_mul_f32 v[254:255], v[254:255], v[46:47]
  v_exp_f32 v248, v248
  v_exp_f32 v249, v249
  v_exp_f32 v250, v250
  v_exp_f32 v251, v251
  v_exp_f32 v252, v252
  v_exp_f32 v253, v253
  v_exp_f32 v254, v254
  v_exp_f32 v255, v255
  v_pk_add_f32 v[248:249], v[248:249], s[52:53]
  v_pk_add_f32 v[250:251], v[250:251], s[52:53]
  v_pk_add_f32 v[252:253], v[252:253], s[52:53]
  v_pk_add_f32 v[254:255], v[254:255], s[52:53]
  v_rcp_f32 v248, v248
  v_rcp_f32 v249, v249
  v_rcp_f32 v250, v250
  v_rcp_f32 v251, v251
  v_rcp_f32 v252, v252
  v_rcp_f32 v253, v253
  v_rcp_f32 v254, v254
  v_rcp_f32 v255, v255
  s_nop 0
  v_pk_mul_f32 v[40:41], v[40:41], v[248:249]
  v_pk_mul_f32 v[42:43], v[42:43], v[250:251]
  v_pk_mul_f32 v[44:45], v[44:45], v[252:253]
  v_pk_mul_f32 v[46:47], v[46:47], v[254:255]
  v_pk_add_f32 v[80:81], v[80:81], v[40:41]
  v_pk_fma_f32 v[88:89], v[40:41], v[40:41], v[88:89]
  v_pk_add_f32 v[82:83], v[82:83], v[42:43]
  v_pk_fma_f32 v[90:91], v[42:43], v[42:43], v[90:91]
  v_cvt_pk_bf16_f32 v216, v40, v41
  v_cvt_pk_bf16_f32 v217, v42, v43
  v_pk_add_f32 v[84:85], v[84:85], v[44:45]
  v_pk_fma_f32 v[92:93], v[44:45], v[44:45], v[92:93]
  v_pk_add_f32 v[86:87], v[86:87], v[46:47]
  v_pk_fma_f32 v[94:95], v[46:47], v[46:47], v[94:95]
  v_cvt_pk_bf16_f32 v218, v44, v45
  v_cvt_pk_bf16_f32 v219, v46, v47
  buffer_load_dwordx4 v[180:183], v237, s[8:11], s32 offen offset:1024
  s_add_u32 s32, s32, 2048
  s_add_u32 m0, s34, 18432
  s_mov_b64 exec, s[40:41]
  buffer_load_dwordx4 v238, s[12:15], s33 offen lds
  s_mov_b64 exec, -1
  buffer_load_dwordx4 v239, s[12:15], s33 offen offset:512 lds
  v_pk_mul_f32 v[248:249], v[48:49], v[48:49]
  v_pk_mul_f32 v[250:251], v[50:51], v[50:51]
  v_pk_mul_f32 v[252:253], v[52:53], v[52:53]
  v_pk_mul_f32 v[254:255], v[54:55], v[54:55]
  v_pk_fma_f32 v[248:249], v[248:249], s[42:43], v[246:247]
  v_pk_fma_f32 v[250:251], v[250:251], s[42:43], v[246:247]
  v_pk_fma_f32 v[252:253], v[252:253], s[42:43], v[246:247]
  v_pk_fma_f32 v[254:255], v[254:255], s[42:43], v[246:247]
  v_pk_mul_f32 v[248:249], v[248:249], v[48:49]
  v_pk_mul_f32 v[250:251], v[250:251], v[50:51]
  v_pk_mul_f32 v[252:253], v[252:253], v[52:53]
  v_pk_mul_f32 v[254:255], v[254:255], v[54:55]
  v_exp_f32 v248, v248
  v_exp_f32 v249, v249
  v_exp_f32 v250, v250
  v_exp_f32 v251, v251
  v_exp_f32 v252, v252
  v_exp_f32 v253, v253
  v_exp_f32 v254, v254
  v_exp_f32 v255, v255
  v_pk_add_f32 v[248:249], v[248:249], s[52:53]
  v_pk_add_f32 v[250:251], v[250:251], s[52:53]
  v_pk_add_f32 v[252:253], v[252:253], s[52:53]
  v_pk_add_f32 v[254:255], v[254:255], s[52:53]
  v_rcp_f32 v248, v248
  v_rcp_f32 v249, v249
  v_rcp_f32 v250, v250
  v_rcp_f32 v251, v251
  v_rcp_f32 v252, v252
  v_rcp_f32 v253, v253
  v_rcp_f32 v254, v254
  v_rcp_f32 v255, v255
  s_nop 0
  v_pk_mul_f32 v[48:49], v[48:49], v[248:249]
  v_pk_mul_f32 v[50:51], v[50:51], v[250:251]
  v_pk_mul_f32 v[52:53], v[52:53], v[252:253]
  v_pk_mul_f32 v[54:55], v[54:55], v[254:255]
  v_pk_add_f32 v[80:81], v[80:81], v[48:49]
  v_pk_fma_f32 v[88:89], v[48:49], v[48:49], v[88:89]
  v_pk_add_f32 v[82:83], v[82:83], v[50:51]
  v_pk_fma_f32 v[90:91], v[50:51], v[50:51], v[90:91]
  v_cvt_pk_bf16_f32 v220, v48, v49
  v_cvt_pk_bf16_f32 v221, v50, v51
  v_pk_add_f32 v[84:85], v[84:85], v[52:53]
  v_pk_fma_f32 v[92:93], v[52:53], v[52:53], v[92:93]
  v_pk_add_f32 v[86:87], v[86:87], v[54:55]
  v_pk_fma_f32 v[94:95], v[54:55], v[54:55], v[94:95]
  v_cvt_pk_bf16_f32 v222, v52, v53
  v_cvt_pk_bf16_f32 v223, v54, v55
  buffer_load_dwordx4 v240, s[12:15], s33 offen offset:1536 lds
  buffer_load_dwordx4 v241, s[12:15], s33 offen offset:2560 lds
  v_pk_mul_f32 v[248:249], v[56:57], v[56:57]
  v_pk_mul_f32 v[250:251], v[58:59], v[58:59]
  v_pk_mul_f32 v[252:253], v[60:61], v[60:61]
  v_pk_mul_f32 v[254:255], v[62:63], v[62:63]
  v_pk_fma_f32 v[248:249], v[248:249], s[42:43], v[246:247]
  v_pk_fma_f32 v[250:251], v[250:251], s[42:43], v[246:247]
  v_pk_fma_f32 v[252:253], v[252:253], s[42:43], v[246:247]
  v_pk_fma_f32 v[254:255], v[254:255], s[42:43], v[246:247]
  v_pk_mul_f32 v[248:249], v[248:249], v[56:57]
  v_pk_mul_f32 v[250:251], v[250:251], v[58:59]
  v_pk_mul_f32 v[252:253], v[252:253], v[60:61]
  v_pk_mul_f32 v[254:255], v[254:255], v[62:63]
  v_exp_f32 v248, v248
  v_exp_f32 v249, v249
  v_exp_f32 v250, v250
  v_exp_f32 v251, v251
  v_exp_f32 v252, v252
  v_exp_f32 v253, v253
  v_exp_f32 v254, v254
  v_exp_f32 v255, v255
  v_pk_add_f32 v[248:249], v[248:249], s[52:53]
  v_pk_add_f32 v[250:251], v[250:251], s[52:53]
  v_pk_add_f32 v[252:253], v[252:253], s[52:53]
  v_pk_add_f32 v[254:255], v[254:255], s[52:53]
  v_rcp_f32 v248, v248
  v_rcp_f32 v249, v249
  v_rcp_f32 v250, v250
  v_rcp_f32 v251, v251
  v_rcp_f32 v252, v252
  v_rcp_f32 v253, v253
  v_rcp_f32 v254, v254
  v_rcp_f32 v255, v255
  s_nop 0
  v_pk_mul_f32 v[56:57], v[56:57], v[248:249]
  v_pk_mul_f32 v[58:59], v[58:59], v[250:251]
  v_pk_mul_f32 v[60:61], v[60:61], v[252:253]
  v_pk_mul_f32 v[62:63], v[62:63], v[254:255]
  v_pk_add_f32 v[80:81], v[80:81], v[56:57]
  v_pk_fma_f32 v[88:89], v[56:57], v[56:57], v[88:89]
  v_pk_add_f32 v[82:83], v[82:83], v[58:59]
  v_pk_fma_f32 v[90:91], v[58:59], v[58:59], v[90:91]
  v_cvt_pk_bf16_f32 v224, v56, v57
  v_cvt_pk_bf16_f32 v225, v58, v59
  v_pk_add_f32 v[84:85], v[84:85], v[60:61]
  v_pk_fma_f32 v[92:93], v[60:61], v[60:61], v[92:93]
  v_pk_add_f32 v[86:87], v[86:87], v[62:63]
  v_pk_fma_f32 v[94:95], v[62:63], v[62:63], v[94:95]
  v_cvt_pk_bf16_f32 v226, v60, v61
  v_cvt_pk_bf16_f32 v227, v62, v63
  buffer_load_dwordx4 v242, s[12:15], s33 offen offset:3584 lds
  s_add_u32 s33, s33, 589824
  s_add_u32 m0, s34, 36864
  s_mov_b64 exec, s[40:41]
  buffer_load_dwordx4 v238, s[12:15], s33 offen lds
  s_mov_b64 exec, -1
  v_pk_mul_f32 v[248:249], v[64:65], v[64:65]
  v_pk_mul_f32 v[250:251], v[66:67], v[66:67]
  v_pk_mul_f32 v[252:253], v[68:69], v[68:69]
  v_pk_mul_f32 v[254:255], v[70:71], v[70:71]
  v_pk_fma_f32 v[248:249], v[248:249], s[42:43], v[246:247]
  v_pk_fma_f32 v[250:251], v[250:251], s[42:43], v[246:247]
  v_pk_fma_f32 v[252:253], v[252:253], s[42:43], v[246:247]
  v_pk_fma_f32 v[254:255], v[254:255], s[42:43], v[246:247]
  v_pk_mul_f32 v[248:249], v[248:249], v[64:65]
  v_pk_mul_f32 v[250:251], v[250:251], v[66:67]
  v_pk_mul_f32 v[252:253], v[252:253], v[68:69]
  v_pk_mul_f32 v[254:255], v[254:255], v[70:71]
  v_exp_f32 v248, v248
  v_exp_f32 v249, v249
  v_exp_f32 v250, v250
  v_exp_f32 v251, v251
  v_exp_f32 v252, v252
  v_exp_f32 v253, v253
  v_exp_f32 v254, v254
  v_exp_f32 v255, v255
  v_pk_add_f32 v[248:249], v[248:249], s[52:53]
  v_pk_add_f32 v[250:251], v[250:251], s[52:53]
  v_pk_add_f32 v[252:253], v[252:253], s[52:53]
  v_pk_add_f32 v[254:255], v[254:255], s[52:53]
  v_rcp_f32 v248, v248
  v_rcp_f32 v249, v249
  v_rcp_f32 v250, v250
  v_rcp_f32 v251, v251
  v_rcp_f32 v252, v252
  v_rcp_f32 v253, v253
  v_rcp_f32 v254, v254
  v_rcp_f32 v255, v255
  s_nop 0
  v_pk_mul_f32 v[64:65], v[64:65], v[248:249]
  v_pk_mul_f32 v[66:67], v[66:67], v[250:251]
  v_pk_mul_f32 v[68:69], v[68:69], v[252:253]
  v_pk_mul_f32 v[70:71], v[70:71], v[254:255]
  v_pk_add_f32 v[80:81], v[80:81], v[64:65]
  v_pk_fma_f32 v[88:89], v[64:65], v[64:65], v[88:89]
  v_pk_add_f32 v[82:83], v[82:83], v[66:67]
  v_pk_fma_f32 v[90:91], v[66:67], v[66:67], v[90:91]
  v_cvt_pk_bf16_f32 v228, v64, v65
  v_cvt_pk_bf16_f32 v229, v66, v67
  v_pk_add_f32 v[84:85], v[84:85], v[68:69]
  v_pk_fma_f32 v[92:93], v[68:69], v[68:69], v[92:93]
  v_pk_add_f32 v[86:87], v[86:87], v[70:71]
  v_pk_fma_f32 v[94:95], v[70:71], v[70:71], v[94:95]
  v_cvt_pk_bf16_f32 v230, v68, v69
  v_cvt_pk_bf16_f32 v231, v70, v71
  buffer_load_dwordx4 v239, s[12:15], s33 offen offset:512 lds
  buffer_load_dwordx4 v240, s[12:15], s33 offen offset:1536 lds
  v_pk_mul_f32 v[248:249], v[72:73], v[72:73]
  v_pk_mul_f32 v[250:251], v[74:75], v[74:75]
  v_pk_mul_f32 v[252:253], v[76:77], v[76:77]
  v_pk_mul_f32 v[254:255], v[78:79], v[78:79]
  v_pk_fma_f32 v[248:249], v[248:249], s[42:43], v[246:247]
  v_pk_fma_f32 v[250:251], v[250:251], s[42:43], v[246:247]
  v_pk_fma_f32 v[252:253], v[252:253], s[42:43], v[246:247]
  v_pk_fma_f32 v[254:255], v[254:255], s[42:43], v[246:247]
  v_pk_mul_f32 v[248:249], v[248:249], v[72:73]
  v_pk_mul_f32 v[250:251], v[250:251], v[74:75]
  v_pk_mul_f32 v[252:253], v[252:253], v[76:77]
  v_pk_mul_f32 v[254:255], v[254:255], v[78:79]
  v_exp_f32 v248, v248
  v_exp_f32 v249, v249
  v_exp_f32 v250, v250
  v_exp_f32 v251, v251
  v_exp_f32 v252, v252
  v_exp_f32 v253, v253
  v_exp_f32 v254, v254
  v_exp_f32 v255, v255
  v_pk_add_f32 v[248:249], v[248:249], s[52:53]
  v_pk_add_f32 v[250:251], v[250:251], s[52:53]
  v_pk_add_f32 v[252:253], v[252:253], s[52:53]
  v_pk_add_f32 v[254:255], v[254:255], s[52:53]
  v_rcp_f32 v248, v248
  v_rcp_f32 v249, v249
  v_rcp_f32 v250, v250
  v_rcp_f32 v251, v251
  v_rcp_f32 v252, v252
  v_rcp_f32 v253, v253
  v_rcp_f32 v254, v254
  v_rcp_f32 v255, v255
  s_nop 0
  v_pk_mul_f32 v[72:73], v[72:73], v[248:249]
  v_pk_mul_f32 v[74:75], v[74:75], v[250:251]
  v_pk_mul_f32 v[76:77], v[76:77], v[252:253]
  v_pk_mul_f32 v[78:79], v[78:79], v[254:255]
  v_pk_add_f32 v[80:81], v[80:81], v[72:73]
  v_pk_fma_f32 v[88:89], v[72:73], v[72:73], v[88:89]
  v_pk_add_f32 v[82:83], v[82:83], v[74:75]
  v_pk_fma_f32 v[90:91], v[74:75], v[74:75], v[90:91]
  v_cvt_pk_bf16_f32 v232, v72, v73
  v_cvt_pk_bf16_f32 v233, v74, v75
  v_pk_add_f32 v[84:85], v[84:85], v[76:77]
  v_pk_fma_f32 v[92:93], v[76:77], v[76:77], v[92:93]
  v_pk_add_f32 v[86:87], v[86:87], v[78:79]
  v_pk_fma_f32 v[94:95], v[78:79], v[78:79], v[94:95]
  v_cvt_pk_bf16_f32 v234, v76, v77
  v_cvt_pk_bf16_f32 v235, v78, v79
  buffer_load_dwordx4 v241, s[12:15], s33 offen offset:2560 lds
  buffer_load_dwordx4 v242, s[12:15], s33 offen offset:3584 lds
  s_add_u32 s33, s33, 589824
  s_nop 1
  v_add_f32_dpp v80, v80, v80 row_ror:8 row_mask:0xf bank_mask:0xf
  v_add_f32_dpp v81, v81, v81 row_ror:8 row_mask:0xf bank_mask:0xf
  v_add_f32_dpp v82, v82, v82 row_ror:8 row_mask:0xf bank_mask:0xf
  v_add_f32_dpp v83, v83, v83 row_ror:8 row_mask:0xf bank_mask:0xf
  v_add_f32_dpp v84, v84, v84 row_ror:8 row_mask:0xf bank_mask:0xf
  v_add_f32_dpp v85, v85, v85 row_ror:8 row_mask:0xf bank_mask:0xf
  v_add_f32_dpp v86, v86, v86 row_ror:8 row_mask:0xf bank_mask:0xf
  v_add_f32_dpp v87, v87, v87 row_ror:8 row_mask:0xf bank_mask:0xf
  v_add_f32_dpp v88, v88, v88 row_ror:8 row_mask:0xf bank_mask:0xf
  v_add_f32_dpp v89, v89, v89 row_ror:8 row_mask:0xf bank_mask:0xf
  v_add_f32_dpp v90, v90, v90 row_ror:8 row_mask:0xf bank_mask:0xf
  v_add_f32_dpp v91, v91, v91 row_ror:8 row_mask:0xf bank_mask:0xf
  v_add_f32_dpp v92, v92, v92 row_ror:8 row_mask:0xf bank_mask:0xf
  v_add_f32_dpp v93, v93, v93 row_ror:8 row_mask:0xf bank_mask:0xf
  v_add_f32_dpp v94, v94, v94 row_ror:8 row_mask:0xf bank_mask:0xf
  v_add_f32_dpp v95, v95, v95 row_ror:8 row_mask:0xf bank_mask:0xf
  s_nop 1
  v_add_f32_dpp v80, v80, v80 row_ror:4 row_mask:0xf bank_mask:0xf
  v_add_f32_dpp v81, v81, v81 row_ror:4 row_mask:0xf bank_mask:0xf
  v_add_f32_dpp v82, v82, v82 row_ror:4 row_mask:0xf bank_mask:0xf
  v_add_f32_dpp v83, v83, v83 row_ror:4 row_mask:0xf bank_mask:0xf
  v_add_f32_dpp v84, v84, v84 row_ror:4 row_mask:0xf bank_mask:0xf
  v_add_f32_dpp v85, v85, v85 row_ror:4 row_mask:0xf bank_mask:0xf
  v_add_f32_dpp v86, v86, v86 row_ror:4 row_mask:0xf bank_mask:0xf
  v_add_f32_dpp v87, v87, v87 row_ror:4 row_mask:0xf bank_mask:0xf
  v_add_f32_dpp v88, v88, v88 row_ror:4 row_mask:0xf bank_mask:0xf
  v_add_f32_dpp v89, v89, v89 row_ror:4 row_mask:0xf bank_mask:0xf
  v_add_f32_dpp v90, v90, v90 row_ror:4 row_mask:0xf bank_mask:0xf
  v_add_f32_dpp v91, v91, v91 row_ror:4 row_mask:0xf bank_mask:0xf
  v_add_f32_dpp v92, v92, v92 row_ror:4 row_mask:0xf bank_mask:0xf
  v_add_f32_dpp v93, v93, v93 row_ror:4 row_mask:0xf bank_mask:0xf
  v_add_f32_dpp v94, v94, v94 row_ror:4 row_mask:0xf bank_mask:0xf
  v_add_f32_dpp v95, v95, v95 row_ror:4 row_mask:0xf bank_mask:0xf
  s_nop 1
  v_add_f32_dpp v80, v80, v80 row_ror:2 row_mask:0xf bank_mask:0xf
  v_add_f32_dpp v81, v81, v81 row_ror:2 row_mask:0xf bank_mask:0xf
  v_add_f32_dpp v82, v82, v82 row_ror:2 row_mask:0xf bank_mask:0xf
  v_add_f32_dpp v83, v83, v83 row_ror:2 row_mask:0xf bank_mask:0xf
  v_add_f32_dpp v84, v84, v84 row_ror:2 row_mask:0xf bank_mask:0xf
  v_add_f32_dpp v85, v85, v85 row_ror:2 row_mask:0xf bank_mask:0xf
  v_add_f32_dpp v86, v86, v86 row_ror:2 row_mask:0xf bank_mask:0xf
  v_add_f32_dpp v87, v87, v87 row_ror:2 row_mask:0xf bank_mask:0xf
  v_add_f32_dpp v88, v88, v88 row_ror:2 row_mask:0xf bank_mask:0xf
  v_add_f32_dpp v89, v89, v89 row_ror:2 row_mask:0xf bank_mask:0xf
  v_add_f32_dpp v90, v90, v90 row_ror:2 row_mask:0xf bank_mask:0xf
  v_add_f32_dpp v91, v91, v91 row_ror:2 row_mask:0xf bank_mask:0xf
  v_add_f32_dpp v92, v92, v92 row_ror:2 row_mask:0xf bank_mask:0xf
  v_add_f32_dpp v93, v93, v93 row_ror:2 row_mask:0xf bank_mask:0xf
  v_add_f32_dpp v94, v94, v94 row_ror:2 row_mask:0xf bank_mask:0xf
  v_add_f32_dpp v95, v95, v95 row_ror:2 row_mask:0xf bank_mask:0xf
  s_nop 1
  v_add_f32_dpp v80, v80, v80 row_ror:1 row_mask:0xf bank_mask:0xf
  v_add_f32_dpp v81, v81, v81 row_ror:1 row_mask:0xf bank_mask:0xf
  v_add_f32_dpp v82, v82, v82 row_ror:1 row_mask:0xf bank_mask:0xf
  v_add_f32_dpp v83, v83, v83 row_ror:1 row_mask:0xf bank_mask:0xf
  v_add_f32_dpp v84, v84, v84 row_ror:1 row_mask:0xf bank_mask:0xf
  v_add_f32_dpp v85, v85, v85 row_ror:1 row_mask:0xf bank_mask:0xf
  v_add_f32_dpp v86, v86, v86 row_ror:1 row_mask:0xf bank_mask:0xf
  v_add_f32_dpp v87, v87, v87 row_ror:1 row_mask:0xf bank_mask:0xf
  v_add_f32_dpp v88, v88, v88 row_ror:1 row_mask:0xf bank_mask:0xf
  v_add_f32_dpp v89, v89, v89 row_ror:1 row_mask:0xf bank_mask:0xf
  v_add_f32_dpp v90, v90, v90 row_ror:1 row_mask:0xf bank_mask:0xf
  v_add_f32_dpp v91, v91, v91 row_ror:1 row_mask:0xf bank_mask:0xf
  v_add_f32_dpp v92, v92, v92 row_ror:1 row_mask:0xf bank_mask:0xf
  v_add_f32_dpp v93, v93, v93 row_ror:1 row_mask:0xf bank_mask:0xf
  v_add_f32_dpp v94, v94, v94 row_ror:1 row_mask:0xf bank_mask:0xf
  v_add_f32_dpp v95, v95, v95 row_ror:1 row_mask:0xf bank_mask:0xf
  s_lshl_b32 s39, s36, 4
  s_add_u32 s39, s39, s37
  s_lshl_b32 s39, s39, 10
  s_lshl_b32 s31, s35, 7
  s_add_u32 s39, s39, s31
  v_lshlrev_b32 v5, 4, v4
  v_cmp_eq_u32 vcc, 0, v3
  s_and_saveexec_b64 s[56:57], vcc
  buffer_store_dwordx4 v[80:83], v5, s[16:19], s39 offen offset:0 sc0 sc1
  buffer_store_dwordx4 v[88:91], v5, s[16:19], s39 offen offset:512 sc0 sc1
  buffer_store_dwordx4 v[84:87], v5, s[16:19], s39 offen offset:64 sc0 sc1
  buffer_store_dwordx4 v[92:95], v5, s[16:19], s39 offen offset:576 sc0 sc1
  s_mov_b64 exec, s[56:57]
  v_mov_b32 v8, 0
  v_mov_b32 v9, 0
  v_mov_b32 v10, 0
  v_mov_b32 v11, 0
  v_mov_b32 v12, 0
  v_mov_b32 v13, 0
  v_mov_b32 v14, 0
  v_mov_b32 v15, 0
  v_mov_b32 v16, 0
  v_mov_b32 v17, 0
  v_mov_b32 v18, 0
  v_mov_b32 v19, 0
  v_mov_b32 v20, 0
  v_mov_b32 v21, 0
  v_mov_b32 v22, 0
  v_mov_b32 v23, 0
  v_mov_b32 v24, 0
  v_mov_b32 v25, 0
  v_mov_b32 v26, 0
  v_mov_b32 v27, 0
  v_mov_b32 v28, 0
  v_mov_b32 v29, 0
  v_mov_b32 v30, 0
  v_mov_b32 v31, 0
  v_mov_b32 v32, 0
  v_mov_b32 v33, 0
  v_mov_b32 v34, 0
  v_mov_b32 v35, 0
  v_mov_b32 v36, 0
  v_mov_b32 v37, 0
  v_mov_b32 v38, 0
  v_mov_b32 v39, 0
  v_mov_b32 v40, 0
  v_mov_b32 v41, 0
  v_mov_b32 v42, 0
  v_mov_b32 v43, 0
  v_mov_b32 v44, 0
  v_mov_b32 v45, 0
  v_mov_b32 v46, 0
  v_mov_b32 v47, 0
  v_mov_b32 v48, 0
  v_mov_b32 v49, 0
  v_mov_b32 v50, 0
  v_mov_b32 v51, 0
  v_mov_b32 v52, 0
  v_mov_b32 v53, 0
  v_mov_b32 v54, 0
  v_mov_b32 v55, 0
  v_mov_b32 v56, 0
  v_mov_b32 v57, 0
  v_mov_b32 v58, 0
  v_mov_b32 v59, 0
  v_mov_b32 v60, 0
  v_mov_b32 v61, 0
  v_mov_b32 v62, 0
  v_mov_b32 v63, 0
  v_mov_b32 v64, 0
  v_mov_b32 v65, 0
  v_mov_b32 v66, 0
  v_mov_b32 v67, 0
  v_mov_b32 v68, 0
  v_mov_b32 v69, 0
  v_mov_b32 v70, 0
  v_mov_b32 v71, 0
  v_mov_b32 v72, 0
  v_mov_b32 v73, 0
  v_mov_b32 v74, 0
  v_mov_b32 v75, 0
  v_mov_b32 v76, 0
  v_mov_b32 v77, 0
  v_mov_b32 v78, 0
  v_mov_b32 v79, 0
  v_lshlrev_b32 v254, 4, v2
  s_lshl_b32 s38, s36, 14
  s_lshl_b32 s31, s35, 12
  s_add_u32 s38, s38, s31
  s_waitcnt vmcnt(18)
  s_barrier
  ds_read_b64_tr_b16 v[80:81], v243 offset:0
  ds_read_b64_tr_b16 v[82:83], v243 offset:2304
  ds_read_b64_tr_b16 v[84:85], v243 offset:32
  ds_read_b64_tr_b16 v[86:87], v243 offset:2336
  ds_read_b64_tr_b16 v[88:89], v243 offset:64
  ds_read_b64_tr_b16 v[90:91], v243 offset:2368
  ds_read_b64_tr_b16 v[92:93], v243 offset:96
  ds_read_b64_tr_b16 v[94:95], v243 offset:2400
  ds_read_b64_tr_b16 v[96:97], v243 offset:128
  ds_read_b64_tr_b16 v[98:99], v243 offset:2432
  ds_read_b64_tr_b16 v[100:101], v243 offset:160
  ds_read_b64_tr_b16 v[102:103], v243 offset:2464
  ds_read_b64_tr_b16 v[104:105], v243 offset:192
  ds_read_b64_tr_b16 v[106:107], v243 offset:2496
  ds_read_b64_tr_b16 v[108:109], v243 offset:224
  ds_read_b64_tr_b16 v[110:111], v243 offset:2528
  ds_read_b64_tr_b16 v[112:113], v243 offset:256
  ds_read_b64_tr_b16 v[114:115], v243 offset:2560
  s_waitcnt vmcnt(23)
  s_waitcnt lgkmcnt(12)
  v_mfma_f32_16x16x32_bf16 v[8:11], v[80:83], v[152:155], v[8:11]
  ds_read_b64_tr_b16 v[116:117], v243 offset:9216
  ds_read_b64_tr_b16 v[118:119], v243 offset:11520
  v_mfma_f32_16x16x32_bf16 v[12:15], v[80:83], v[156:159], v[12:15]
  v_mfma_f32_16x16x32_bf16 v[16:19], v[84:87], v[152:155], v[16:19]
  ds_read_b64_tr_b16 v[120:121], v243 offset:9248
  ds_read_b64_tr_b16 v[122:123], v243 offset:11552
  v_mfma_f32_16x16x32_bf16 v[20:23], v[84:87], v[156:159], v[20:23]
  buffer_load_dwordx4 v[184:187], v236, s[8:11], s32 offen offset:0
  v_mfma_f32_16x16x32_bf16 v[24:27], v[88:91], v[152:155], v[24:27]
  ds_read_b64_tr_b16 v[124:125], v243 offset:9280
  ds_read_b64_tr_b16 v[126:127], v243 offset:11584
  v_mfma_f32_16x16x32_bf16 v[28:31], v[88:91], v[156:159], v[28:31]
  s_waitcnt lgkmcnt(12)
  v_mfma_f32_16x16x32_bf16 v[32:35], v[92:95], v[152:155], v[32:35]
  ds_read_b64_tr_b16 v[128:129], v243 offset:9312
  ds_read_b64_tr_b16 v[130:131], v243 offset:11616
  v_mfma_f32_16x16x32_bf16 v[36:39], v[92:95], v[156:159], v[36:39]
  buffer_load_dwordx4 v[188:191], v237, s[8:11], s32 offen offset:0
  v_mfma_f32_16x16x32_bf16 v[40:43], v[96:99], v[152:155], v[40:43]
  ds_read_b64_tr_b16 v[132:133], v243 offset:9344
  ds_read_b64_tr_b16 v[134:135], v243 offset:11648
  v_mfma_f32_16x16x32_bf16 v[44:47], v[96:99], v[156:159], v[44:47]
  v_mfma_f32_16x16x32_bf16 v[48:51], v[100:103], v[152:155], v[48:51]
  ds_read_b64_tr_b16 v[136:137], v243 offset:9376
  ds_read_b64_tr_b16 v[138:139], v243 offset:11680
  v_mfma_f32_16x16x32_bf16 v[52:55], v[100:103], v[156:159], v[52:55]
  buffer_load_dwordx4 v[192:195], v236, s[8:11], s32 offen offset:1024
  s_waitcnt lgkmcnt(12)
  v_mfma_f32_16x16x32_bf16 v[56:59], v[104:107], v[152:155], v[56:59]
  ds_read_b64_tr_b16 v[140:141], v243 offset:9408
  ds_read_b64_tr_b16 v[142:143], v243 offset:11712
  v_mfma_f32_16x16x32_bf16 v[60:63], v[104:107], v[156:159], v[60:63]
  v_mfma_f32_16x16x32_bf16 v[64:67], v[108:111], v[152:155], v[64:67]
  ds_read_b64_tr_b16 v[144:145], v243 offset:9440
  ds_read_b64_tr_b16 v[146:147], v243 offset:11744
  v_mfma_f32_16x16x32_bf16 v[68:71], v[108:111], v[156:159], v[68:71]
  buffer_load_dwordx4 v[196:199], v237, s[8:11], s32 offen offset:1024
  s_add_u32 s32, s32, 2048
  v_mfma_f32_16x16x32_bf16 v[72:75], v[112:115], v[152:155], v[72:75]
  ds_read_b64_tr_b16 v[148:149], v243 offset:9472
  ds_read_b64_tr_b16 v[150:151], v243 offset:11776
  v_mfma_f32_16x16x32_bf16 v[76:79], v[112:115], v[156:159], v[76:79]
  s_waitcnt lgkmcnt(12)
  v_mfma_f32_16x16x32_bf16 v[8:11], v[116:119], v[160:163], v[8:11]
  s_waitcnt vmcnt(13)
  s_barrier
  ds_read_b64_tr_b16 v[80:81], v243 offset:18432
  ds_read_b64_tr_b16 v[82:83], v243 offset:20736
  v_mfma_f32_16x16x32_bf16 v[12:15], v[116:119], v[164:167], v[12:15]
  v_mfma_f32_16x16x32_bf16 v[16:19], v[120:123], v[160:163], v[16:19]
  ds_read_b64_tr_b16 v[84:85], v243 offset:18464
  ds_read_b64_tr_b16 v[86:87], v243 offset:20768
  v_mfma_f32_16x16x32_bf16 v[20:23], v[120:123], v[164:167], v[20:23]
  s_add_u32 m0, s34, 55296
  s_mov_b64 exec, s[40:41]
  buffer_load_dwordx4 v238, s[12:15], s33 offen lds
  s_mov_b64 exec, -1
  v_mfma_f32_16x16x32_bf16 v[24:27], v[124:127], v[160:163], v[24:27]
  ds_read_b64_tr_b16 v[88:89], v243 offset:18496
  ds_read_b64_tr_b16 v[90:91], v243 offset:20800
  v_mfma_f32_16x16x32_bf16 v[28:31], v[124:127], v[164:167], v[28:31]
  s_waitcnt lgkmcnt(12)
  v_mfma_f32_16x16x32_bf16 v[32:35], v[128:131], v[160:163], v[32:35]
  ds_read_b64_tr_b16 v[92:93], v243 offset:18528
  ds_read_b64_tr_b16 v[94:95], v243 offset:20832
  v_mfma_f32_16x16x32_bf16 v[36:39], v[128:131], v[164:167], v[36:39]
  buffer_load_dwordx4 v239, s[12:15], s33 offen offset:512 lds
  v_mfma_f32_16x16x32_bf16 v[40:43], v[132:135], v[160:163], v[40:43]
  ds_read_b64_tr_b16 v[96:97], v243 offset:18560
  ds_read_b64_tr_b16 v[98:99], v243 offset:20864
  v_mfma_f32_16x16x32_bf16 v[44:47], v[132:135], v[164:167], v[44:47]
  v_mfma_f32_16x16x32_bf16 v[48:51], v[136:139], v[160:163], v[48:51]
  ds_read_b64_tr_b16 v[100:101], v243 offset:18592
  ds_read_b64_tr_b16 v[102:103], v243 offset:20896
  v_mfma_f32_16x16x32_bf16 v[52:55], v[136:139], v[164:167], v[52:55]
  buffer_load_dwordx4 v240, s[12:15], s33 offen offset:1536 lds
  s_waitcnt lgkmcnt(12)
  v_mfma_f32_16x16x32_bf16 v[56:59], v[140:143], v[160:163], v[56:59]
  ds_read_b64_tr_b16 v[104:105], v243 offset:18624
  ds_read_b64_tr_b16 v[106:107], v243 offset:20928
  v_mfma_f32_16x16x32_bf16 v[60:63], v[140:143], v[164:167], v[60:63]
  v_mfma_f32_16x16x32_bf16 v[64:67], v[144:147], v[160:163], v[64:67]
  ds_read_b64_tr_b16 v[108:109], v243 offset:18656
  ds_read_b64_tr_b16 v[110:111], v243 offset:20960
  v_mfma_f32_16x16x32_bf16 v[68:71], v[144:147], v[164:167], v[68:71]
  buffer_load_dwordx4 v241, s[12:15], s33 offen offset:2560 lds
  v_mfma_f32_16x16x32_bf16 v[72:75], v[148:151], v[160:163], v[72:75]
  ds_read_b64_tr_b16 v[112:113], v243 offset:18688
  ds_read_b64_tr_b16 v[114:115], v243 offset:20992
  v_mfma_f32_16x16x32_bf16 v[76:79], v[148:151], v[164:167], v[76:79]
  buffer_load_dwordx4 v242, s[12:15], s33 offen offset:3584 lds
  s_add_u32 s33, s33, 589824
  s_waitcnt vmcnt(23)
  s_waitcnt lgkmcnt(12)
  v_mfma_f32_16x16x32_bf16 v[8:11], v[80:83], v[168:171], v[8:11]
  ds_read_b64_tr_b16 v[116:117], v243 offset:27648
  ds_read_b64_tr_b16 v[118:119], v243 offset:29952
  v_mfma_f32_16x16x32_bf16 v[12:15], v[80:83], v[172:175], v[12:15]
  v_mfma_f32_16x16x32_bf16 v[16:19], v[84:87], v[168:171], v[16:19]
  ds_read_b64_tr_b16 v[120:121], v243 offset:27680
  ds_read_b64_tr_b16 v[122:123], v243 offset:29984
  v_mfma_f32_16x16x32_bf16 v[20:23], v[84:87], v[172:175], v[20:23]
  buffer_load_dwordx4 v[152:155], v236, s[8:11], s32 offen offset:0
  v_mfma_f32_16x16x32_bf16 v[24:27], v[88:91], v[168:171], v[24:27]
  ds_read_b64_tr_b16 v[124:125], v243 offset:27712
  ds_read_b64_tr_b16 v[126:127], v243 offset:30016
  v_mfma_f32_16x16x32_bf16 v[28:31], v[88:91], v[172:175], v[28:31]
  s_waitcnt lgkmcnt(12)
  v_mfma_f32_16x16x32_bf16 v[32:35], v[92:95], v[168:171], v[32:35]
  ds_read_b64_tr_b16 v[128:129], v243 offset:27744
  ds_read_b64_tr_b16 v[130:131], v243 offset:30048
  v_mfma_f32_16x16x32_bf16 v[36:39], v[92:95], v[172:175], v[36:39]
  buffer_load_dwordx4 v[156:159], v237, s[8:11], s32 offen offset:0
  v_mfma_f32_16x16x32_bf16 v[40:43], v[96:99], v[168:171], v[40:43]
  ds_read_b64_tr_b16 v[132:133], v243 offset:27776
  ds_read_b64_tr_b16 v[134:135], v243 offset:30080
  v_mfma_f32_16x16x32_bf16 v[44:47], v[96:99], v[172:175], v[44:47]
  v_mfma_f32_16x16x32_bf16 v[48:51], v[100:103], v[168:171], v[48:51]
  ds_read_b64_tr_b16 v[136:137], v243 offset:27808
  ds_read_b64_tr_b16 v[138:139], v243 offset:30112
  v_mfma_f32_16x16x32_bf16 v[52:55], v[100:103], v[172:175], v[52:55]
  buffer_load_dwordx4 v[160:163], v236, s[8:11], s32 offen offset:1024
  s_waitcnt lgkmcnt(12)
  v_mfma_f32_16x16x32_bf16 v[56:59], v[104:107], v[168:171], v[56:59]
  ds_read_b64_tr_b16 v[140:141], v243 offset:27840
  ds_read_b64_tr_b16 v[142:143], v243 offset:30144
  v_mfma_f32_16x16x32_bf16 v[60:63], v[104:107], v[172:175], v[60:63]
  v_mfma_f32_16x16x32_bf16 v[64:67], v[108:111], v[168:171], v[64:67]
  ds_read_b64_tr_b16 v[144:145], v243 offset:27872
  ds_read_b64_tr_b16 v[146:147], v243 offset:30176
  v_mfma_f32_16x16x32_bf16 v[68:71], v[108:111], v[172:175], v[68:71]
  buffer_load_dwordx4 v[164:167], v237, s[8:11], s32 offen offset:1024
  s_add_u32 s32, s32, 2048
  v_mfma_f32_16x16x32_bf16 v[72:75], v[112:115], v[168:171], v[72:75]
  ds_read_b64_tr_b16 v[148:149], v243 offset:27904
  ds_read_b64_tr_b16 v[150:151], v243 offset:30208
  v_mfma_f32_16x16x32_bf16 v[76:79], v[112:115], v[172:175], v[76:79]
  s_waitcnt lgkmcnt(12)
  v_mfma_f32_16x16x32_bf16 v[8:11], v[116:119], v[176:179], v[8:11]
  s_waitcnt vmcnt(17)
  s_barrier
  ds_read_b64_tr_b16 v[80:81], v244 offset:0
  ds_read_b64_tr_b16 v[82:83], v244 offset:2304
  v_mfma_f32_16x16x32_bf16 v[12:15], v[116:119], v[180:183], v[12:15]
  v_mfma_f32_16x16x32_bf16 v[16:19], v[120:123], v[176:179], v[16:19]
  ds_read_b64_tr_b16 v[84:85], v244 offset:32
  ds_read_b64_tr_b16 v[86:87], v244 offset:2336
  v_mfma_f32_16x16x32_bf16 v[20:23], v[120:123], v[180:183], v[20:23]
  s_add_u32 m0, s34, 0
  s_mov_b64 exec, s[40:41]
  buffer_load_dwordx4 v238, s[12:15], s33 offen lds
  s_mov_b64 exec, -1
  v_mfma_f32_16x16x32_bf16 v[24:27], v[124:127], v[176:179], v[24:27]
  ds_read_b64_tr_b16 v[88:89], v244 offset:64
  ds_read_b64_tr_b16 v[90:91], v244 offset:2368
  v_mfma_f32_16x16x32_bf16 v[28:31], v[124:127], v[180:183], v[28:31]
  s_waitcnt lgkmcnt(12)
  v_mfma_f32_16x16x32_bf16 v[32:35], v[128:131], v[176:179], v[32:35]
  ds_read_b64_tr_b16 v[92:93], v244 offset:96
  ds_read_b64_tr_b16 v[94:95], v244 offset:2400
  v_mfma_f32_16x16x32_bf16 v[36:39], v[128:131], v[180:183], v[36:39]
  buffer_load_dwordx4 v239, s[12:15], s33 offen offset:512 lds
  v_mfma_f32_16x16x32_bf16 v[40:43], v[132:135], v[176:179], v[40:43]
  ds_read_b64_tr_b16 v[96:97], v244 offset:128
  ds_read_b64_tr_b16 v[98:99], v244 offset:2432
  v_mfma_f32_16x16x32_bf16 v[44:47], v[132:135], v[180:183], v[44:47]
  v_mfma_f32_16x16x32_bf16 v[48:51], v[136:139], v[176:179], v[48:51]
  ds_read_b64_tr_b16 v[100:101], v244 offset:160
  ds_read_b64_tr_b16 v[102:103], v244 offset:2464
  v_mfma_f32_16x16x32_bf16 v[52:55], v[136:139], v[180:183], v[52:55]
  buffer_load_dwordx4 v240, s[12:15], s33 offen offset:1536 lds
  s_waitcnt lgkmcnt(12)
  v_mfma_f32_16x16x32_bf16 v[56:59], v[140:143], v[176:179], v[56:59]
  ds_read_b64_tr_b16 v[104:105], v244 offset:192
  ds_read_b64_tr_b16 v[106:107], v244 offset:2496
  v_mfma_f32_16x16x32_bf16 v[60:63], v[140:143], v[180:183], v[60:63]
  v_mfma_f32_16x16x32_bf16 v[64:67], v[144:147], v[176:179], v[64:67]
  ds_read_b64_tr_b16 v[108:109], v244 offset:224
  ds_read_b64_tr_b16 v[110:111], v244 offset:2528
  v_mfma_f32_16x16x32_bf16 v[68:71], v[144:147], v[180:183], v[68:71]
  buffer_load_dwordx4 v241, s[12:15], s33 offen offset:2560 lds
  v_mfma_f32_16x16x32_bf16 v[72:75], v[148:151], v[176:179], v[72:75]
  ds_read_b64_tr_b16 v[112:113], v244 offset:256
  ds_read_b64_tr_b16 v[114:115], v244 offset:2560
  v_mfma_f32_16x16x32_bf16 v[76:79], v[148:151], v[180:183], v[76:79]
  buffer_load_dwordx4 v242, s[12:15], s33 offen offset:3584 lds
  s_add_u32 s33, s33, 589824
  s_waitcnt vmcnt(14)
  s_waitcnt lgkmcnt(12)
  v_mfma_f32_16x16x32_bf16 v[8:11], v[80:83], v[184:187], v[8:11]
  ds_read_b64_tr_b16 v[116:117], v244 offset:9216
  ds_read_b64_tr_b16 v[118:119], v244 offset:11520
  v_mfma_f32_16x16x32_bf16 v[12:15], v[80:83], v[188:191], v[12:15]
  v_mfma_f32_16x16x32_bf16 v[16:19], v[84:87], v[184:187], v[16:19]
  ds_read_b64_tr_b16 v[120:121], v244 offset:9248
  ds_read_b64_tr_b16 v[122:123], v244 offset:11552
  v_mfma_f32_16x16x32_bf16 v[20:23], v[84:87], v[188:191], v[20:23]
  buffer_load_dwordx4 v[168:171], v236, s[8:11], s32 offen offset:0
  v_mfma_f32_16x16x32_bf16 v[24:27], v[88:91], v[184:187], v[24:27]
  ds_read_b64_tr_b16 v[124:125], v244 offset:9280
  ds_read_b64_tr_b16 v[126:127], v244 offset:11584
  v_mfma_f32_16x16x32_bf16 v[28:31], v[88:91], v[188:191], v[28:31]
  s_waitcnt lgkmcnt(12)
  v_mfma_f32_16x16x32_bf16 v[32:35], v[92:95], v[184:187], v[32:35]
  ds_read_b64_tr_b16 v[128:129], v244 offset:9312
  ds_read_b64_tr_b16 v[130:131], v244 offset:11616
  v_mfma_f32_16x16x32_bf16 v[36:39], v[92:95], v[188:191], v[36:39]
  buffer_load_dwordx4 v[172:175], v237, s[8:11], s32 offen offset:0
  v_mfma_f32_16x16x32_bf16 v[40:43], v[96:99], v[184:187], v[40:43]
  ds_read_b64_tr_b16 v[132:133], v244 offset:9344
  ds_read_b64_tr_b16 v[134:135], v244 offset:11648
  v_mfma_f32_16x16x32_bf16 v[44:47], v[96:99], v[188:191], v[44:47]
  v_mfma_f32_16x16x32_bf16 v[48:51], v[100:103], v[184:187], v[48:51]
  ds_read_b64_tr_b16 v[136:137], v244 offset:9376
  ds_read_b64_tr_b16 v[138:139], v244 offset:11680
  v_mfma_f32_16x16x32_bf16 v[52:55], v[100:103], v[188:191], v[52:55]
  buffer_load_dwordx4 v[176:179], v236, s[8:11], s32 offen offset:1024
  s_waitcnt lgkmcnt(12)
  v_mfma_f32_16x16x32_bf16 v[56:59], v[104:107], v[184:187], v[56:59]
  ds_read_b64_tr_b16 v[140:141], v244 offset:9408
  ds_read_b64_tr_b16 v[142:143], v244 offset:11712
  v_mfma_f32_16x16x32_bf16 v[60:63], v[104:107], v[188:191], v[60:63]
  v_mfma_f32_16x16x32_bf16 v[64:67], v[108:111], v[184:187], v[64:67]
  ds_read_b64_tr_b16 v[144:145], v244 offset:9440
  ds_read_b64_tr_b16 v[146:147], v244 offset:11744
  v_mfma_f32_16x16x32_bf16 v[68:71], v[108:111], v[188:191], v[68:71]
  buffer_load_dwordx4 v[180:183], v237, s[8:11], s32 offen offset:1024
  s_add_u32 s32, s32, 2048
  v_mfma_f32_16x16x32_bf16 v[72:75], v[112:115], v[184:187], v[72:75]
  ds_read_b64_tr_b16 v[148:149], v244 offset:9472
  ds_read_b64_tr_b16 v[150:151], v244 offset:11776
  v_mfma_f32_16x16x32_bf16 v[76:79], v[112:115], v[188:191], v[76:79]
  s_waitcnt lgkmcnt(12)
  v_mfma_f32_16x16x32_bf16 v[8:11], v[116:119], v[192:195], v[8:11]
  s_waitcnt vmcnt(13)
  s_barrier
  ds_read_b64_tr_b16 v[80:81], v244 offset:18432
  ds_read_b64_tr_b16 v[82:83], v244 offset:20736
  v_mfma_f32_16x16x32_bf16 v[12:15], v[116:119], v[196:199], v[12:15]
  v_mfma_f32_16x16x32_bf16 v[16:19], v[120:123], v[192:195], v[16:19]
  ds_read_b64_tr_b16 v[84:85], v244 offset:18464
  ds_read_b64_tr_b16 v[86:87], v244 offset:20768
  v_mfma_f32_16x16x32_bf16 v[20:23], v[120:123], v[196:199], v[20:23]
  s_add_u32 m0, s34, 18432
  s_mov_b64 exec, s[40:41]
  buffer_load_dwordx4 v238, s[12:15], s33 offen lds
  s_mov_b64 exec, -1
  v_mfma_f32_16x16x32_bf16 v[24:27], v[124:127], v[192:195], v[24:27]
  ds_read_b64_tr_b16 v[88:89], v244 offset:18496
  ds_read_b64_tr_b16 v[90:91], v244 offset:20800
  v_mfma_f32_16x16x32_bf16 v[28:31], v[124:127], v[196:199], v[28:31]
  s_waitcnt lgkmcnt(12)
  v_mfma_f32_16x16x32_bf16 v[32:35], v[128:131], v[192:195], v[32:35]
  ds_read_b64_tr_b16 v[92:93], v244 offset:18528
  ds_read_b64_tr_b16 v[94:95], v244 offset:20832
  v_mfma_f32_16x16x32_bf16 v[36:39], v[128:131], v[196:199], v[36:39]
  buffer_load_dwordx4 v239, s[12:15], s33 offen offset:512 lds
  v_mfma_f32_16x16x32_bf16 v[40:43], v[132:135], v[192:195], v[40:43]
  ds_read_b64_tr_b16 v[96:97], v244 offset:18560
  ds_read_b64_tr_b16 v[98:99], v244 offset:20864
  v_mfma_f32_16x16x32_bf16 v[44:47], v[132:135], v[196:199], v[44:47]
  v_mfma_f32_16x16x32_bf16 v[48:51], v[136:139], v[192:195], v[48:51]
  ds_read_b64_tr_b16 v[100:101], v244 offset:18592
  ds_read_b64_tr_b16 v[102:103], v244 offset:20896
  v_mfma_f32_16x16x32_bf16 v[52:55], v[136:139], v[196:199], v[52:55]
  buffer_load_dwordx4 v240, s[12:15], s33 offen offset:1536 lds
  s_waitcnt lgkmcnt(12)
  v_mfma_f32_16x16x32_bf16 v[56:59], v[140:143], v[192:195], v[56:59]
  ds_read_b64_tr_b16 v[104:105], v244 offset:18624
  ds_read_b64_tr_b16 v[106:107], v244 offset:20928
  v_mfma_f32_16x16x32_bf16 v[60:63], v[140:143], v[196:199], v[60:63]
  v_mfma_f32_16x16x32_bf16 v[64:67], v[144:147], v[192:195], v[64:67]
  ds_read_b64_tr_b16 v[108:109], v244 offset:18656
  ds_read_b64_tr_b16 v[110:111], v244 offset:20960
  v_mfma_f32_16x16x32_bf16 v[68:71], v[144:147], v[196:199], v[68:71]
  buffer_load_dwordx4 v241, s[12:15], s33 offen offset:2560 lds
  v_mfma_f32_16x16x32_bf16 v[72:75], v[148:151], v[192:195], v[72:75]
  ds_read_b64_tr_b16 v[112:113], v244 offset:18688
  ds_read_b64_tr_b16 v[114:115], v244 offset:20992
  v_mfma_f32_16x16x32_bf16 v[76:79], v[148:151], v[196:199], v[76:79]
  buffer_load_dwordx4 v242, s[12:15], s33 offen offset:3584 lds
  s_add_u32 s33, s33, 589824
  s_waitcnt vmcnt(14)
  s_waitcnt lgkmcnt(12)
  v_mfma_f32_16x16x32_bf16 v[8:11], v[80:83], v[152:155], v[8:11]
  ds_read_b64_tr_b16 v[116:117], v244 offset:27648
  ds_read_b64_tr_b16 v[118:119], v244 offset:29952
  v_mfma_f32_16x16x32_bf16 v[12:15], v[80:83], v[156:159], v[12:15]
  v_mfma_f32_16x16x32_bf16 v[16:19], v[84:87], v[152:155], v[16:19]
  ds_read_b64_tr_b16 v[120:121], v244 offset:27680
  ds_read_b64_tr_b16 v[122:123], v244 offset:29984
  v_mfma_f32_16x16x32_bf16 v[20:23], v[84:87], v[156:159], v[20:23]
  buffer_load_dwordx4 v[184:187], v236, s[8:11], s32 offen offset:0
  v_mfma_f32_16x16x32_bf16 v[24:27], v[88:91], v[152:155], v[24:27]
  ds_read_b64_tr_b16 v[124:125], v244 offset:27712
  ds_read_b64_tr_b16 v[126:127], v244 offset:30016
  v_mfma_f32_16x16x32_bf16 v[28:31], v[88:91], v[156:159], v[28:31]
  s_waitcnt lgkmcnt(12)
  v_mfma_f32_16x16x32_bf16 v[32:35], v[92:95], v[152:155], v[32:35]
  ds_read_b64_tr_b16 v[128:129], v244 offset:27744
  ds_read_b64_tr_b16 v[130:131], v244 offset:30048
  v_mfma_f32_16x16x32_bf16 v[36:39], v[92:95], v[156:159], v[36:39]
  buffer_load_dwordx4 v[188:191], v237, s[8:11], s32 offen offset:0
  v_mfma_f32_16x16x32_bf16 v[40:43], v[96:99], v[152:155], v[40:43]
  ds_read_b64_tr_b16 v[132:133], v244 offset:27776
  ds_read_b64_tr_b16 v[134:135], v244 offset:30080
  v_mfma_f32_16x16x32_bf16 v[44:47], v[96:99], v[156:159], v[44:47]
  v_mfma_f32_16x16x32_bf16 v[48:51], v[100:103], v[152:155], v[48:51]
  ds_read_b64_tr_b16 v[136:137], v244 offset:27808
  ds_read_b64_tr_b16 v[138:139], v244 offset:30112
  v_mfma_f32_16x16x32_bf16 v[52:55], v[100:103], v[156:159], v[52:55]
  buffer_load_dwordx4 v[192:195], v236, s[8:11], s32 offen offset:1024
  s_waitcnt lgkmcnt(12)
  v_mfma_f32_16x16x32_bf16 v[56:59], v[104:107], v[152:155], v[56:59]
  ds_read_b64_tr_b16 v[140:141], v244 offset:27840
  ds_read_b64_tr_b16 v[142:143], v244 offset:30144
  v_mfma_f32_16x16x32_bf16 v[60:63], v[104:107], v[156:159], v[60:63]
  v_mfma_f32_16x16x32_bf16 v[64:67], v[108:111], v[152:155], v[64:67]
  ds_read_b64_tr_b16 v[144:145], v244 offset:27872
  ds_read_b64_tr_b16 v[146:147], v244 offset:30176
  v_mfma_f32_16x16x32_bf16 v[68:71], v[108:111], v[156:159], v[68:71]
  buffer_load_dwordx4 v[196:199], v237, s[8:11], s32 offen offset:1024
  s_add_u32 s32, s32, 2048
  v_mfma_f32_16x16x32_bf16 v[72:75], v[112:115], v[152:155], v[72:75]
  ds_read_b64_tr_b16 v[148:149], v244 offset:27904
  ds_read_b64_tr_b16 v[150:151], v244 offset:30208
  v_mfma_f32_16x16x32_bf16 v[76:79], v[112:115], v[156:159], v[76:79]
  s_waitcnt lgkmcnt(12)
  v_mfma_f32_16x16x32_bf16 v[8:11], v[116:119], v[160:163], v[8:11]
  s_waitcnt vmcnt(13)
  s_barrier
  ds_read_b64_tr_b16 v[80:81], v243 offset:0
  ds_read_b64_tr_b16 v[82:83], v243 offset:2304
  v_mfma_f32_16x16x32_bf16 v[12:15], v[116:119], v[164:167], v[12:15]
  v_mfma_f32_16x16x32_bf16 v[16:19], v[120:123], v[160:163], v[16:19]
  ds_read_b64_tr_b16 v[84:85], v243 offset:32
  ds_read_b64_tr_b16 v[86:87], v243 offset:2336
  v_mfma_f32_16x16x32_bf16 v[20:23], v[120:123], v[164:167], v[20:23]
  s_add_u32 m0, s34, 36864
  s_mov_b64 exec, s[40:41]
  buffer_load_dwordx4 v238, s[12:15], s33 offen lds
  s_mov_b64 exec, -1
  v_mfma_f32_16x16x32_bf16 v[24:27], v[124:127], v[160:163], v[24:27]
  ds_read_b64_tr_b16 v[88:89], v243 offset:64
  ds_read_b64_tr_b16 v[90:91], v243 offset:2368
  v_mfma_f32_16x16x32_bf16 v[28:31], v[124:127], v[164:167], v[28:31]
  s_waitcnt lgkmcnt(12)
  v_mfma_f32_16x16x32_bf16 v[32:35], v[128:131], v[160:163], v[32:35]
  ds_read_b64_tr_b16 v[92:93], v243 offset:96
  ds_read_b64_tr_b16 v[94:95], v243 offset:2400
  v_mfma_f32_16x16x32_bf16 v[36:39], v[128:131], v[164:167], v[36:39]
  buffer_load_dwordx4 v239, s[12:15], s33 offen offset:512 lds
  v_mfma_f32_16x16x32_bf16 v[40:43], v[132:135], v[160:163], v[40:43]
  ds_read_b64_tr_b16 v[96:97], v243 offset:128
  ds_read_b64_tr_b16 v[98:99], v243 offset:2432
  v_mfma_f32_16x16x32_bf16 v[44:47], v[132:135], v[164:167], v[44:47]
  v_mfma_f32_16x16x32_bf16 v[48:51], v[136:139], v[160:163], v[48:51]
  ds_read_b64_tr_b16 v[100:101], v243 offset:160
  ds_read_b64_tr_b16 v[102:103], v243 offset:2464
  v_mfma_f32_16x16x32_bf16 v[52:55], v[136:139], v[164:167], v[52:55]
  buffer_load_dwordx4 v240, s[12:15], s33 offen offset:1536 lds
  s_waitcnt lgkmcnt(12)
  v_mfma_f32_16x16x32_bf16 v[56:59], v[140:143], v[160:163], v[56:59]
  ds_read_b64_tr_b16 v[104:105], v243 offset:192
  ds_read_b64_tr_b16 v[106:107], v243 offset:2496
  v_mfma_f32_16x16x32_bf16 v[60:63], v[140:143], v[164:167], v[60:63]
  v_mfma_f32_16x16x32_bf16 v[64:67], v[144:147], v[160:163], v[64:67]
  ds_read_b64_tr_b16 v[108:109], v243 offset:224
  ds_read_b64_tr_b16 v[110:111], v243 offset:2528
  v_mfma_f32_16x16x32_bf16 v[68:71], v[144:147], v[164:167], v[68:71]
  buffer_load_dwordx4 v241, s[12:15], s33 offen offset:2560 lds
  v_mfma_f32_16x16x32_bf16 v[72:75], v[148:151], v[160:163], v[72:75]
  ds_read_b64_tr_b16 v[112:113], v243 offset:256
  ds_read_b64_tr_b16 v[114:115], v243 offset:2560
  v_mfma_f32_16x16x32_bf16 v[76:79], v[148:151], v[164:167], v[76:79]
  buffer_load_dwordx4 v242, s[12:15], s33 offen offset:3584 lds
  s_add_u32 s33, s33, 589824
  s_waitcnt vmcnt(14)
  s_waitcnt lgkmcnt(12)
  v_mfma_f32_16x16x32_bf16 v[8:11], v[80:83], v[168:171], v[8:11]
  ds_read_b64_tr_b16 v[116:117], v243 offset:9216
  ds_read_b64_tr_b16 v[118:119], v243 offset:11520
  v_mfma_f32_16x16x32_bf16 v[12:15], v[80:83], v[172:175], v[12:15]
  v_mfma_f32_16x16x32_bf16 v[16:19], v[84:87], v[168:171], v[16:19]
  ds_read_b64_tr_b16 v[120:121], v243 offset:9248
  ds_read_b64_tr_b16 v[122:123], v243 offset:11552
  v_mfma_f32_16x16x32_bf16 v[20:23], v[84:87], v[172:175], v[20:23]
  buffer_load_dwordx4 v[152:155], v236, s[8:11], s32 offen offset:0
  v_mfma_f32_16x16x32_bf16 v[24:27], v[88:91], v[168:171], v[24:27]
  ds_read_b64_tr_b16 v[124:125], v243 offset:9280
  ds_read_b64_tr_b16 v[126:127], v243 offset:11584
  v_mfma_f32_16x16x32_bf16 v[28:31], v[88:91], v[172:175], v[28:31]
  s_waitcnt lgkmcnt(12)
  v_mfma_f32_16x16x32_bf16 v[32:35], v[92:95], v[168:171], v[32:35]
  ds_read_b64_tr_b16 v[128:129], v243 offset:9312
  ds_read_b64_tr_b16 v[130:131], v243 offset:11616
  v_mfma_f32_16x16x32_bf16 v[36:39], v[92:95], v[172:175], v[36:39]
  buffer_load_dwordx4 v[156:159], v237, s[8:11], s32 offen offset:0
  v_mfma_f32_16x16x32_bf16 v[40:43], v[96:99], v[168:171], v[40:43]
  ds_read_b64_tr_b16 v[132:133], v243 offset:9344
  ds_read_b64_tr_b16 v[134:135], v243 offset:11648
  v_mfma_f32_16x16x32_bf16 v[44:47], v[96:99], v[172:175], v[44:47]
  v_mfma_f32_16x16x32_bf16 v[48:51], v[100:103], v[168:171], v[48:51]
  ds_read_b64_tr_b16 v[136:137], v243 offset:9376
  ds_read_b64_tr_b16 v[138:139], v243 offset:11680
  v_mfma_f32_16x16x32_bf16 v[52:55], v[100:103], v[172:175], v[52:55]
  buffer_load_dwordx4 v[160:163], v236, s[8:11], s32 offen offset:1024
  s_waitcnt lgkmcnt(12)
  v_mfma_f32_16x16x32_bf16 v[56:59], v[104:107], v[168:171], v[56:59]
  ds_read_b64_tr_b16 v[140:141], v243 offset:9408
  ds_read_b64_tr_b16 v[142:143], v243 offset:11712
  v_mfma_f32_16x16x32_bf16 v[60:63], v[104:107], v[172:175], v[60:63]
  v_mfma_f32_16x16x32_bf16 v[64:67], v[108:111], v[168:171], v[64:67]
  ds_read_b64_tr_b16 v[144:145], v243 offset:9440
  ds_read_b64_tr_b16 v[146:147], v243 offset:11744
  v_mfma_f32_16x16x32_bf16 v[68:71], v[108:111], v[172:175], v[68:71]
  buffer_load_dwordx4 v[164:167], v237, s[8:11], s32 offen offset:1024
  s_add_u32 s32, s32, 2048
  v_mfma_f32_16x16x32_bf16 v[72:75], v[112:115], v[168:171], v[72:75]
  ds_read_b64_tr_b16 v[148:149], v243 offset:9472
  ds_read_b64_tr_b16 v[150:151], v243 offset:11776
  v_mfma_f32_16x16x32_bf16 v[76:79], v[112:115], v[172:175], v[76:79]
  s_waitcnt lgkmcnt(12)
  v_mfma_f32_16x16x32_bf16 v[8:11], v[116:119], v[176:179], v[8:11]
  s_waitcnt vmcnt(13)
  s_barrier
  ds_read_b64_tr_b16 v[80:81], v243 offset:18432
  ds_read_b64_tr_b16 v[82:83], v243 offset:20736
  v_mfma_f32_16x16x32_bf16 v[12:15], v[116:119], v[180:183], v[12:15]
  v_mfma_f32_16x16x32_bf16 v[16:19], v[120:123], v[176:179], v[16:19]
  ds_read_b64_tr_b16 v[84:85], v243 offset:18464
  ds_read_b64_tr_b16 v[86:87], v243 offset:20768
  v_mfma_f32_16x16x32_bf16 v[20:23], v[120:123], v[180:183], v[20:23]
  s_add_u32 m0, s34, 55296
  s_mov_b64 exec, s[40:41]
  buffer_load_dwordx4 v238, s[12:15], s33 offen lds
  s_mov_b64 exec, -1
  v_mfma_f32_16x16x32_bf16 v[24:27], v[124:127], v[176:179], v[24:27]
  ds_read_b64_tr_b16 v[88:89], v243 offset:18496
  ds_read_b64_tr_b16 v[90:91], v243 offset:20800
  v_mfma_f32_16x16x32_bf16 v[28:31], v[124:127], v[180:183], v[28:31]
  s_waitcnt lgkmcnt(12)
  v_mfma_f32_16x16x32_bf16 v[32:35], v[128:131], v[176:179], v[32:35]
  ds_read_b64_tr_b16 v[92:93], v243 offset:18528
  ds_read_b64_tr_b16 v[94:95], v243 offset:20832
  v_mfma_f32_16x16x32_bf16 v[36:39], v[128:131], v[180:183], v[36:39]
  buffer_load_dwordx4 v239, s[12:15], s33 offen offset:512 lds
  v_mfma_f32_16x16x32_bf16 v[40:43], v[132:135], v[176:179], v[40:43]
  ds_read_b64_tr_b16 v[96:97], v243 offset:18560
  ds_read_b64_tr_b16 v[98:99], v243 offset:20864
  v_mfma_f32_16x16x32_bf16 v[44:47], v[132:135], v[180:183], v[44:47]
  v_mfma_f32_16x16x32_bf16 v[48:51], v[136:139], v[176:179], v[48:51]
  ds_read_b64_tr_b16 v[100:101], v243 offset:18592
  ds_read_b64_tr_b16 v[102:103], v243 offset:20896
  v_mfma_f32_16x16x32_bf16 v[52:55], v[136:139], v[180:183], v[52:55]
  buffer_load_dwordx4 v240, s[12:15], s33 offen offset:1536 lds
  s_waitcnt lgkmcnt(12)
  v_mfma_f32_16x16x32_bf16 v[56:59], v[140:143], v[176:179], v[56:59]
  ds_read_b64_tr_b16 v[104:105], v243 offset:18624
  ds_read_b64_tr_b16 v[106:107], v243 offset:20928
  v_mfma_f32_16x16x32_bf16 v[60:63], v[140:143], v[180:183], v[60:63]
  v_mfma_f32_16x16x32_bf16 v[64:67], v[144:147], v[176:179], v[64:67]
  ds_read_b64_tr_b16 v[108:109], v243 offset:18656
  ds_read_b64_tr_b16 v[110:111], v243 offset:20960
  v_mfma_f32_16x16x32_bf16 v[68:71], v[144:147], v[180:183], v[68:71]
  buffer_load_dwordx4 v241, s[12:15], s33 offen offset:2560 lds
  v_mfma_f32_16x16x32_bf16 v[72:75], v[148:151], v[176:179], v[72:75]
  ds_read_b64_tr_b16 v[112:113], v243 offset:18688
  ds_read_b64_tr_b16 v[114:115], v243 offset:20992
  v_mfma_f32_16x16x32_bf16 v[76:79], v[148:151], v[180:183], v[76:79]
  buffer_load_dwordx4 v242, s[12:15], s33 offen offset:3584 lds
  s_add_u32 s33, s33, 589824
  s_waitcnt vmcnt(14)
  s_waitcnt lgkmcnt(12)
  v_mfma_f32_16x16x32_bf16 v[8:11], v[80:83], v[184:187], v[8:11]
  ds_read_b64_tr_b16 v[116:117], v243 offset:27648
  ds_read_b64_tr_b16 v[118:119], v243 offset:29952
  v_mfma_f32_16x16x32_bf16 v[12:15], v[80:83], v[188:191], v[12:15]
  v_mfma_f32_16x16x32_bf16 v[16:19], v[84:87], v[184:187], v[16:19]
  ds_read_b64_tr_b16 v[120:121], v243 offset:27680
  ds_read_b64_tr_b16 v[122:123], v243 offset:29984
  v_mfma_f32_16x16x32_bf16 v[20:23], v[84:87], v[188:191], v[20:23]
  buffer_load_dwordx4 v[168:171], v236, s[8:11], s32 offen offset:0
  v_mfma_f32_16x16x32_bf16 v[24:27], v[88:91], v[184:187], v[24:27]
  ds_read_b64_tr_b16 v[124:125], v243 offset:27712
  ds_read_b64_tr_b16 v[126:127], v243 offset:30016
  v_mfma_f32_16x16x32_bf16 v[28:31], v[88:91], v[188:191], v[28:31]
  s_waitcnt lgkmcnt(12)
  v_mfma_f32_16x16x32_bf16 v[32:35], v[92:95], v[184:187], v[32:35]
  ds_read_b64_tr_b16 v[128:129], v243 offset:27744
  ds_read_b64_tr_b16 v[130:131], v243 offset:30048
  v_mfma_f32_16x16x32_bf16 v[36:39], v[92:95], v[188:191], v[36:39]
  buffer_load_dwordx4 v[172:175], v237, s[8:11], s32 offen offset:0
  v_mfma_f32_16x16x32_bf16 v[40:43], v[96:99], v[184:187], v[40:43]
  ds_read_b64_tr_b16 v[132:133], v243 offset:27776
  ds_read_b64_tr_b16 v[134:135], v243 offset:30080
  v_mfma_f32_16x16x32_bf16 v[44:47], v[96:99], v[188:191], v[44:47]
  v_mfma_f32_16x16x32_bf16 v[48:51], v[100:103], v[184:187], v[48:51]
  ds_read_b64_tr_b16 v[136:137], v243 offset:27808
  ds_read_b64_tr_b16 v[138:139], v243 offset:30112
  v_mfma_f32_16x16x32_bf16 v[52:55], v[100:103], v[188:191], v[52:55]
  buffer_load_dwordx4 v[176:179], v236, s[8:11], s32 offen offset:1024
  s_waitcnt lgkmcnt(12)
  v_mfma_f32_16x16x32_bf16 v[56:59], v[104:107], v[184:187], v[56:59]
  ds_read_b64_tr_b16 v[140:141], v243 offset:27840
  ds_read_b64_tr_b16 v[142:143], v243 offset:30144
  v_mfma_f32_16x16x32_bf16 v[60:63], v[104:107], v[188:191], v[60:63]
  v_mfma_f32_16x16x32_bf16 v[64:67], v[108:111], v[184:187], v[64:67]
  ds_read_b64_tr_b16 v[144:145], v243 offset:27872
  ds_read_b64_tr_b16 v[146:147], v243 offset:30176
  v_mfma_f32_16x16x32_bf16 v[68:71], v[108:111], v[188:191], v[68:71]
  buffer_load_dwordx4 v[180:183], v237, s[8:11], s32 offen offset:1024
  s_add_u32 s32, s32, 2048
  v_mfma_f32_16x16x32_bf16 v[72:75], v[112:115], v[184:187], v[72:75]
  ds_read_b64_tr_b16 v[148:149], v243 offset:27904
  ds_read_b64_tr_b16 v[150:151], v243 offset:30208
  v_mfma_f32_16x16x32_bf16 v[76:79], v[112:115], v[188:191], v[76:79]
  s_waitcnt lgkmcnt(12)
  v_mfma_f32_16x16x32_bf16 v[8:11], v[116:119], v[192:195], v[8:11]
  s_waitcnt vmcnt(13)
  s_barrier
  ds_read_b64_tr_b16 v[80:81], v244 offset:0
  ds_read_b64_tr_b16 v[82:83], v244 offset:2304
  v_mfma_f32_16x16x32_bf16 v[12:15], v[116:119], v[196:199], v[12:15]
  v_mfma_f32_16x16x32_bf16 v[16:19], v[120:123], v[192:195], v[16:19]
  ds_read_b64_tr_b16 v[84:85], v244 offset:32
  ds_read_b64_tr_b16 v[86:87], v244 offset:2336
  v_mfma_f32_16x16x32_bf16 v[20:23], v[120:123], v[196:199], v[20:23]
  s_add_u32 m0, s34, 0
  s_mov_b64 exec, s[40:41]
  buffer_load_dwordx4 v238, s[12:15], s33 offen lds
  s_mov_b64 exec, -1
  v_mfma_f32_16x16x32_bf16 v[24:27], v[124:127], v[192:195], v[24:27]
  ds_read_b64_tr_b16 v[88:89], v244 offset:64
  ds_read_b64_tr_b16 v[90:91], v244 offset:2368
  v_mfma_f32_16x16x32_bf16 v[28:31], v[124:127], v[196:199], v[28:31]
  s_waitcnt lgkmcnt(12)
  v_mfma_f32_16x16x32_bf16 v[32:35], v[128:131], v[192:195], v[32:35]
  ds_read_b64_tr_b16 v[92:93], v244 offset:96
  ds_read_b64_tr_b16 v[94:95], v244 offset:2400
  v_mfma_f32_16x16x32_bf16 v[36:39], v[128:131], v[196:199], v[36:39]
  buffer_load_dwordx4 v239, s[12:15], s33 offen offset:512 lds
  v_mfma_f32_16x16x32_bf16 v[40:43], v[132:135], v[192:195], v[40:43]
  ds_read_b64_tr_b16 v[96:97], v244 offset:128
  ds_read_b64_tr_b16 v[98:99], v244 offset:2432
  v_mfma_f32_16x16x32_bf16 v[44:47], v[132:135], v[196:199], v[44:47]
  v_mfma_f32_16x16x32_bf16 v[48:51], v[136:139], v[192:195], v[48:51]
  ds_read_b64_tr_b16 v[100:101], v244 offset:160
  ds_read_b64_tr_b16 v[102:103], v244 offset:2464
  v_mfma_f32_16x16x32_bf16 v[52:55], v[136:139], v[196:199], v[52:55]
  buffer_load_dwordx4 v240, s[12:15], s33 offen offset:1536 lds
  s_waitcnt lgkmcnt(12)
  v_mfma_f32_16x16x32_bf16 v[56:59], v[140:143], v[192:195], v[56:59]
  ds_read_b64_tr_b16 v[104:105], v244 offset:192
  ds_read_b64_tr_b16 v[106:107], v244 offset:2496
  v_mfma_f32_16x16x32_bf16 v[60:63], v[140:143], v[196:199], v[60:63]
  v_mfma_f32_16x16x32_bf16 v[64:67], v[144:147], v[192:195], v[64:67]
  ds_read_b64_tr_b16 v[108:109], v244 offset:224
  ds_read_b64_tr_b16 v[110:111], v244 offset:2528
  v_mfma_f32_16x16x32_bf16 v[68:71], v[144:147], v[196:199], v[68:71]
  buffer_load_dwordx4 v241, s[12:15], s33 offen offset:2560 lds
  v_mfma_f32_16x16x32_bf16 v[72:75], v[148:151], v[192:195], v[72:75]
  ds_read_b64_tr_b16 v[112:113], v244 offset:256
  ds_read_b64_tr_b16 v[114:115], v244 offset:2560
  v_mfma_f32_16x16x32_bf16 v[76:79], v[148:151], v[196:199], v[76:79]
  buffer_load_dwordx4 v242, s[12:15], s33 offen offset:3584 lds
  s_add_u32 s33, s33, 589824
  s_waitcnt vmcnt(14)
  s_waitcnt lgkmcnt(12)
  v_mfma_f32_16x16x32_bf16 v[8:11], v[80:83], v[152:155], v[8:11]
  ds_read_b64_tr_b16 v[116:117], v244 offset:9216
  ds_read_b64_tr_b16 v[118:119], v244 offset:11520
  v_mfma_f32_16x16x32_bf16 v[12:15], v[80:83], v[156:159], v[12:15]
  v_mfma_f32_16x16x32_bf16 v[16:19], v[84:87], v[152:155], v[16:19]
  ds_read_b64_tr_b16 v[120:121], v244 offset:9248
  ds_read_b64_tr_b16 v[122:123], v244 offset:11552
  v_mfma_f32_16x16x32_bf16 v[20:23], v[84:87], v[156:159], v[20:23]
  buffer_load_dwordx4 v[184:187], v236, s[8:11], s32 offen offset:0
  v_mfma_f32_16x16x32_bf16 v[24:27], v[88:91], v[152:155], v[24:27]
  ds_read_b64_tr_b16 v[124:125], v244 offset:9280
  ds_read_b64_tr_b16 v[126:127], v244 offset:11584
  v_mfma_f32_16x16x32_bf16 v[28:31], v[88:91], v[156:159], v[28:31]
  s_waitcnt lgkmcnt(12)
  v_mfma_f32_16x16x32_bf16 v[32:35], v[92:95], v[152:155], v[32:35]
  ds_read_b64_tr_b16 v[128:129], v244 offset:9312
  ds_read_b64_tr_b16 v[130:131], v244 offset:11616
  v_mfma_f32_16x16x32_bf16 v[36:39], v[92:95], v[156:159], v[36:39]
  buffer_load_dwordx4 v[188:191], v237, s[8:11], s32 offen offset:0
  v_mfma_f32_16x16x32_bf16 v[40:43], v[96:99], v[152:155], v[40:43]
  ds_read_b64_tr_b16 v[132:133], v244 offset:9344
  ds_read_b64_tr_b16 v[134:135], v244 offset:11648
  v_mfma_f32_16x16x32_bf16 v[44:47], v[96:99], v[156:159], v[44:47]
  v_mfma_f32_16x16x32_bf16 v[48:51], v[100:103], v[152:155], v[48:51]
  ds_read_b64_tr_b16 v[136:137], v244 offset:9376
  ds_read_b64_tr_b16 v[138:139], v244 offset:11680
  v_mfma_f32_16x16x32_bf16 v[52:55], v[100:103], v[156:159], v[52:55]
  buffer_load_dwordx4 v[192:195], v236, s[8:11], s32 offen offset:1024
  s_waitcnt lgkmcnt(12)
  v_mfma_f32_16x16x32_bf16 v[56:59], v[104:107], v[152:155], v[56:59]
  ds_read_b64_tr_b16 v[140:141], v244 offset:9408
  ds_read_b64_tr_b16 v[142:143], v244 offset:11712
  v_mfma_f32_16x16x32_bf16 v[60:63], v[104:107], v[156:159], v[60:63]
  v_mfma_f32_16x16x32_bf16 v[64:67], v[108:111], v[152:155], v[64:67]
  ds_read_b64_tr_b16 v[144:145], v244 offset:9440
  ds_read_b64_tr_b16 v[146:147], v244 offset:11744
  v_mfma_f32_16x16x32_bf16 v[68:71], v[108:111], v[156:159], v[68:71]
  buffer_load_dwordx4 v[196:199], v237, s[8:11], s32 offen offset:1024
  s_add_u32 s32, s32, 2048
  v_mfma_f32_16x16x32_bf16 v[72:75], v[112:115], v[152:155], v[72:75]
  ds_read_b64_tr_b16 v[148:149], v244 offset:9472
  ds_read_b64_tr_b16 v[150:151], v244 offset:11776
  v_mfma_f32_16x16x32_bf16 v[76:79], v[112:115], v[156:159], v[76:79]
  s_waitcnt lgkmcnt(12)
  v_mfma_f32_16x16x32_bf16 v[8:11], v[116:119], v[160:163], v[8:11]
  s_waitcnt vmcnt(13)
  s_barrier
  ds_read_b64_tr_b16 v[80:81], v244 offset:18432
  ds_read_b64_tr_b16 v[82:83], v244 offset:20736
  v_mfma_f32_16x16x32_bf16 v[12:15], v[116:119], v[164:167], v[12:15]
  v_mfma_f32_16x16x32_bf16 v[16:19], v[120:123], v[160:163], v[16:19]
  ds_read_b64_tr_b16 v[84:85], v244 offset:18464
  ds_read_b64_tr_b16 v[86:87], v244 offset:20768
  v_mfma_f32_16x16x32_bf16 v[20:23], v[120:123], v[164:167], v[20:23]
  v_mfma_f32_16x16x32_bf16 v[24:27], v[124:127], v[160:163], v[24:27]
  ds_read_b64_tr_b16 v[88:89], v244 offset:18496
  ds_read_b64_tr_b16 v[90:91], v244 offset:20800
  v_mfma_f32_16x16x32_bf16 v[28:31], v[124:127], v[164:167], v[28:31]
  s_waitcnt lgkmcnt(12)
  v_mfma_f32_16x16x32_bf16 v[32:35], v[128:131], v[160:163], v[32:35]
  ds_read_b64_tr_b16 v[92:93], v244 offset:18528
  ds_read_b64_tr_b16 v[94:95], v244 offset:20832
  v_mfma_f32_16x16x32_bf16 v[36:39], v[128:131], v[164:167], v[36:39]
  v_mfma_f32_16x16x32_bf16 v[40:43], v[132:135], v[160:163], v[40:43]
  ds_read_b64_tr_b16 v[96:97], v244 offset:18560
  ds_read_b64_tr_b16 v[98:99], v244 offset:20864
  v_mfma_f32_16x16x32_bf16 v[44:47], v[132:135], v[164:167], v[44:47]
  v_mfma_f32_16x16x32_bf16 v[48:51], v[136:139], v[160:163], v[48:51]
  ds_read_b64_tr_b16 v[100:101], v244 offset:18592
  ds_read_b64_tr_b16 v[102:103], v244 offset:20896
  v_mfma_f32_16x16x32_bf16 v[52:55], v[136:139], v[164:167], v[52:55]
  s_waitcnt lgkmcnt(12)
  v_mfma_f32_16x16x32_bf16 v[56:59], v[140:143], v[160:163], v[56:59]
  ds_read_b64_tr_b16 v[104:105], v244 offset:18624
  ds_read_b64_tr_b16 v[106:107], v244 offset:20928
  v_mfma_f32_16x16x32_bf16 v[60:63], v[140:143], v[164:167], v[60:63]
  v_mfma_f32_16x16x32_bf16 v[64:67], v[144:147], v[160:163], v[64:67]
  ds_read_b64_tr_b16 v[108:109], v244 offset:18656
  ds_read_b64_tr_b16 v[110:111], v244 offset:20960
  v_mfma_f32_16x16x32_bf16 v[68:71], v[144:147], v[164:167], v[68:71]
  v_mfma_f32_16x16x32_bf16 v[72:75], v[148:151], v[160:163], v[72:75]
  ds_read_b64_tr_b16 v[112:113], v244 offset:18688
  ds_read_b64_tr_b16 v[114:115], v244 offset:20992
  v_mfma_f32_16x16x32_bf16 v[76:79], v[148:151], v[164:167], v[76:79]
  s_waitcnt vmcnt(9)
  s_waitcnt lgkmcnt(12)
  v_mfma_f32_16x16x32_bf16 v[8:11], v[80:83], v[168:171], v[8:11]
  ds_read_b64_tr_b16 v[116:117], v244 offset:27648
  ds_read_b64_tr_b16 v[118:119], v244 offset:29952
  v_mfma_f32_16x16x32_bf16 v[12:15], v[80:83], v[172:175], v[12:15]
  v_mfma_f32_16x16x32_bf16 v[16:19], v[84:87], v[168:171], v[16:19]
  ds_read_b64_tr_b16 v[120:121], v244 offset:27680
  ds_read_b64_tr_b16 v[122:123], v244 offset:29984
  v_mfma_f32_16x16x32_bf16 v[20:23], v[84:87], v[172:175], v[20:23]
  buffer_load_dwordx4 v[152:155], v254, s[16:19], s38 offen offset:0 sc0 sc1
  v_mfma_f32_16x16x32_bf16 v[24:27], v[88:91], v[168:171], v[24:27]
  ds_read_b64_tr_b16 v[124:125], v244 offset:27712
  ds_read_b64_tr_b16 v[126:127], v244 offset:30016
  v_mfma_f32_16x16x32_bf16 v[28:31], v[88:91], v[172:175], v[28:31]
  s_waitcnt lgkmcnt(12)
  v_mfma_f32_16x16x32_bf16 v[32:35], v[92:95], v[168:171], v[32:35]
  ds_read_b64_tr_b16 v[128:129], v244 offset:27744
  ds_read_b64_tr_b16 v[130:131], v244 offset:30048
  v_mfma_f32_16x16x32_bf16 v[36:39], v[92:95], v[172:175], v[36:39]
  buffer_load_dwordx4 v[156:159], v254, s[16:19], s38 offen offset:1024 sc0 sc1
  v_mfma_f32_16x16x32_bf16 v[40:43], v[96:99], v[168:171], v[40:43]
  ds_read_b64_tr_b16 v[132:133], v244 offset:27776
  ds_read_b64_tr_b16 v[134:135], v244 offset:30080
  v_mfma_f32_16x16x32_bf16 v[44:47], v[96:99], v[172:175], v[44:47]
  v_mfma_f32_16x16x32_bf16 v[48:51], v[100:103], v[168:171], v[48:51]
  ds_read_b64_tr_b16 v[136:137], v244 offset:27808
  ds_read_b64_tr_b16 v[138:139], v244 offset:30112
  v_mfma_f32_16x16x32_bf16 v[52:55], v[100:103], v[172:175], v[52:55]
  buffer_load_dwordx4 v[160:163], v254, s[16:19], s38 offen offset:2048 sc0 sc1
  s_waitcnt lgkmcnt(12)
  v_mfma_f32_16x16x32_bf16 v[56:59], v[104:107], v[168:171], v[56:59]
  ds_read_b64_tr_b16 v[140:141], v244 offset:27840
  ds_read_b64_tr_b16 v[142:143], v244 offset:30144
  v_mfma_f32_16x16x32_bf16 v[60:63], v[104:107], v[172:175], v[60:63]
  v_mfma_f32_16x16x32_bf16 v[64:67], v[108:111], v[168:171], v[64:67]
  ds_read_b64_tr_b16 v[144:145], v244 offset:27872
  ds_read_b64_tr_b16 v[146:147], v244 offset:30176
  v_mfma_f32_16x16x32_bf16 v[68:71], v[108:111], v[172:175], v[68:71]
  buffer_load_dwordx4 v[164:167], v254, s[16:19], s38 offen offset:3072 sc0 sc1
  v_mfma_f32_16x16x32_bf16 v[72:75], v[112:115], v[168:171], v[72:75]
  ds_read_b64_tr_b16 v[148:149], v244 offset:27904
  ds_read_b64_tr_b16 v[150:151], v244 offset:30208
  v_mfma_f32_16x16x32_bf16 v[76:79], v[112:115], v[172:175], v[76:79]
  s_waitcnt lgkmcnt(12)
  v_mfma_f32_16x16x32_bf16 v[8:11], v[116:119], v[176:179], v[8:11]
  s_waitcnt vmcnt(8)
  s_barrier
  ds_read_b64_tr_b16 v[80:81], v243 offset:0
  ds_read_b64_tr_b16 v[82:83], v243 offset:2304
  v_mfma_f32_16x16x32_bf16 v[12:15], v[116:119], v[180:183], v[12:15]
  v_mfma_f32_16x16x32_bf16 v[16:19], v[120:123], v[176:179], v[16:19]
  ds_read_b64_tr_b16 v[84:85], v243 offset:32
  ds_read_b64_tr_b16 v[86:87], v243 offset:2336
  v_mfma_f32_16x16x32_bf16 v[20:23], v[120:123], v[180:183], v[20:23]
  v_mfma_f32_16x16x32_bf16 v[24:27], v[124:127], v[176:179], v[24:27]
  ds_read_b64_tr_b16 v[88:89], v243 offset:64
  ds_read_b64_tr_b16 v[90:91], v243 offset:2368
  v_mfma_f32_16x16x32_bf16 v[28:31], v[124:127], v[180:183], v[28:31]
  s_waitcnt lgkmcnt(12)
  v_mfma_f32_16x16x32_bf16 v[32:35], v[128:131], v[176:179], v[32:35]
  ds_read_b64_tr_b16 v[92:93], v243 offset:96
  ds_read_b64_tr_b16 v[94:95], v243 offset:2400
  v_mfma_f32_16x16x32_bf16 v[36:39], v[128:131], v[180:183], v[36:39]
  v_mfma_f32_16x16x32_bf16 v[40:43], v[132:135], v[176:179], v[40:43]
  ds_read_b64_tr_b16 v[96:97], v243 offset:128
  ds_read_b64_tr_b16 v[98:99], v243 offset:2432
  v_mfma_f32_16x16x32_bf16 v[44:47], v[132:135], v[180:183], v[44:47]
  v_mfma_f32_16x16x32_bf16 v[48:51], v[136:139], v[176:179], v[48:51]
  ds_read_b64_tr_b16 v[100:101], v243 offset:160
  ds_read_b64_tr_b16 v[102:103], v243 offset:2464
  v_mfma_f32_16x16x32_bf16 v[52:55], v[136:139], v[180:183], v[52:55]
  s_waitcnt lgkmcnt(12)
  v_mfma_f32_16x16x32_bf16 v[56:59], v[140:143], v[176:179], v[56:59]
  ds_read_b64_tr_b16 v[104:105], v243 offset:192
  ds_read_b64_tr_b16 v[106:107], v243 offset:2496
  v_mfma_f32_16x16x32_bf16 v[60:63], v[140:143], v[180:183], v[60:63]
  v_mfma_f32_16x16x32_bf16 v[64:67], v[144:147], v[176:179], v[64:67]
  ds_read_b64_tr_b16 v[108:109], v243 offset:224
  ds_read_b64_tr_b16 v[110:111], v243 offset:2528
  v_mfma_f32_16x16x32_bf16 v[68:71], v[144:147], v[180:183], v[68:71]
  v_mfma_f32_16x16x32_bf16 v[72:75], v[148:151], v[176:179], v[72:75]
  ds_read_b64_tr_b16 v[112:113], v243 offset:256
  ds_read_b64_tr_b16 v[114:115], v243 offset:2560
  v_mfma_f32_16x16x32_bf16 v[76:79], v[148:151], v[180:183], v[76:79]
  s_waitcnt vmcnt(4)
  s_waitcnt lgkmcnt(12)
  v_mfma_f32_16x16x32_bf16 v[8:11], v[80:83], v[184:187], v[8:11]
  ds_read_b64_tr_b16 v[116:117], v243 offset:9216
  ds_read_b64_tr_b16 v[118:119], v243 offset:11520
  v_mfma_f32_16x16x32_bf16 v[12:15], v[80:83], v[188:191], v[12:15]
  v_mfma_f32_16x16x32_bf16 v[16:19], v[84:87], v[184:187], v[16:19]
  ds_read_b64_tr_b16 v[120:121], v243 offset:9248
  ds_read_b64_tr_b16 v[122:123], v243 offset:11552
  v_mfma_f32_16x16x32_bf16 v[20:23], v[84:87], v[188:191], v[20:23]
  v_mfma_f32_16x16x32_bf16 v[24:27], v[88:91], v[184:187], v[24:27]
  ds_read_b64_tr_b16 v[124:125], v243 offset:9280
  ds_read_b64_tr_b16 v[126:127], v243 offset:11584
  v_mfma_f32_16x16x32_bf16 v[28:31], v[88:91], v[188:191], v[28:31]
  s_waitcnt lgkmcnt(12)
  v_mfma_f32_16x16x32_bf16 v[32:35], v[92:95], v[184:187], v[32:35]
  ds_read_b64_tr_b16 v[128:129], v243 offset:9312
  ds_read_b64_tr_b16 v[130:131], v243 offset:11616
  v_mfma_f32_16x16x32_bf16 v[36:39], v[92:95], v[188:191], v[36:39]
  v_mfma_f32_16x16x32_bf16 v[40:43], v[96:99], v[184:187], v[40:43]
  ds_read_b64_tr_b16 v[132:133], v243 offset:9344
  ds_read_b64_tr_b16 v[134:135], v243 offset:11648
  v_mfma_f32_16x16x32_bf16 v[44:47], v[96:99], v[188:191], v[44:47]
  v_mfma_f32_16x16x32_bf16 v[48:51], v[100:103], v[184:187], v[48:51]
  ds_read_b64_tr_b16 v[136:137], v243 offset:9376
  ds_read_b64_tr_b16 v[138:139], v243 offset:11680
  v_mfma_f32_16x16x32_bf16 v[52:55], v[100:103], v[188:191], v[52:55]
  s_waitcnt lgkmcnt(12)
  v_mfma_f32_16x16x32_bf16 v[56:59], v[104:107], v[184:187], v[56:59]
  ds_read_b64_tr_b16 v[140:141], v243 offset:9408
  ds_read_b64_tr_b16 v[142:143], v243 offset:11712
  v_mfma_f32_16x16x32_bf16 v[60:63], v[104:107], v[188:191], v[60:63]
  v_mfma_f32_16x16x32_bf16 v[64:67], v[108:111], v[184:187], v[64:67]
  ds_read_b64_tr_b16 v[144:145], v243 offset:9440
  ds_read_b64_tr_b16 v[146:147], v243 offset:11744
  v_mfma_f32_16x16x32_bf16 v[68:71], v[108:111], v[188:191], v[68:71]
  v_mfma_f32_16x16x32_bf16 v[72:75], v[112:115], v[184:187], v[72:75]
  ds_read_b64_tr_b16 v[148:149], v243 offset:9472
  ds_read_b64_tr_b16 v[150:151], v243 offset:11776
  v_mfma_f32_16x16x32_bf16 v[76:79], v[112:115], v[188:191], v[76:79]
  s_waitcnt lgkmcnt(12)
  v_mfma_f32_16x16x32_bf16 v[8:11], v[116:119], v[192:195], v[8:11]
  v_mfma_f32_16x16x32_bf16 v[12:15], v[116:119], v[196:199], v[12:15]
  v_mfma_f32_16x16x32_bf16 v[16:19], v[120:123], v[192:195], v[16:19]
  v_mfma_f32_16x16x32_bf16 v[20:23], v[120:123], v[196:199], v[20:23]
  v_mfma_f32_16x16x32_bf16 v[24:27], v[124:127], v[192:195], v[24:27]
  v_mfma_f32_16x16x32_bf16 v[28:31], v[124:127], v[196:199], v[28:31]
  s_waitcnt lgkmcnt(6)
  v_mfma_f32_16x16x32_bf16 v[32:35], v[128:131], v[192:195], v[32:35]
  v_mfma_f32_16x16x32_bf16 v[36:39], v[128:131], v[196:199], v[36:39]
  v_mfma_f32_16x16x32_bf16 v[40:43], v[132:135], v[192:195], v[40:43]
  v_mfma_f32_16x16x32_bf16 v[44:47], v[132:135], v[196:199], v[44:47]
  v_mfma_f32_16x16x32_bf16 v[48:51], v[136:139], v[192:195], v[48:51]
  v_mfma_f32_16x16x32_bf16 v[52:55], v[136:139], v[196:199], v[52:55]
  s_waitcnt lgkmcnt(0)
  v_mfma_f32_16x16x32_bf16 v[56:59], v[140:143], v[192:195], v[56:59]
  v_mfma_f32_16x16x32_bf16 v[60:63], v[140:143], v[196:199], v[60:63]
  v_mfma_f32_16x16x32_bf16 v[64:67], v[144:147], v[192:195], v[64:67]
  v_mfma_f32_16x16x32_bf16 v[68:71], v[144:147], v[196:199], v[68:71]
  v_mfma_f32_16x16x32_bf16 v[72:75], v[148:151], v[192:195], v[72:75]
  v_mfma_f32_16x16x32_bf16 v[76:79], v[148:151], v[196:199], v[76:79]
  s_mov_b32 s58, 0x8000
  s_waitcnt vmcnt(0)
zst_1:
  v_max_u32 v6, v152, v153
  v_max_u32 v6, v6, v154
  v_max_u32 v6, v6, v155
  v_max_u32 v6, v6, v156
  v_max_u32 v6, v6, v157
  v_max_u32 v6, v6, v158
  v_max_u32 v6, v6, v159
  v_max_u32 v6, v6, v160
  v_max_u32 v6, v6, v161
  v_max_u32 v6, v6, v162
  v_max_u32 v6, v6, v163
  v_max_u32 v6, v6, v164
  v_max_u32 v6, v6, v165
  v_max_u32 v6, v6, v166
  v_max_u32 v6, v6, v167
  v_cmp_eq_u32 vcc, -1, v6
  s_cbranch_vccz zst_1_ok
  s_sleep 1
  buffer_load_dwordx4 v[152:155], v254, s[16:19], s38 offen offset:0 sc0 sc1
  buffer_load_dwordx4 v[156:159], v254, s[16:19], s38 offen offset:1024 sc0 sc1
  buffer_load_dwordx4 v[160:163], v254, s[16:19], s38 offen offset:2048 sc0 sc1
  buffer_load_dwordx4 v[164:167], v254, s[16:19], s38 offen offset:3072 sc0 sc1
  s_waitcnt vmcnt(0)
  s_sub_u32 s58, s58, 1
  s_cmp_lg_u32 s58, 0
  s_cbranch_scc1 zst_1
zst_1_ok:
  v_pk_add_f32 v[152:153], v[152:153], v[156:157]
  v_pk_add_f32 v[160:161], v[160:161], v[164:165]
  v_pk_add_f32 v[154:155], v[154:155], v[158:159]
  v_pk_add_f32 v[162:163], v[162:163], v[166:167]
  v_pk_add_f32 v[152:153], v[152:153], v[160:161]
  v_pk_add_f32 v[154:155], v[154:155], v[162:163]
  s_lshl_b32 s31, s35, 10
  v_add_u32 v7, s31, v254
  ds_write_b128 v7, v[152:155] offset:36864
  s_lshl_b32 s39, s36, 7
  s_lshl_b32 s31, s35, 5
  s_add_u32 s66, s39, s31
  s_lshl_b32 s39, s66, 12
  v_lshl_add_u32 v236, v2, 4, s39
  v_add_u32 v237, 0x10000, v236
  s_waitcnt lgkmcnt(0)
  s_barrier
  v_and_b32 v5, 127, v0
  v_lshlrev_b32 v7, 2, v5
  ds_read_b32 v82, v7 offset:36864
  ds_read_b32 v86, v7 offset:37376
  ds_read_b32 v83, v7 offset:37888
  ds_read_b32 v87, v7 offset:38400
  ds_read_b32 v84, v7 offset:38912
  ds_read_b32 v88, v7 offset:39424
  ds_read_b32 v85, v7 offset:39936
  ds_read_b32 v89, v7 offset:40448
  s_waitcnt lgkmcnt(0)
  v_add_f32 v80, v82, v83
  v_add_f32 v84, v84, v85
  v_add_f32 v80, v80, v84
  v_add_f32 v81, v86, v87
  v_add_f32 v88, v88, v89
  v_add_f32 v81, v81, v88
  v_mul_f32 v80, 0x39e38e39, v80
  v_mul_f32 v81, 0x39e38e39, v81
  v_fma_f32 v81, -v80, v80, v81
  v_max_f32 v81, 0, v81
  v_cvt_pk_bf16_f32 v81, v81, v81
  v_and_b32 v81, 0xffff0000, v81
  v_add_f32 v81, 0x3727c5ac, v81
  v_cvt_pk_bf16_f32 v81, v81, v81
  v_and_b32 v81, 0xffff0000, v81
  v_sqrt_f32 v81, v81
  s_nop 0
  v_cvt_pk_bf16_f32 v81, v81, v81
  v_and_b32 v81, 0xffff0000, v81
  v_cvt_pk_bf16_f32 v80, v80, v80
  v_and_b32 v80, 0xffff0000, v80
  v_rcp_f32 v81, v81
  v_lshlrev_b32 v7, 2, v5
  v_add_u32 v7, 74752, v7
  ds_write_b32 v7, v80
  ds_write_b32 v7, v81 offset:512
  s_waitcnt lgkmcnt(0)
  s_lshl_b32 s67, s36, 8
  s_add_u32 s67, s67, 10240
  s_cmp_eq_u32 s35, 0
  s_cbranch_scc0 wfx_3
  v_mov_b32 v248, s67
  s_mov_b32 s58, 0x8000
wf_2:
  buffer_load_dword v249, v248, s[44:47], 0 offen sc0 sc1
  s_waitcnt vmcnt(0)
  v_readfirstlane_b32 s59, v249
  s_cmp_ge_u32 s59, 16
  s_cbranch_scc1 wfx_3
  s_sleep 2
  s_sub_u32 s58, s58, 1
  s_cmp_lg_u32 s58, 0
  s_cbranch_scc1 wf_2
wfx_3:
  s_and_b32 s67, s37, 7
  s_lshl_b32 s67, s67, 8
  s_add_u32 s67, s67, 14336
  s_cmp_eq_u32 s35, 0
  s_cbranch_scc0 wfx_5
  v_mov_b32 v248, s67
  s_mov_b32 s58, 0x8000
wf_4:
  buffer_load_dword v249, v248, s[44:47], 0 offen sc0 sc1
  s_waitcnt vmcnt(0)
  v_readfirstlane_b32 s59, v249
  s_cmp_ge_u32 s59, 18
  s_cbranch_scc1 wfx_5
  s_sleep 2
  s_sub_u32 s58, s58, 1
  s_cmp_lg_u32 s58, 0
  s_cbranch_scc1 wf_4
wfx_5:
  s_barrier
  s_mov_b32 s32, 0
  buffer_load_dwordx4 v[152:155], v236, s[24:27], s32 offen offset:0 sc1
  buffer_load_dwordx4 v[156:159], v237, s[24:27], s32 offen offset:0 sc1
  buffer_load_dwordx4 v[160:163], v236, s[24:27], s32 offen offset:1024 sc1
  buffer_load_dwordx4 v[164:167], v237, s[24:27], s32 offen offset:1024 sc1
  s_add_u32 s32, s32, 2048
  buffer_load_dwordx4 v[168:171], v236, s[24:27], s32 offen offset:0 sc1
  buffer_load_dwordx4 v[172:175], v237, s[24:27], s32 offen offset:0 sc1
  buffer_load_dwordx4 v[176:179], v236, s[24:27], s32 offen offset:1024 sc1
  buffer_load_dwordx4 v[180:183], v237, s[24:27], s32 offen offset:1024 sc1
  s_add_u32 s32, s32, 2048
  s_lshl_b32 s31, s35, 7
  v_lshlrev_b32 v7, 4, v4
  v_add_u32 v7, s31, v7
  v_add_u32 v7, 74752, v7
  ds_read_b128 v[84:87], v7 offset:0
  ds_read_b128 v[92:95], v7 offset:512
  ds_read_b128 v[88:91], v7 offset:64
  ds_read_b128 v[96:99], v7 offset:576
  v_lshrrev_b32 v5, 1, v4
  v_and_b32 v6, 1, v4
  v_lshl_add_u32 v5, v6, 1, v5
  v_mul_u32_u24 v5, 36864, v5
  v_lshl_add_u32 v5, v3, 4, v5
  s_lshl_b32 s39, s36, 4
  s_lshl_b32 s31, s35, 2
  s_add_u32 s39, s39, s31
  s_mul_i32 s39, s39, 36864
  s_mul_i32 s31, s37, 2304
  s_add_u32 s39, s39, s31
  s_waitcnt lgkmcnt(0)
  v_lshlrev_b32 v116, 16, v200
  v_and_b32 v117, 0xffff0000, v200
  v_pk_add_f32 v[116:117], v[116:117], v[84:85] neg_lo:[0,1] neg_hi:[0,1]
  v_pk_mul_f32 v[116:117], v[116:117], v[92:93]
  v_cvt_pk_bf16_f32 v124, v116, v117
  v_lshlrev_b32 v118, 16, v201
  v_and_b32 v119, 0xffff0000, v201
  v_pk_add_f32 v[118:119], v[118:119], v[86:87] neg_lo:[0,1] neg_hi:[0,1]
  v_pk_mul_f32 v[118:119], v[118:119], v[94:95]
  v_cvt_pk_bf16_f32 v125, v118, v119
  v_lshlrev_b32 v120, 16, v202
  v_and_b32 v121, 0xffff0000, v202
  v_pk_add_f32 v[120:121], v[120:121], v[88:89] neg_lo:[0,1] neg_hi:[0,1]
  v_pk_mul_f32 v[120:121], v[120:121], v[96:97]
  v_cvt_pk_bf16_f32 v126, v120, v121
  v_lshlrev_b32 v122, 16, v203
  v_and_b32 v123, 0xffff0000, v203
  v_pk_add_f32 v[122:123], v[122:123], v[90:91] neg_lo:[0,1] neg_hi:[0,1]
  v_pk_mul_f32 v[122:123], v[122:123], v[98:99]
  v_cvt_pk_bf16_f32 v127, v122, v123
  s_nop 1
  v_permlane16_swap_b32 v124, v126
  v_permlane16_swap_b32 v125, v127
  buffer_store_dwordx4 v[124:127], v5, s[20:23], s39 offen offset:0 sc1
  v_lshlrev_b32 v116, 16, v204
  v_and_b32 v117, 0xffff0000, v204
  v_pk_add_f32 v[116:117], v[116:117], v[84:85] neg_lo:[0,1] neg_hi:[0,1]
  v_pk_mul_f32 v[116:117], v[116:117], v[92:93]
  v_cvt_pk_bf16_f32 v128, v116, v117
  v_lshlrev_b32 v118, 16, v205
  v_and_b32 v119, 0xffff0000, v205
  v_pk_add_f32 v[118:119], v[118:119], v[86:87] neg_lo:[0,1] neg_hi:[0,1]
  v_pk_mul_f32 v[118:119], v[118:119], v[94:95]
  v_cvt_pk_bf16_f32 v129, v118, v119
  v_lshlrev_b32 v120, 16, v206
  v_and_b32 v121, 0xffff0000, v206
  v_pk_add_f32 v[120:121], v[120:121], v[88:89] neg_lo:[0,1] neg_hi:[0,1]
  v_pk_mul_f32 v[120:121], v[120:121], v[96:97]
  v_cvt_pk_bf16_f32 v130, v120, v121
  v_lshlrev_b32 v122, 16, v207
  v_and_b32 v123, 0xffff0000, v207
  v_pk_add_f32 v[122:123], v[122:123], v[90:91] neg_lo:[0,1] neg_hi:[0,1]
  v_pk_mul_f32 v[122:123], v[122:123], v[98:99]
  v_cvt_pk_bf16_f32 v131, v122, v123
  s_nop 1
  v_permlane16_swap_b32 v128, v130
  v_permlane16_swap_b32 v129, v131
  buffer_store_dwordx4 v[128:131], v5, s[20:23], s39 offen offset:256 sc1
  v_lshlrev_b32 v116, 16, v208
  v_and_b32 v117, 0xffff0000, v208
  v_pk_add_f32 v[116:117], v[116:117], v[84:85] neg_lo:[0,1] neg_hi:[0,1]
  v_pk_mul_f32 v[116:117], v[116:117], v[92:93]
  v_cvt_pk_bf16_f32 v132, v116, v117
  v_lshlrev_b32 v118, 16, v209
  v_and_b32 v119, 0xffff0000, v209
  v_pk_add_f32 v[118:119], v[118:119], v[86:87] neg_lo:[0,1] neg_hi:[0,1]
  v_pk_mul_f32 v[118:119], v[118:119], v[94:95]
  v_cvt_pk_bf16_f32 v133, v118, v119
  v_lshlrev_b32 v120, 16, v210
  v_and_b32 v121, 0xffff0000, v210
  v_pk_add_f32 v[120:121], v[120:121], v[88:89] neg_lo:[0,1] neg_hi:[0,1]
  v_pk_mul_f32 v[120:121], v[120:121], v[96:97]
  v_cvt_pk_bf16_f32 v134, v120, v121
  v_lshlrev_b32 v122, 16, v211
  v_and_b32 v123, 0xffff0000, v211
  v_pk_add_f32 v[122:123], v[122:123], v[90:91] neg_lo:[0,1] neg_hi:[0,1]
  v_pk_mul_f32 v[122:123], v[122:123], v[98:99]
  v_cvt_pk_bf16_f32 v135, v122, v123
  s_nop 1
  v_permlane16_swap_b32 v132, v134
  v_permlane16_swap_b32 v133, v135
  buffer_store_dwordx4 v[132:135], v5, s[20:23], s39 offen offset:512 sc1
  v_lshlrev_b32 v116, 16, v212
  v_and_b32 v117, 0xffff0000, v212
  v_pk_add_f32 v[116:117], v[116:117], v[84:85] neg_lo:[0,1] neg_hi:[0,1]
  v_pk_mul_f32 v[116:117], v[116:117], v[92:93]
  v_cvt_pk_bf16_f32 v136, v116, v117
  v_lshlrev_b32 v118, 16, v213
  v_and_b32 v119, 0xffff0000, v213
  v_pk_add_f32 v[118:119], v[118:119], v[86:87] neg_lo:[0,1] neg_hi:[0,1]
  v_pk_mul_f32 v[118:119], v[118:119], v[94:95]
  v_cvt_pk_bf16_f32 v137, v118, v119
  v_lshlrev_b32 v120, 16, v214
  v_and_b32 v121, 0xffff0000, v214
  v_pk_add_f32 v[120:121], v[120:121], v[88:89] neg_lo:[0,1] neg_hi:[0,1]
  v_pk_mul_f32 v[120:121], v[120:121], v[96:97]
  v_cvt_pk_bf16_f32 v138, v120, v121
  v_lshlrev_b32 v122, 16, v215
  v_and_b32 v123, 0xffff0000, v215
  v_pk_add_f32 v[122:123], v[122:123], v[90:91] neg_lo:[0,1] neg_hi:[0,1]
  v_pk_mul_f32 v[122:123], v[122:123], v[98:99]
  v_cvt_pk_bf16_f32 v139, v122, v123
  s_nop 1
  v_permlane16_swap_b32 v136, v138
  v_permlane16_swap_b32 v137, v139
  buffer_store_dwordx4 v[136:139], v5, s[20:23], s39 offen offset:768 sc1
  v_lshlrev_b32 v116, 16, v216
  v_and_b32 v117, 0xffff0000, v216
  v_pk_add_f32 v[116:117], v[116:117], v[84:85] neg_lo:[0,1] neg_hi:[0,1]
  v_pk_mul_f32 v[116:117], v[116:117], v[92:93]
  v_cvt_pk_bf16_f32 v124, v116, v117
  v_lshlrev_b32 v118, 16, v217
  v_and_b32 v119, 0xffff0000, v217
  v_pk_add_f32 v[118:119], v[118:119], v[86:87] neg_lo:[0,1] neg_hi:[0,1]
  v_pk_mul_f32 v[118:119], v[118:119], v[94:95]
  v_cvt_pk_bf16_f32 v125, v118, v119
  v_lshlrev_b32 v120, 16, v218
  v_and_b32 v121, 0xffff0000, v218
  v_pk_add_f32 v[120:121], v[120:121], v[88:89] neg_lo:[0,1] neg_hi:[0,1]
  v_pk_mul_f32 v[120:121], v[120:121], v[96:97]
  v_cvt_pk_bf16_f32 v126, v120, v121
  v_lshlrev_b32 v122, 16, v219
  v_and_b32 v123, 0xffff0000, v219
  v_pk_add_f32 v[122:123], v[122:123], v[90:91] neg_lo:[0,1] neg_hi:[0,1]
  v_pk_mul_f32 v[122:123], v[122:123], v[98:99]
  v_cvt_pk_bf16_f32 v127, v122, v123
  s_nop 1
  v_permlane16_swap_b32 v124, v126
  v_permlane16_swap_b32 v125, v127
  buffer_store_dwordx4 v[124:127], v5, s[20:23], s39 offen offset:1024 sc1
  v_lshlrev_b32 v116, 16, v220
  v_and_b32 v117, 0xffff0000, v220
  v_pk_add_f32 v[116:117], v[116:117], v[84:85] neg_lo:[0,1] neg_hi:[0,1]
  v_pk_mul_f32 v[116:117], v[116:117], v[92:93]
  v_cvt_pk_bf16_f32 v128, v116, v117
  v_lshlrev_b32 v118, 16, v221
  v_and_b32 v119, 0xffff0000, v221
  v_pk_add_f32 v[118:119], v[118:119], v[86:87] neg_lo:[0,1] neg_hi:[0,1]
  v_pk_mul_f32 v[118:119], v[118:119], v[94:95]
  v_cvt_pk_bf16_f32 v129, v118, v119
  v_lshlrev_b32 v120, 16, v222
  v_and_b32 v121, 0xffff0000, v222
  v_pk_add_f32 v[120:121], v[120:121], v[88:89] neg_lo:[0,1] neg_hi:[0,1]
  v_pk_mul_f32 v[120:121], v[120:121], v[96:97]
  v_cvt_pk_bf16_f32 v130, v120, v121
  v_lshlrev_b32 v122, 16, v223
  v_and_b32 v123, 0xffff0000, v223
  v_pk_add_f32 v[122:123], v[122:123], v[90:91] neg_lo:[0,1] neg_hi:[0,1]
  v_pk_mul_f32 v[122:123], v[122:123], v[98:99]
  v_cvt_pk_bf16_f32 v131, v122, v123
  s_nop 1
  v_permlane16_swap_b32 v128, v130
  v_permlane16_swap_b32 v129, v131
  buffer_store_dwordx4 v[128:131], v5, s[20:23], s39 offen offset:1280 sc1
  v_lshlrev_b32 v116, 16, v224
  v_and_b32 v117, 0xffff0000, v224
  v_pk_add_f32 v[116:117], v[116:117], v[84:85] neg_lo:[0,1] neg_hi:[0,1]
  v_pk_mul_f32 v[116:117], v[116:117], v[92:93]
  v_cvt_pk_bf16_f32 v132, v116, v117
  v_lshlrev_b32 v118, 16, v225
  v_and_b32 v119, 0xffff0000, v225
  v_pk_add_f32 v[118:119], v[118:119], v[86:87] neg_lo:[0,1] neg_hi:[0,1]
  v_pk_mul_f32 v[118:119], v[118:119], v[94:95]
  v_cvt_pk_bf16_f32 v133, v118, v119
  v_lshlrev_b32 v120, 16, v226
  v_and_b32 v121, 0xffff0000, v226
  v_pk_add_f32 v[120:121], v[120:121], v[88:89] neg_lo:[0,1] neg_hi:[0,1]
  v_pk_mul_f32 v[120:121], v[120:121], v[96:97]
  v_cvt_pk_bf16_f32 v134, v120, v121
  v_lshlrev_b32 v122, 16, v227
  v_and_b32 v123, 0xffff0000, v227
  v_pk_add_f32 v[122:123], v[122:123], v[90:91] neg_lo:[0,1] neg_hi:[0,1]
  v_pk_mul_f32 v[122:123], v[122:123], v[98:99]
  v_cvt_pk_bf16_f32 v135, v122, v123
  s_nop 1
  v_permlane16_swap_b32 v132, v134
  v_permlane16_swap_b32 v133, v135
  buffer_store_dwordx4 v[132:135], v5, s[20:23], s39 offen offset:1536 sc1
  v_lshlrev_b32 v116, 16, v228
  v_and_b32 v117, 0xffff0000, v228
  v_pk_add_f32 v[116:117], v[116:117], v[84:85] neg_lo:[0,1] neg_hi:[0,1]
  v_pk_mul_f32 v[116:117], v[116:117], v[92:93]
  v_cvt_pk_bf16_f32 v136, v116, v117
  v_lshlrev_b32 v118, 16, v229
  v_and_b32 v119, 0xffff0000, v229
  v_pk_add_f32 v[118:119], v[118:119], v[86:87] neg_lo:[0,1] neg_hi:[0,1]
  v_pk_mul_f32 v[118:119], v[118:119], v[94:95]
  v_cvt_pk_bf16_f32 v137, v118, v119
  v_lshlrev_b32 v120, 16, v230
  v_and_b32 v121, 0xffff0000, v230
  v_pk_add_f32 v[120:121], v[120:121], v[88:89] neg_lo:[0,1] neg_hi:[0,1]
  v_pk_mul_f32 v[120:121], v[120:121], v[96:97]
  v_cvt_pk_bf16_f32 v138, v120, v121
  v_lshlrev_b32 v122, 16, v231
  v_and_b32 v123, 0xffff0000, v231
  v_pk_add_f32 v[122:123], v[122:123], v[90:91] neg_lo:[0,1] neg_hi:[0,1]
  v_pk_mul_f32 v[122:123], v[122:123], v[98:99]
  v_cvt_pk_bf16_f32 v139, v122, v123
  s_nop 1
  v_permlane16_swap_b32 v136, v138
  v_permlane16_swap_b32 v137, v139
  buffer_store_dwordx4 v[136:139], v5, s[20:23], s39 offen offset:1792 sc1
  v_lshlrev_b32 v116, 16, v232
  v_and_b32 v117, 0xffff0000, v232
  v_pk_add_f32 v[116:117], v[116:117], v[84:85] neg_lo:[0,1] neg_hi:[0,1]
  v_pk_mul_f32 v[116:117], v[116:117], v[92:93]
  v_cvt_pk_bf16_f32 v124, v116, v117
  v_lshlrev_b32 v118, 16, v233
  v_and_b32 v119, 0xffff0000, v233
  v_pk_add_f32 v[118:119], v[118:119], v[86:87] neg_lo:[0,1] neg_hi:[0,1]
  v_pk_mul_f32 v[118:119], v[118:119], v[94:95]
  v_cvt_pk_bf16_f32 v125, v118, v119
  v_lshlrev_b32 v120, 16, v234
  v_and_b32 v121, 0xffff0000, v234
  v_pk_add_f32 v[120:121], v[120:121], v[88:89] neg_lo:[0,1] neg_hi:[0,1]
  v_pk_mul_f32 v[120:121], v[120:121], v[96:97]
  v_cvt_pk_bf16_f32 v126, v120, v121
  v_lshlrev_b32 v122, 16, v235
  v_and_b32 v123, 0xffff0000, v235
  v_pk_add_f32 v[122:123], v[122:123], v[90:91] neg_lo:[0,1] neg_hi:[0,1]
  v_pk_mul_f32 v[122:123], v[122:123], v[98:99]
  v_cvt_pk_bf16_f32 v127, v122, v123
  s_nop 1
  v_permlane16_swap_b32 v124, v126
  v_permlane16_swap_b32 v125, v127
  buffer_store_dwordx4 v[124:127], v5, s[20:23], s39 offen offset:2048 sc1
  v_pk_mul_f32 v[248:249], v[8:9], v[8:9]
  v_pk_mul_f32 v[250:251], v[10:11], v[10:11]
  v_pk_mul_f32 v[252:253], v[12:13], v[12:13]
  v_pk_mul_f32 v[254:255], v[14:15], v[14:15]
  v_pk_fma_f32 v[248:249], v[248:249], s[42:43], v[246:247]
  v_pk_fma_f32 v[250:251], v[250:251], s[42:43], v[246:247]
  v_pk_fma_f32 v[252:253], v[252:253], s[42:43], v[246:247]
  v_pk_fma_f32 v[254:255], v[254:255], s[42:43], v[246:247]
  v_pk_mul_f32 v[248:249], v[248:249], v[8:9]
  v_pk_mul_f32 v[250:251], v[250:251], v[10:11]
  v_pk_mul_f32 v[252:253], v[252:253], v[12:13]
  v_pk_mul_f32 v[254:255], v[254:255], v[14:15]
  v_exp_f32 v248, v248
  v_exp_f32 v249, v249
  v_exp_f32 v250, v250
  v_exp_f32 v251, v251
  v_exp_f32 v252, v252
  v_exp_f32 v253, v253
  v_exp_f32 v254, v254
  v_exp_f32 v255, v255
  v_pk_add_f32 v[248:249], v[248:249], s[52:53]
  v_pk_add_f32 v[250:251], v[250:251], s[52:53]
  v_pk_add_f32 v[252:253], v[252:253], s[52:53]
  v_pk_add_f32 v[254:255], v[254:255], s[52:53]
  v_rcp_f32 v248, v248
  v_rcp_f32 v249, v249
  v_rcp_f32 v250, v250
  v_rcp_f32 v251, v251
  v_rcp_f32 v252, v252
  v_rcp_f32 v253, v253
  v_rcp_f32 v254, v254
  v_rcp_f32 v255, v255
  s_nop 0
  v_pk_mul_f32 v[8:9], v[8:9], v[248:249]
  v_pk_mul_f32 v[10:11], v[10:11], v[250:251]
  v_pk_mul_f32 v[12:13], v[12:13], v[252:253]
  v_pk_mul_f32 v[14:15], v[14:15], v[254:255]
  v_cvt_pk_bf16_f32 v200, v8, v9
  v_cvt_pk_bf16_f32 v201, v10, v11
  v_cvt_pk_bf16_f32 v202, v12, v13
  v_cvt_pk_bf16_f32 v203, v14, v15
  v_pk_mul_f32 v[248:249], v[16:17], v[16:17]
  v_pk_mul_f32 v[250:251], v[18:19], v[18:19]
  v_pk_mul_f32 v[252:253], v[20:21], v[20:21]
  v_pk_mul_f32 v[254:255], v[22:23], v[22:23]
  v_pk_fma_f32 v[248:249], v[248:249], s[42:43], v[246:247]
  v_pk_fma_f32 v[250:251], v[250:251], s[42:43], v[246:247]
  v_pk_fma_f32 v[252:253], v[252:253], s[42:43], v[246:247]
  v_pk_fma_f32 v[254:255], v[254:255], s[42:43], v[246:247]
  v_pk_mul_f32 v[248:249], v[248:249], v[16:17]
  v_pk_mul_f32 v[250:251], v[250:251], v[18:19]
  v_pk_mul_f32 v[252:253], v[252:253], v[20:21]
  v_pk_mul_f32 v[254:255], v[254:255], v[22:23]
  v_exp_f32 v248, v248
  v_exp_f32 v249, v249
  v_exp_f32 v250, v250
  v_exp_f32 v251, v251
  v_exp_f32 v252, v252
  v_exp_f32 v253, v253
  v_exp_f32 v254, v254
  v_exp_f32 v255, v255
  v_pk_add_f32 v[248:249], v[248:249], s[52:53]
  v_pk_add_f32 v[250:251], v[250:251], s[52:53]
  v_pk_add_f32 v[252:253], v[252:253], s[52:53]
  v_pk_add_f32 v[254:255], v[254:255], s[52:53]
  v_rcp_f32 v248, v248
  v_rcp_f32 v249, v249
  v_rcp_f32 v250, v250
  v_rcp_f32 v251, v251
  v_rcp_f32 v252, v252
  v_rcp_f32 v253, v253
  v_rcp_f32 v254, v254
  v_rcp_f32 v255, v255
  s_nop 0
  v_pk_mul_f32 v[16:17], v[16:17], v[248:249]
  v_pk_mul_f32 v[18:19], v[18:19], v[250:251]
  v_pk_mul_f32 v[20:21], v[20:21], v[252:253]
  v_pk_mul_f32 v[22:23], v[22:23], v[254:255]
  v_cvt_pk_bf16_f32 v204, v16, v17
  v_cvt_pk_bf16_f32 v205, v18, v19
  v_cvt_pk_bf16_f32 v206, v20, v21
  v_cvt_pk_bf16_f32 v207, v22, v23
  v_pk_mul_f32 v[248:249], v[24:25], v[24:25]
  v_pk_mul_f32 v[250:251], v[26:27], v[26:27]
  v_pk_mul_f32 v[252:253], v[28:29], v[28:29]
  v_pk_mul_f32 v[254:255], v[30:31], v[30:31]
  v_pk_fma_f32 v[248:249], v[248:249], s[42:43], v[246:247]
  v_pk_fma_f32 v[250:251], v[250:251], s[42:43], v[246:247]
  v_pk_fma_f32 v[252:253], v[252:253], s[42:43], v[246:247]
  v_pk_fma_f32 v[254:255], v[254:255], s[42:43], v[246:247]
  v_pk_mul_f32 v[248:249], v[248:249], v[24:25]
  v_pk_mul_f32 v[250:251], v[250:251], v[26:27]
  v_pk_mul_f32 v[252:253], v[252:253], v[28:29]
  v_pk_mul_f32 v[254:255], v[254:255], v[30:31]
  v_exp_f32 v248, v248
  v_exp_f32 v249, v249
  v_exp_f32 v250, v250
  v_exp_f32 v251, v251
  v_exp_f32 v252, v252
  v_exp_f32 v253, v253
  v_exp_f32 v254, v254
  v_exp_f32 v255, v255
  v_pk_add_f32 v[248:249], v[248:249], s[52:53]
  v_pk_add_f32 v[250:251], v[250:251], s[52:53]
  v_pk_add_f32 v[252:253], v[252:253], s[52:53]
  v_pk_add_f32 v[254:255], v[254:255], s[52:53]
  v_rcp_f32 v248, v248
  v_rcp_f32 v249, v249
  v_rcp_f32 v250, v250
  v_rcp_f32 v251, v251
  v_rcp_f32 v252, v252
  v_rcp_f32 v253, v253
  v_rcp_f32 v254, v254
  v_rcp_f32 v255, v255
  s_nop 0
  v_pk_mul_f32 v[24:25], v[24:25], v[248:249]
  v_pk_mul_f32 v[26:27], v[26:27], v[250:251]
  v_pk_mul_f32 v[28:29], v[28:29], v[252:253]
  v_pk_mul_f32 v[30:31], v[30:31], v[254:255]
  v_cvt_pk_bf16_f32 v208, v24, v25
  v_cvt_pk_bf16_f32 v209, v26, v27
  v_cvt_pk_bf16_f32 v210, v28, v29
  v_cvt_pk_bf16_f32 v211, v30, v31
  v_pk_mul_f32 v[248:249], v[32:33], v[32:33]
  v_pk_mul_f32 v[250:251], v[34:35], v[34:35]
  v_pk_mul_f32 v[252:253], v[36:37], v[36:37]
  v_pk_mul_f32 v[254:255], v[38:39], v[38:39]
  v_pk_fma_f32 v[248:249], v[248:249], s[42:43], v[246:247]
  v_pk_fma_f32 v[250:251], v[250:251], s[42:43], v[246:247]
  v_pk_fma_f32 v[252:253], v[252:253], s[42:43], v[246:247]
  v_pk_fma_f32 v[254:255], v[254:255], s[42:43], v[246:247]
  v_pk_mul_f32 v[248:249], v[248:249], v[32:33]
  v_pk_mul_f32 v[250:251], v[250:251], v[34:35]
  v_pk_mul_f32 v[252:253], v[252:253], v[36:37]
  v_pk_mul_f32 v[254:255], v[254:255], v[38:39]
  v_exp_f32 v248, v248
  v_exp_f32 v249, v249
  v_exp_f32 v250, v250
  v_exp_f32 v251, v251
  v_exp_f32 v252, v252
  v_exp_f32 v253, v253
  v_exp_f32 v254, v254
  v_exp_f32 v255, v255
  v_pk_add_f32 v[248:249], v[248:249], s[52:53]
  v_pk_add_f32 v[250:251], v[250:251], s[52:53]
  v_pk_add_f32 v[252:253], v[252:253], s[52:53]
  v_pk_add_f32 v[254:255], v[254:255], s[52:53]
  v_rcp_f32 v248, v248
  v_rcp_f32 v249, v249
  v_rcp_f32 v250, v250
  v_rcp_f32 v251, v251
  v_rcp_f32 v252, v252
  v_rcp_f32 v253, v253
  v_rcp_f32 v254, v254
  v_rcp_f32 v255, v255
  s_nop 0
  v_pk_mul_f32 v[32:33], v[32:33], v[248:249]
  v_pk_mul_f32 v[34:35], v[34:35], v[250:251]
  v_pk_mul_f32 v[36:37], v[36:37], v[252:253]
  v_pk_mul_f32 v[38:39], v[38:39], v[254:255]
  v_cvt_pk_bf16_f32 v212, v32, v33
  v_cvt_pk_bf16_f32 v213, v34, v35
  v_cvt_pk_bf16_f32 v214, v36, v37
  v_cvt_pk_bf16_f32 v215, v38, v39
  v_pk_mul_f32 v[248:249], v[40:41], v[40:41]
  v_pk_mul_f32 v[250:251], v[42:43], v[42:43]
  v_pk_mul_f32 v[252:253], v[44:45], v[44:45]
  v_pk_mul_f32 v[254:255], v[46:47], v[46:47]
  v_pk_fma_f32 v[248:249], v[248:249], s[42:43], v[246:247]
  v_pk_fma_f32 v[250:251], v[250:251], s[42:43], v[246:247]
  v_pk_fma_f32 v[252:253], v[252:253], s[42:43], v[246:247]
  v_pk_fma_f32 v[254:255], v[254:255], s[42:43], v[246:247]
  v_pk_mul_f32 v[248:249], v[248:249], v[40:41]
  v_pk_mul_f32 v[250:251], v[250:251], v[42:43]
  v_pk_mul_f32 v[252:253], v[252:253], v[44:45]
  v_pk_mul_f32 v[254:255], v[254:255], v[46:47]
  v_exp_f32 v248, v248
  v_exp_f32 v249, v249
  v_exp_f32 v250, v250
  v_exp_f32 v251, v251
  v_exp_f32 v252, v252
  v_exp_f32 v253, v253
  v_exp_f32 v254, v254
  v_exp_f32 v255, v255
  v_pk_add_f32 v[248:249], v[248:249], s[52:53]
  v_pk_add_f32 v[250:251], v[250:251], s[52:53]
  v_pk_add_f32 v[252:253], v[252:253], s[52:53]
  v_pk_add_f32 v[254:255], v[254:255], s[52:53]
  v_rcp_f32 v248, v248
  v_rcp_f32 v249, v249
  v_rcp_f32 v250, v250
  v_rcp_f32 v251, v251
  v_rcp_f32 v252, v252
  v_rcp_f32 v253, v253
  v_rcp_f32 v254, v254
  v_rcp_f32 v255, v255
  s_nop 0
  v_pk_mul_f32 v[40:41], v[40:41], v[248:249]
  v_pk_mul_f32 v[42:43], v[42:43], v[250:251]
  v_pk_mul_f32 v[44:45], v[44:45], v[252:253]
  v_pk_mul_f32 v[46:47], v[46:47], v[254:255]
  v_cvt_pk_bf16_f32 v216, v40, v41
  v_cvt_pk_bf16_f32 v217, v42, v43
  v_cvt_pk_bf16_f32 v218, v44, v45
  v_cvt_pk_bf16_f32 v219, v46, v47
  v_pk_mul_f32 v[248:249], v[48:49], v[48:49]
  v_pk_mul_f32 v[250:251], v[50:51], v[50:51]
  v_pk_mul_f32 v[252:253], v[52:53], v[52:53]
  v_pk_mul_f32 v[254:255], v[54:55], v[54:55]
  v_pk_fma_f32 v[248:249], v[248:249], s[42:43], v[246:247]
  v_pk_fma_f32 v[250:251], v[250:251], s[42:43], v[246:247]
  v_pk_fma_f32 v[252:253], v[252:253], s[42:43], v[246:247]
  v_pk_fma_f32 v[254:255], v[254:255], s[42:43], v[246:247]
  v_pk_mul_f32 v[248:249], v[248:249], v[48:49]
  v_pk_mul_f32 v[250:251], v[250:251], v[50:51]
  v_pk_mul_f32 v[252:253], v[252:253], v[52:53]
  v_pk_mul_f32 v[254:255], v[254:255], v[54:55]
  v_exp_f32 v248, v248
  v_exp_f32 v249, v249
  v_exp_f32 v250, v250
  v_exp_f32 v251, v251
  v_exp_f32 v252, v252
  v_exp_f32 v253, v253
  v_exp_f32 v254, v254
  v_exp_f32 v255, v255
  v_pk_add_f32 v[248:249], v[248:249], s[52:53]
  v_pk_add_f32 v[250:251], v[250:251], s[52:53]
  v_pk_add_f32 v[252:253], v[252:253], s[52:53]
  v_pk_add_f32 v[254:255], v[254:255], s[52:53]
  v_rcp_f32 v248, v248
  v_rcp_f32 v249, v249
  v_rcp_f32 v250, v250
  v_rcp_f32 v251, v251
  v_rcp_f32 v252, v252
  v_rcp_f32 v253, v253
  v_rcp_f32 v254, v254
  v_rcp_f32 v255, v255
  s_nop 0
  v_pk_mul_f32 v[48:49], v[48:49], v[248:249]
  v_pk_mul_f32 v[50:51], v[50:51], v[250:251]
  v_pk_mul_f32 v[52:53], v[52:53], v[252:253]
  v_pk_mul_f32 v[54:55], v[54:55], v[254:255]
  v_cvt_pk_bf16_f32 v220, v48, v49
  v_cvt_pk_bf16_f32 v221, v50, v51
  v_cvt_pk_bf16_f32 v222, v52, v53
  v_cvt_pk_bf16_f32 v223, v54, v55
  v_pk_mul_f32 v[248:249], v[56:57], v[56:57]
  v_pk_mul_f32 v[250:251], v[58:59], v[58:59]
  v_pk_mul_f32 v[252:253], v[60:61], v[60:61]
  v_pk_mul_f32 v[254:255], v[62:63], v[62:63]
  v_pk_fma_f32 v[248:249], v[248:249], s[42:43], v[246:247]
  v_pk_fma_f32 v[250:251], v[250:251], s[42:43], v[246:247]
  v_pk_fma_f32 v[252:253], v[252:253], s[42:43], v[246:247]
  v_pk_fma_f32 v[254:255], v[254:255], s[42:43], v[246:247]
  v_pk_mul_f32 v[248:249], v[248:249], v[56:57]
  v_pk_mul_f32 v[250:251], v[250:251], v[58:59]
  v_pk_mul_f32 v[252:253], v[252:253], v[60:61]
  v_pk_mul_f32 v[254:255], v[254:255], v[62:63]
  v_exp_f32 v248, v248
  v_exp_f32 v249, v249
  v_exp_f32 v250, v250
  v_exp_f32 v251, v251
  v_exp_f32 v252, v252
  v_exp_f32 v253, v253
  v_exp_f32 v254, v254
  v_exp_f32 v255, v255
  v_pk_add_f32 v[248:249], v[248:249], s[52:53]
  v_pk_add_f32 v[250:251], v[250:251], s[52:53]
  v_pk_add_f32 v[252:253], v[252:253], s[52:53]
  v_pk_add_f32 v[254:255], v[254:255], s[52:53]
  v_rcp_f32 v248, v248
  v_rcp_f32 v249, v249
  v_rcp_f32 v250, v250
  v_rcp_f32 v251, v251
  v_rcp_f32 v252, v252
  v_rcp_f32 v253, v253
  v_rcp_f32 v254, v254
  v_rcp_f32 v255, v255
  s_nop 0
  v_pk_mul_f32 v[56:57], v[56:57], v[248:249]
  v_pk_mul_f32 v[58:59], v[58:59], v[250:251]
  v_pk_mul_f32 v[60:61], v[60:61], v[252:253]
  v_pk_mul_f32 v[62:63], v[62:63], v[254:255]
  v_cvt_pk_bf16_f32 v224, v56, v57
  v_cvt_pk_bf16_f32 v225, v58, v59
  v_cvt_pk_bf16_f32 v226, v60, v61
  v_cvt_pk_bf16_f32 v227, v62, v63
  v_pk_mul_f32 v[248:249], v[64:65], v[64:65]
  v_pk_mul_f32 v[250:251], v[66:67], v[66:67]
  v_pk_mul_f32 v[252:253], v[68:69], v[68:69]
  v_pk_mul_f32 v[254:255], v[70:71], v[70:71]
  v_pk_fma_f32 v[248:249], v[248:249], s[42:43], v[246:247]
  v_pk_fma_f32 v[250:251], v[250:251], s[42:43], v[246:247]
  v_pk_fma_f32 v[252:253], v[252:253], s[42:43], v[246:247]
  v_pk_fma_f32 v[254:255], v[254:255], s[42:43], v[246:247]
  v_pk_mul_f32 v[248:249], v[248:249], v[64:65]
  v_pk_mul_f32 v[250:251], v[250:251], v[66:67]
  v_pk_mul_f32 v[252:253], v[252:253], v[68:69]
  v_pk_mul_f32 v[254:255], v[254:255], v[70:71]
  v_exp_f32 v248, v248
  v_exp_f32 v249, v249
  v_exp_f32 v250, v250
  v_exp_f32 v251, v251
  v_exp_f32 v252, v252
  v_exp_f32 v253, v253
  v_exp_f32 v254, v254
  v_exp_f32 v255, v255
  v_pk_add_f32 v[248:249], v[248:249], s[52:53]
  v_pk_add_f32 v[250:251], v[250:251], s[52:53]
  v_pk_add_f32 v[252:253], v[252:253], s[52:53]
  v_pk_add_f32 v[254:255], v[254:255], s[52:53]
  v_rcp_f32 v248, v248
  v_rcp_f32 v249, v249
  v_rcp_f32 v250, v250
  v_rcp_f32 v251, v251
  v_rcp_f32 v252, v252
  v_rcp_f32 v253, v253
  v_rcp_f32 v254, v254
  v_rcp_f32 v255, v255
  s_nop 0
  v_pk_mul_f32 v[64:65], v[64:65], v[248:249]
  v_pk_mul_f32 v[66:67], v[66:67], v[250:251]
  v_pk_mul_f32 v[68:69], v[68:69], v[252:253]
  v_pk_mul_f32 v[70:71], v[70:71], v[254:255]
  v_cvt_pk_bf16_f32 v228, v64, v65
  v_cvt_pk_bf16_f32 v229, v66, v67
  v_cvt_pk_bf16_f32 v230, v68, v69
  v_cvt_pk_bf16_f32 v231, v70, v71
  v_pk_mul_f32 v[248:249], v[72:73], v[72:73]
  v_pk_mul_f32 v[250:251], v[74:75], v[74:75]
  v_pk_mul_f32 v[252:253], v[76:77], v[76:77]
  v_pk_mul_f32 v[254:255], v[78:79], v[78:79]
  v_pk_fma_f32 v[248:249], v[248:249], s[42:43], v[246:247]
  v_pk_fma_f32 v[250:251], v[250:251], s[42:43], v[246:247]
  v_pk_fma_f32 v[252:253], v[252:253], s[42:43], v[246:247]
  v_pk_fma_f32 v[254:255], v[254:255], s[42:43], v[246:247]
  v_pk_mul_f32 v[248:249], v[248:249], v[72:73]
  v_pk_mul_f32 v[250:251], v[250:251], v[74:75]
  v_pk_mul_f32 v[252:253], v[252:253], v[76:77]
  v_pk_mul_f32 v[254:255], v[254:255], v[78:79]
  v_exp_f32 v248, v248
  v_exp_f32 v249, v249
  v_exp_f32 v250, v250
  v_exp_f32 v251, v251
  v_exp_f32 v252, v252
  v_exp_f32 v253, v253
  v_exp_f32 v254, v254
  v_exp_f32 v255, v255
  v_pk_add_f32 v[248:249], v[248:249], s[52:53]
  v_pk_add_f32 v[250:251], v[250:251], s[52:53]
  v_pk_add_f32 v[252:253], v[252:253], s[52:53]
  v_pk_add_f32 v[254:255], v[254:255], s[52:53]
  v_rcp_f32 v248, v248
  v_rcp_f32 v249, v249
  v_rcp_f32 v250, v250
  v_rcp_f32 v251, v251
  v_rcp_f32 v252, v252
  v_rcp_f32 v253, v253
  v_rcp_f32 v254, v254
  v_rcp_f32 v255, v255
  s_nop 0
  v_pk_mul_f32 v[72:73], v[72:73], v[248:249]
  v_pk_mul_f32 v[74:75], v[74:75], v[250:251]
  v_pk_mul_f32 v[76:77], v[76:77], v[252:253]
  v_pk_mul_f32 v[78:79], v[78:79], v[254:255]
  v_cvt_pk_bf16_f32 v232, v72, v73
  v_cvt_pk_bf16_f32 v233, v74, v75
  v_cvt_pk_bf16_f32 v234, v76, v77
  v_cvt_pk_bf16_f32 v235, v78, v79
  s_lshl_b32 s67, s37, 8
  s_waitcnt vmcnt(0)
  s_barrier
  s_cmp_eq_u32 s35, 0
  s_cbranch_scc0 sig_6
  v_mov_b32 v248, s67
  s_mov_b64 s[56:57], exec
  s_mov_b64 exec, 1
  v_mov_b32 v249, 1
  buffer_atomic_add v249, v248, s[44:47], 0 offen sc1
  s_mov_b64 exec, s[56:57]
sig_6:
  s_mul_i32 s39, s35, 73728
  s_mul_i32 s30, s37, 2304
  s_add_u32 s39, s39, s30
  v_lshl_add_u32 v238, v2, 4, s39
  v_add_u32 v239, 34560, v238
  v_cmp_le_u32 vcc, 48, v2
  s_nop 1
  v_cndmask_b32 v240, v238, v239, vcc
  v_mul_u32_u24 v5, 2304, v4
  v_lshl_add_u32 v243, v3, 4, v5
  v_add_u32 v244, 36864, v243
  v_mov_b32 v8, 0
  v_mov_b32 v9, 0
  v_mov_b32 v10, 0
  v_mov_b32 v11, 0
  v_mov_b32 v12, 0
  v_mov_b32 v13, 0
  v_mov_b32 v14, 0
  v_mov_b32 v15, 0
  v_mov_b32 v16, 0
  v_mov_b32 v17, 0
  v_mov_b32 v18, 0
  v_mov_b32 v19, 0
  v_mov_b32 v20, 0
  v_mov_b32 v21, 0
  v_mov_b32 v22, 0
  v_mov_b32 v23, 0
  v_mov_b32 v24, 0
  v_mov_b32 v25, 0
  v_mov_b32 v26, 0
  v_mov_b32 v27, 0
  v_mov_b32 v28, 0
  v_mov_b32 v29, 0
  v_mov_b32 v30, 0
  v_mov_b32 v31, 0
  v_mov_b32 v32, 0
  v_mov_b32 v33, 0
  v_mov_b32 v34, 0
  v_mov_b32 v35, 0
  v_mov_b32 v36, 0
  v_mov_b32 v37, 0
  v_mov_b32 v38, 0
  v_mov_b32 v39, 0
  v_mov_b32 v40, 0
  v_mov_b32 v41, 0
  v_mov_b32 v42, 0
  v_mov_b32 v43, 0
  v_mov_b32 v44, 0
  v_mov_b32 v45, 0
  v_mov_b32 v46, 0
  v_mov_b32 v47, 0
  v_mov_b32 v48, 0
  v_mov_b32 v49, 0
  v_mov_b32 v50, 0
  v_mov_b32 v51, 0
  v_mov_b32 v52, 0
  v_mov_b32 v53, 0
  v_mov_b32 v54, 0
  v_mov_b32 v55, 0
  v_mov_b32 v56, 0
  v_mov_b32 v57, 0
  v_mov_b32 v58, 0
  v_mov_b32 v59, 0
  v_mov_b32 v60, 0
  v_mov_b32 v61, 0
  v_mov_b32 v62, 0
  v_mov_b32 v63, 0
  v_mov_b32 v64, 0
  v_mov_b32 v65, 0
  v_mov_b32 v66, 0
  v_mov_b32 v67, 0
  v_mov_b32 v68, 0
  v_mov_b32 v69, 0
  v_mov_b32 v70, 0
  v_mov_b32 v71, 0
  v_mov_b32 v72, 0
  v_mov_b32 v73, 0
  v_mov_b32 v74, 0
  v_mov_b32 v75, 0
  v_mov_b32 v76, 0
  v_mov_b32 v77, 0
  v_mov_b32 v78, 0
  v_mov_b32 v79, 0
  v_add_u32 v5, s66, v3
  v_lshlrev_b32 v5, 1, v5
  buffer_load_ushort v254, v5, s[48:51], 0 offen
  buffer_load_ushort v255, v5, s[48:51], 0 offen offset:32
  s_cmp_eq_u32 s35, 0
  s_cbranch_scc0 wfx_8
  v_mov_b32 v248, s67
  s_mov_b32 s58, 0x8000
wf_7:
  buffer_load_dword v249, v248, s[44:47], 0 offen sc0 sc1
  s_waitcnt vmcnt(0)
  v_readfirstlane_b32 s59, v249
  s_cmp_ge_u32 s59, 16
  s_cbranch_scc1 wfx_8
  s_sleep 2
  s_sub_u32 s58, s58, 1
  s_cmp_lg_u32 s58, 0
  s_cbranch_scc1 wf_7
wfx_8:
  s_barrier
  s_waitcnt vmcnt(0)
  s_mov_b32 s33, 0
  s_add_u32 m0, s34, 0
  s_mov_b64 exec, s[40:41]
  buffer_load_dwordx4 v238, s[20:23], s33 offen sc1 lds
  s_mov_b64 exec, -1
  buffer_load_dwordx4 v238, s[20:23], s33 offen offset:512 sc1 lds
  buffer_load_dwordx4 v240, s[20:23], s33 offen offset:1536 sc1 lds
  buffer_load_dwordx4 v239, s[20:23], s33 offen offset:2560 sc1 lds
  buffer_load_dwordx4 v239, s[20:23], s33 offen offset:3584 sc1 lds
  s_add_u32 s33, s33, 294912
  s_add_u32 m0, s34, 18432
  s_mov_b64 exec, s[40:41]
  buffer_load_dwordx4 v238, s[20:23], s33 offen sc1 lds
  s_mov_b64 exec, -1
  buffer_load_dwordx4 v238, s[20:23], s33 offen offset:512 sc1 lds
  buffer_load_dwordx4 v240, s[20:23], s33 offen offset:1536 sc1 lds
  buffer_load_dwordx4 v239, s[20:23], s33 offen offset:2560 sc1 lds
  buffer_load_dwordx4 v239, s[20:23], s33 offen offset:3584 sc1 lds
  s_add_u32 s33, s33, 294912
  s_add_u32 m0, s34, 36864
  s_mov_b64 exec, s[40:41]
  buffer_load_dwordx4 v238, s[20:23], s33 offen sc1 lds
  s_mov_b64 exec, -1
  buffer_load_dwordx4 v238, s[20:23], s33 offen offset:512 sc1 lds
  buffer_load_dwordx4 v240, s[20:23], s33 offen offset:1536 sc1 lds
  buffer_load_dwordx4 v239, s[20:23], s33 offen offset:2560 sc1 lds
  buffer_load_dwordx4 v239, s[20:23], s33 offen offset:3584 sc1 lds
  s_add_u32 s33, s33, 294912
  s_waitcnt vmcnt(10)
  s_barrier
  ds_read_b128 v[80:83], v243 offset:0
  ds_read_b128 v[84:87], v243 offset:256
  ds_read_b128 v[88:91], v243 offset:512
  ds_read_b128 v[92:95], v243 offset:768
  ds_read_b128 v[96:99], v243 offset:1024
  ds_read_b128 v[100:103], v243 offset:1280
  ds_read_b128 v[104:107], v243 offset:1536
  ds_read_b128 v[108:111], v243 offset:1792
  ds_read_b128 v[112:115], v243 offset:2048
  s_mov_b32 s54, 2
.p2align 6
loop_9:
  s_waitcnt vmcnt(14)
  s_waitcnt lgkmcnt(6)
  v_mfma_f32_16x16x32_bf16 v[8:11], v[80:83], v[152:155], v[8:11]
  ds_read_b128 v[116:119], v243 offset:9216
  v_mfma_f32_16x16x32_bf16 v[12:15], v[80:83], v[156:159], v[12:15]
  v_mfma_f32_16x16x32_bf16 v[16:19], v[84:87], v[152:155], v[16:19]
  ds_read_b128 v[120:123], v243 offset:9472
  v_mfma_f32_16x16x32_bf16 v[20:23], v[84:87], v[156:159], v[20:23]
  buffer_load_dwordx4 v[184:187], v236, s[24:27], s32 offen offset:0 sc1
  v_mfma_f32_16x16x32_bf16 v[24:27], v[88:91], v[152:155], v[24:27]
  ds_read_b128 v[124:127], v243 offset:9728
  v_mfma_f32_16x16x32_bf16 v[28:31], v[88:91], v[156:159], v[28:31]
  s_waitcnt lgkmcnt(6)
  v_mfma_f32_16x16x32_bf16 v[32:35], v[92:95], v[152:155], v[32:35]
  ds_read_b128 v[128:131], v243 offset:9984
  v_mfma_f32_16x16x32_bf16 v[36:39], v[92:95], v[156:159], v[36:39]
  buffer_load_dwordx4 v[188:191], v237, s[24:27], s32 offen offset:0 sc1
  v_mfma_f32_16x16x32_bf16 v[40:43], v[96:99], v[152:155], v[40:43]
  ds_read_b128 v[132:135], v243 offset:10240
  v_mfma_f32_16x16x32_bf16 v[44:47], v[96:99], v[156:159], v[44:47]
  v_mfma_f32_16x16x32_bf16 v[48:51], v[100:103], v[152:155], v[48:51]
  ds_read_b128 v[136:139], v243 offset:10496
  v_mfma_f32_16x16x32_bf16 v[52:55], v[100:103], v[156:159], v[52:55]
  buffer_load_dwordx4 v[192:195], v236, s[24:27], s32 offen offset:1024 sc1
  s_waitcnt lgkmcnt(6)
  v_mfma_f32_16x16x32_bf16 v[56:59], v[104:107], v[152:155], v[56:59]
  ds_read_b128 v[140:143], v243 offset:10752
  v_mfma_f32_16x16x32_bf16 v[60:63], v[104:107], v[156:159], v[60:63]
  v_mfma_f32_16x16x32_bf16 v[64:67], v[108:111], v[152:155], v[64:67]
  ds_read_b128 v[144:147], v243 offset:11008
  v_mfma_f32_16x16x32_bf16 v[68:71], v[108:111], v[156:159], v[68:71]
  buffer_load_dwordx4 v[196:199], v237, s[24:27], s32 offen offset:1024 sc1
  s_add_u32 s32, s32, 2048
  v_mfma_f32_16x16x32_bf16 v[72:75], v[112:115], v[152:155], v[72:75]
  ds_read_b128 v[148:151], v243 offset:11264
  v_mfma_f32_16x16x32_bf16 v[76:79], v[112:115], v[156:159], v[76:79]
  s_waitcnt lgkmcnt(6)
  v_mfma_f32_16x16x32_bf16 v[8:11], v[116:119], v[160:163], v[8:11]
  s_waitcnt vmcnt(9)
  s_barrier
  ds_read_b128 v[80:83], v243 offset:18432
  v_mfma_f32_16x16x32_bf16 v[12:15], v[116:119], v[164:167], v[12:15]
  v_mfma_f32_16x16x32_bf16 v[16:19], v[120:123], v[160:163], v[16:19]
  ds_read_b128 v[84:87], v243 offset:18688
  v_mfma_f32_16x16x32_bf16 v[20:23], v[120:123], v[164:167], v[20:23]
  s_add_u32 m0, s34, 55296
  s_mov_b64 exec, s[40:41]
  buffer_load_dwordx4 v238, s[20:23], s33 offen sc1 lds
  s_mov_b64 exec, -1
  v_mfma_f32_16x16x32_bf16 v[24:27], v[124:127], v[160:163], v[24:27]
  ds_read_b128 v[88:91], v243 offset:18944
  v_mfma_f32_16x16x32_bf16 v[28:31], v[124:127], v[164:167], v[28:31]
  s_waitcnt lgkmcnt(6)
  v_mfma_f32_16x16x32_bf16 v[32:35], v[128:131], v[160:163], v[32:35]
  ds_read_b128 v[92:95], v243 offset:19200
  v_mfma_f32_16x16x32_bf16 v[36:39], v[128:131], v[164:167], v[36:39]
  buffer_load_dwordx4 v238, s[20:23], s33 offen offset:512 sc1 lds
  v_mfma_f32_16x16x32_bf16 v[40:43], v[132:135], v[160:163], v[40:43]
  ds_read_b128 v[96:99], v243 offset:19456
  v_mfma_f32_16x16x32_bf16 v[44:47], v[132:135], v[164:167], v[44:47]
  v_mfma_f32_16x16x32_bf16 v[48:51], v[136:139], v[160:163], v[48:51]
  ds_read_b128 v[100:103], v243 offset:19712
  v_mfma_f32_16x16x32_bf16 v[52:55], v[136:139], v[164:167], v[52:55]
  buffer_load_dwordx4 v240, s[20:23], s33 offen offset:1536 sc1 lds
  s_waitcnt lgkmcnt(6)
  v_mfma_f32_16x16x32_bf16 v[56:59], v[140:143], v[160:163], v[56:59]
  ds_read_b128 v[104:107], v243 offset:19968
  v_mfma_f32_16x16x32_bf16 v[60:63], v[140:143], v[164:167], v[60:63]
  v_mfma_f32_16x16x32_bf16 v[64:67], v[144:147], v[160:163], v[64:67]
  ds_read_b128 v[108:111], v243 offset:20224
  v_mfma_f32_16x16x32_bf16 v[68:71], v[144:147], v[164:167], v[68:71]
  buffer_load_dwordx4 v239, s[20:23], s33 offen offset:2560 sc1 lds
  v_mfma_f32_16x16x32_bf16 v[72:75], v[148:151], v[160:163], v[72:75]
  ds_read_b128 v[112:115], v243 offset:20480
  v_mfma_f32_16x16x32_bf16 v[76:79], v[148:151], v[164:167], v[76:79]
  buffer_load_dwordx4 v239, s[20:23], s33 offen offset:3584 sc1 lds
  s_add_u32 s33, s33, 294912
  s_waitcnt vmcnt(14)
  s_waitcnt lgkmcnt(6)
  v_mfma_f32_16x16x32_bf16 v[8:11], v[80:83], v[168:171], v[8:11]
  ds_read_b128 v[116:119], v243 offset:27648
  v_mfma_f32_16x16x32_bf16 v[12:15], v[80:83], v[172:175], v[12:15]
  v_mfma_f32_16x16x32_bf16 v[16:19], v[84:87], v[168:171], v[16:19]
  ds_read_b128 v[120:123], v243 offset:27904
  v_mfma_f32_16x16x32_bf16 v[20:23], v[84:87], v[172:175], v[20:23]
  buffer_load_dwordx4 v[152:155], v236, s[24:27], s32 offen offset:0 sc1
  v_mfma_f32_16x16x32_bf16 v[24:27], v[88:91], v[168:171], v[24:27]
  ds_read_b128 v[124:127], v243 offset:28160
  v_mfma_f32_16x16x32_bf16 v[28:31], v[88:91], v[172:175], v[28:31]
  s_waitcnt lgkmcnt(6)
  v_mfma_f32_16x16x32_bf16 v[32:35], v[92:95], v[168:171], v[32:35]
  ds_read_b128 v[128:131], v243 offset:28416
  v_mfma_f32_16x16x32_bf16 v[36:39], v[92:95], v[172:175], v[36:39]
  buffer_load_dwordx4 v[156:159], v237, s[24:27], s32 offen offset:0 sc1
  v_mfma_f32_16x16x32_bf16 v[40:43], v[96:99], v[168:171], v[40:43]
  ds_read_b128 v[132:135], v243 offset:28672
  v_mfma_f32_16x16x32_bf16 v[44:47], v[96:99], v[172:175], v[44:47]
  v_mfma_f32_16x16x32_bf16 v[48:51], v[100:103], v[168:171], v[48:51]
  ds_read_b128 v[136:139], v243 offset:28928
  v_mfma_f32_16x16x32_bf16 v[52:55], v[100:103], v[172:175], v[52:55]
  buffer_load_dwordx4 v[160:163], v236, s[24:27], s32 offen offset:1024 sc1
  s_waitcnt lgkmcnt(6)
  v_mfma_f32_16x16x32_bf16 v[56:59], v[104:107], v[168:171], v[56:59]
  ds_read_b128 v[140:143], v243 offset:29184
  v_mfma_f32_16x16x32_bf16 v[60:63], v[104:107], v[172:175], v[60:63]
  v_mfma_f32_16x16x32_bf16 v[64:67], v[108:111], v[168:171], v[64:67]
  ds_read_b128 v[144:147], v243 offset:29440
  v_mfma_f32_16x16x32_bf16 v[68:71], v[108:111], v[172:175], v[68:71]
  buffer_load_dwordx4 v[164:167], v237, s[24:27], s32 offen offset:1024 sc1
  s_add_u32 s32, s32, 2048
  v_mfma_f32_16x16x32_bf16 v[72:75], v[112:115], v[168:171], v[72:75]
  ds_read_b128 v[148:151], v243 offset:29696
  v_mfma_f32_16x16x32_bf16 v[76:79], v[112:115], v[172:175], v[76:79]
  s_waitcnt lgkmcnt(6)
  v_mfma_f32_16x16x32_bf16 v[8:11], v[116:119], v[176:179], v[8:11]
  s_waitcnt vmcnt(13)
  s_barrier
  ds_read_b128 v[80:83], v244 offset:0
  v_mfma_f32_16x16x32_bf16 v[12:15], v[116:119], v[180:183], v[12:15]
  v_mfma_f32_16x16x32_bf16 v[16:19], v[120:123], v[176:179], v[16:19]
  ds_read_b128 v[84:87], v244 offset:256
  v_mfma_f32_16x16x32_bf16 v[20:23], v[120:123], v[180:183], v[20:23]
  s_add_u32 m0, s34, 0
  s_mov_b64 exec, s[40:41]
  buffer_load_dwordx4 v238, s[20:23], s33 offen sc1 lds
  s_mov_b64 exec, -1
  v_mfma_f32_16x16x32_bf16 v[24:27], v[124:127], v[176:179], v[24:27]
  ds_read_b128 v[88:91], v244 offset:512
  v_mfma_f32_16x16x32_bf16 v[28:31], v[124:127], v[180:183], v[28:31]
  s_waitcnt lgkmcnt(6)
  v_mfma_f32_16x16x32_bf16 v[32:35], v[128:131], v[176:179], v[32:35]
  ds_read_b128 v[92:95], v244 offset:768
  v_mfma_f32_16x16x32_bf16 v[36:39], v[128:131], v[180:183], v[36:39]
  buffer_load_dwordx4 v238, s[20:23], s33 offen offset:512 sc1 lds
  v_mfma_f32_16x16x32_bf16 v[40:43], v[132:135], v[176:179], v[40:43]
  ds_read_b128 v[96:99], v244 offset:1024
  v_mfma_f32_16x16x32_bf16 v[44:47], v[132:135], v[180:183], v[44:47]
  v_mfma_f32_16x16x32_bf16 v[48:51], v[136:139], v[176:179], v[48:51]
  ds_read_b128 v[100:103], v244 offset:1280
  v_mfma_f32_16x16x32_bf16 v[52:55], v[136:139], v[180:183], v[52:55]
  buffer_load_dwordx4 v240, s[20:23], s33 offen offset:1536 sc1 lds
  s_waitcnt lgkmcnt(6)
  v_mfma_f32_16x16x32_bf16 v[56:59], v[140:143], v[176:179], v[56:59]
  ds_read_b128 v[104:107], v244 offset:1536
  v_mfma_f32_16x16x32_bf16 v[60:63], v[140:143], v[180:183], v[60:63]
  v_mfma_f32_16x16x32_bf16 v[64:67], v[144:147], v[176:179], v[64:67]
  ds_read_b128 v[108:111], v244 offset:1792
  v_mfma_f32_16x16x32_bf16 v[68:71], v[144:147], v[180:183], v[68:71]
  buffer_load_dwordx4 v239, s[20:23], s33 offen offset:2560 sc1 lds
  v_mfma_f32_16x16x32_bf16 v[72:75], v[148:151], v[176:179], v[72:75]
  ds_read_b128 v[112:115], v244 offset:2048
  v_mfma_f32_16x16x32_bf16 v[76:79], v[148:151], v[180:183], v[76:79]
  buffer_load_dwordx4 v239, s[20:23], s33 offen offset:3584 sc1 lds
  s_add_u32 s33, s33, 294912
  s_waitcnt vmcnt(14)
  s_waitcnt lgkmcnt(6)
  v_mfma_f32_16x16x32_bf16 v[8:11], v[80:83], v[184:187], v[8:11]
  ds_read_b128 v[116:119], v244 offset:9216
  v_mfma_f32_16x16x32_bf16 v[12:15], v[80:83], v[188:191], v[12:15]
  v_mfma_f32_16x16x32_bf16 v[16:19], v[84:87], v[184:187], v[16:19]
  ds_read_b128 v[120:123], v244 offset:9472
  v_mfma_f32_16x16x32_bf16 v[20:23], v[84:87], v[188:191], v[20:23]
  buffer_load_dwordx4 v[168:171], v236, s[24:27], s32 offen offset:0 sc1
  v_mfma_f32_16x16x32_bf16 v[24:27], v[88:91], v[184:187], v[24:27]
  ds_read_b128 v[124:127], v244 offset:9728
  v_mfma_f32_16x16x32_bf16 v[28:31], v[88:91], v[188:191], v[28:31]
  s_waitcnt lgkmcnt(6)
  v_mfma_f32_16x16x32_bf16 v[32:35], v[92:95], v[184:187], v[32:35]
  ds_read_b128 v[128:131], v244 offset:9984
  v_mfma_f32_16x16x32_bf16 v[36:39], v[92:95], v[188:191], v[36:39]
  buffer_load_dwordx4 v[172:175], v237, s[24:27], s32 offen offset:0 sc1
  v_mfma_f32_16x16x32_bf16 v[40:43], v[96:99], v[184:187], v[40:43]
  ds_read_b128 v[132:135], v244 offset:10240
  v_mfma_f32_16x16x32_bf16 v[44:47], v[96:99], v[188:191], v[44:47]
  v_mfma_f32_16x16x32_bf16 v[48:51], v[100:103], v[184:187], v[48:51]
  ds_read_b128 v[136:139], v244 offset:10496
  v_mfma_f32_16x16x32_bf16 v[52:55], v[100:103], v[188:191], v[52:55]
  buffer_load_dwordx4 v[176:179], v236, s[24:27], s32 offen offset:1024 sc1
  s_waitcnt lgkmcnt(6)
  v_mfma_f32_16x16x32_bf16 v[56:59], v[104:107], v[184:187], v[56:59]
  ds_read_b128 v[140:143], v244 offset:10752
  v_mfma_f32_16x16x32_bf16 v[60:63], v[104:107], v[188:191], v[60:63]
  v_mfma_f32_16x16x32_bf16 v[64:67], v[108:111], v[184:187], v[64:67]
  ds_read_b128 v[144:147], v244 offset:11008
  v_mfma_f32_16x16x32_bf16 v[68:71], v[108:111], v[188:191], v[68:71]
  buffer_load_dwordx4 v[180:183], v237, s[24:27], s32 offen offset:1024 sc1
  s_add_u32 s32, s32, 2048
  v_mfma_f32_16x16x32_bf16 v[72:75], v[112:115], v[184:187], v[72:75]
  ds_read_b128 v[148:151], v244 offset:11264
  v_mfma_f32_16x16x32_bf16 v[76:79], v[112:115], v[188:191], v[76:79]
  s_waitcnt lgkmcnt(6)
  v_mfma_f32_16x16x32_bf16 v[8:11], v[116:119], v[192:195], v[8:11]
  s_waitcnt vmcnt(13)
  s_barrier
  ds_read_b128 v[80:83], v244 offset:18432
  v_mfma_f32_16x16x32_bf16 v[12:15], v[116:119], v[196:199], v[12:15]
  v_mfma_f32_16x16x32_bf16 v[16:19], v[120:123], v[192:195], v[16:19]
  ds_read_b128 v[84:87], v244 offset:18688
  v_mfma_f32_16x16x32_bf16 v[20:23], v[120:123], v[196:199], v[20:23]
  s_add_u32 m0, s34, 18432
  s_mov_b64 exec, s[40:41]
  buffer_load_dwordx4 v238, s[20:23], s33 offen sc1 lds
  s_mov_b64 exec, -1
  v_mfma_f32_16x16x32_bf16 v[24:27], v[124:127], v[192:195], v[24:27]
  ds_read_b128 v[88:91], v244 offset:18944
  v_mfma_f32_16x16x32_bf16 v[28:31], v[124:127], v[196:199], v[28:31]
  s_waitcnt lgkmcnt(6)
  v_mfma_f32_16x16x32_bf16 v[32:35], v[128:131], v[192:195], v[32:35]
  ds_read_b128 v[92:95], v244 offset:19200
  v_mfma_f32_16x16x32_bf16 v[36:39], v[128:131], v[196:199], v[36:39]
  buffer_load_dwordx4 v238, s[20:23], s33 offen offset:512 sc1 lds
  v_mfma_f32_16x16x32_bf16 v[40:43], v[132:135], v[192:195], v[40:43]
  ds_read_b128 v[96:99], v244 offset:19456
  v_mfma_f32_16x16x32_bf16 v[44:47], v[132:135], v[196:199], v[44:47]
  v_mfma_f32_16x16x32_bf16 v[48:51], v[136:139], v[192:195], v[48:51]
  ds_read_b128 v[100:103], v244 offset:19712
  v_mfma_f32_16x16x32_bf16 v[52:55], v[136:139], v[196:199], v[52:55]
  buffer_load_dwordx4 v240, s[20:23], s33 offen offset:1536 sc1 lds
  s_waitcnt lgkmcnt(6)
  v_mfma_f32_16x16x32_bf16 v[56:59], v[140:143], v[192:195], v[56:59]
  ds_read_b128 v[104:107], v244 offset:19968
  v_mfma_f32_16x16x32_bf16 v[60:63], v[140:143], v[196:199], v[60:63]
  v_mfma_f32_16x16x32_bf16 v[64:67], v[144:147], v[192:195], v[64:67]
  ds_read_b128 v[108:111], v244 offset:20224
  v_mfma_f32_16x16x32_bf16 v[68:71], v[144:147], v[196:199], v[68:71]
  buffer_load_dwordx4 v239, s[20:23], s33 offen offset:2560 sc1 lds
  v_mfma_f32_16x16x32_bf16 v[72:75], v[148:151], v[192:195], v[72:75]
  ds_read_b128 v[112:115], v244 offset:20480
  v_mfma_f32_16x16x32_bf16 v[76:79], v[148:151], v[196:199], v[76:79]
  buffer_load_dwordx4 v239, s[20:23], s33 offen offset:3584 sc1 lds
  s_add_u32 s33, s33, 294912
  s_waitcnt vmcnt(14)
  s_waitcnt lgkmcnt(6)
  v_mfma_f32_16x16x32_bf16 v[8:11], v[80:83], v[152:155], v[8:11]
  ds_read_b128 v[116:119], v244 offset:27648
  v_mfma_f32_16x16x32_bf16 v[12:15], v[80:83], v[156:159], v[12:15]
  v_mfma_f32_16x16x32_bf16 v[16:19], v[84:87], v[152:155], v[16:19]
  ds_read_b128 v[120:123], v244 offset:27904
  v_mfma_f32_16x16x32_bf16 v[20:23], v[84:87], v[156:159], v[20:23]
  buffer_load_dwordx4 v[184:187], v236, s[24:27], s32 offen offset:0 sc1
  v_mfma_f32_16x16x32_bf16 v[24:27], v[88:91], v[152:155], v[24:27]
  ds_read_b128 v[124:127], v244 offset:28160
  v_mfma_f32_16x16x32_bf16 v[28:31], v[88:91], v[156:159], v[28:31]
  s_waitcnt lgkmcnt(6)
  v_mfma_f32_16x16x32_bf16 v[32:35], v[92:95], v[152:155], v[32:35]
  ds_read_b128 v[128:131], v244 offset:28416
  v_mfma_f32_16x16x32_bf16 v[36:39], v[92:95], v[156:159], v[36:39]
  buffer_load_dwordx4 v[188:191], v237, s[24:27], s32 offen offset:0 sc1
  v_mfma_f32_16x16x32_bf16 v[40:43], v[96:99], v[152:155], v[40:43]
  ds_read_b128 v[132:135], v244 offset:28672
  v_mfma_f32_16x16x32_bf16 v[44:47], v[96:99], v[156:159], v[44:47]
  v_mfma_f32_16x16x32_bf16 v[48:51], v[100:103], v[152:155], v[48:51]
  ds_read_b128 v[136:139], v244 offset:28928
  v_mfma_f32_16x16x32_bf16 v[52:55], v[100:103], v[156:159], v[52:55]
  buffer_load_dwordx4 v[192:195], v236, s[24:27], s32 offen offset:1024 sc1
  s_waitcnt lgkmcnt(6)
  v_mfma_f32_16x16x32_bf16 v[56:59], v[104:107], v[152:155], v[56:59]
  ds_read_b128 v[140:143], v244 offset:29184
  v_mfma_f32_16x16x32_bf16 v[60:63], v[104:107], v[156:159], v[60:63]
  v_mfma_f32_16x16x32_bf16 v[64:67], v[108:111], v[152:155], v[64:67]
  ds_read_b128 v[144:147], v244 offset:29440
  v_mfma_f32_16x16x32_bf16 v[68:71], v[108:111], v[156:159], v[68:71]
  buffer_load_dwordx4 v[196:199], v237, s[24:27], s32 offen offset:1024 sc1
  s_add_u32 s32, s32, 2048
  v_mfma_f32_16x16x32_bf16 v[72:75], v[112:115], v[152:155], v[72:75]
  ds_read_b128 v[148:151], v244 offset:29696
  v_mfma_f32_16x16x32_bf16 v[76:79], v[112:115], v[156:159], v[76:79]
  s_waitcnt lgkmcnt(6)
  v_mfma_f32_16x16x32_bf16 v[8:11], v[116:119], v[160:163], v[8:11]
  s_waitcnt vmcnt(13)
  s_barrier
  ds_read_b128 v[80:83], v243 offset:0
  v_mfma_f32_16x16x32_bf16 v[12:15], v[116:119], v[164:167], v[12:15]
  v_mfma_f32_16x16x32_bf16 v[16:19], v[120:123], v[160:163], v[16:19]
  ds_read_b128 v[84:87], v243 offset:256
  v_mfma_f32_16x16x32_bf16 v[20:23], v[120:123], v[164:167], v[20:23]
  s_add_u32 m0, s34, 36864
  s_mov_b64 exec, s[40:41]
  buffer_load_dwordx4 v238, s[20:23], s33 offen sc1 lds
  s_mov_b64 exec, -1
  v_mfma_f32_16x16x32_bf16 v[24:27], v[124:127], v[160:163], v[24:27]
  ds_read_b128 v[88:91], v243 offset:512
  v_mfma_f32_16x16x32_bf16 v[28:31], v[124:127], v[164:167], v[28:31]
  s_waitcnt lgkmcnt(6)
  v_mfma_f32_16x16x32_bf16 v[32:35], v[128:131], v[160:163], v[32:35]
  ds_read_b128 v[92:95], v243 offset:768
  v_mfma_f32_16x16x32_bf16 v[36:39], v[128:131], v[164:167], v[36:39]
  buffer_load_dwordx4 v238, s[20:23], s33 offen offset:512 sc1 lds
  v_mfma_f32_16x16x32_bf16 v[40:43], v[132:135], v[160:163], v[40:43]
  ds_read_b128 v[96:99], v243 offset:1024
  v_mfma_f32_16x16x32_bf16 v[44:47], v[132:135], v[164:167], v[44:47]
  v_mfma_f32_16x16x32_bf16 v[48:51], v[136:139], v[160:163], v[48:51]
  ds_read_b128 v[100:103], v243 offset:1280
  v_mfma_f32_16x16x32_bf16 v[52:55], v[136:139], v[164:167], v[52:55]
  buffer_load_dwordx4 v240, s[20:23], s33 offen offset:1536 sc1 lds
  s_waitcnt lgkmcnt(6)
  v_mfma_f32_16x16x32_bf16 v[56:59], v[140:143], v[160:163], v[56:59]
  ds_read_b128 v[104:107], v243 offset:1536
  v_mfma_f32_16x16x32_bf16 v[60:63], v[140:143], v[164:167], v[60:63]
  v_mfma_f32_16x16x32_bf16 v[64:67], v[144:147], v[160:163], v[64:67]
  ds_read_b128 v[108:111], v243 offset:1792
  v_mfma_f32_16x16x32_bf16 v[68:71], v[144:147], v[164:167], v[68:71]
  buffer_load_dwordx4 v239, s[20:23], s33 offen offset:2560 sc1 lds
  v_mfma_f32_16x16x32_bf16 v[72:75], v[148:151], v[160:163], v[72:75]
  ds_read_b128 v[112:115], v243 offset:2048
  v_mfma_f32_16x16x32_bf16 v[76:79], v[148:151], v[164:167], v[76:79]
  buffer_load_dwordx4 v239, s[20:23], s33 offen offset:3584 sc1 lds
  s_add_u32 s33, s33, 294912
  s_waitcnt vmcnt(14)
  s_waitcnt lgkmcnt(6)
  v_mfma_f32_16x16x32_bf16 v[8:11], v[80:83], v[168:171], v[8:11]
  ds_read_b128 v[116:119], v243 offset:9216
  v_mfma_f32_16x16x32_bf16 v[12:15], v[80:83], v[172:175], v[12:15]
  v_mfma_f32_16x16x32_bf16 v[16:19], v[84:87], v[168:171], v[16:19]
  ds_read_b128 v[120:123], v243 offset:9472
  v_mfma_f32_16x16x32_bf16 v[20:23], v[84:87], v[172:175], v[20:23]
  buffer_load_dwordx4 v[152:155], v236, s[24:27], s32 offen offset:0 sc1
  v_mfma_f32_16x16x32_bf16 v[24:27], v[88:91], v[168:171], v[24:27]
  ds_read_b128 v[124:127], v243 offset:9728
  v_mfma_f32_16x16x32_bf16 v[28:31], v[88:91], v[172:175], v[28:31]
  s_waitcnt lgkmcnt(6)
  v_mfma_f32_16x16x32_bf16 v[32:35], v[92:95], v[168:171], v[32:35]
  ds_read_b128 v[128:131], v243 offset:9984
  v_mfma_f32_16x16x32_bf16 v[36:39], v[92:95], v[172:175], v[36:39]
  buffer_load_dwordx4 v[156:159], v237, s[24:27], s32 offen offset:0 sc1
  v_mfma_f32_16x16x32_bf16 v[40:43], v[96:99], v[168:171], v[40:43]
  ds_read_b128 v[132:135], v243 offset:10240
  v_mfma_f32_16x16x32_bf16 v[44:47], v[96:99], v[172:175], v[44:47]
  v_mfma_f32_16x16x32_bf16 v[48:51], v[100:103], v[168:171], v[48:51]
  ds_read_b128 v[136:139], v243 offset:10496
  v_mfma_f32_16x16x32_bf16 v[52:55], v[100:103], v[172:175], v[52:55]
  buffer_load_dwordx4 v[160:163], v236, s[24:27], s32 offen offset:1024 sc1
  s_waitcnt lgkmcnt(6)
  v_mfma_f32_16x16x32_bf16 v[56:59], v[104:107], v[168:171], v[56:59]
  ds_read_b128 v[140:143], v243 offset:10752
  v_mfma_f32_16x16x32_bf16 v[60:63], v[104:107], v[172:175], v[60:63]
  v_mfma_f32_16x16x32_bf16 v[64:67], v[108:111], v[168:171], v[64:67]
  ds_read_b128 v[144:147], v243 offset:11008
  v_mfma_f32_16x16x32_bf16 v[68:71], v[108:111], v[172:175], v[68:71]
  buffer_load_dwordx4 v[164:167], v237, s[24:27], s32 offen offset:1024 sc1
  s_add_u32 s32, s32, 2048
  v_mfma_f32_16x16x32_bf16 v[72:75], v[112:115], v[168:171], v[72:75]
  ds_read_b128 v[148:151], v243 offset:11264
  v_mfma_f32_16x16x32_bf16 v[76:79], v[112:115], v[172:175], v[76:79]
  s_waitcnt lgkmcnt(6)
  v_mfma_f32_16x16x32_bf16 v[8:11], v[116:119], v[176:179], v[8:11]
  s_waitcnt vmcnt(13)
  s_barrier
  ds_read_b128 v[80:83], v243 offset:18432
  v_mfma_f32_16x16x32_bf16 v[12:15], v[116:119], v[180:183], v[12:15]
  v_mfma_f32_16x16x32_bf16 v[16:19], v[120:123], v[176:179], v[16:19]
  ds_read_b128 v[84:87], v243 offset:18688
  v_mfma_f32_16x16x32_bf16 v[20:23], v[120:123], v[180:183], v[20:23]
  s_add_u32 m0, s34, 55296
  s_mov_b64 exec, s[40:41]
  buffer_load_dwordx4 v238, s[20:23], s33 offen sc1 lds
  s_mov_b64 exec, -1
  v_mfma_f32_16x16x32_bf16 v[24:27], v[124:127], v[176:179], v[24:27]
  ds_read_b128 v[88:91], v243 offset:18944
  v_mfma_f32_16x16x32_bf16 v[28:31], v[124:127], v[180:183], v[28:31]
  s_waitcnt lgkmcnt(6)
  v_mfma_f32_16x16x32_bf16 v[32:35], v[128:131], v[176:179], v[32:35]
  ds_read_b128 v[92:95], v243 offset:19200
  v_mfma_f32_16x16x32_bf16 v[36:39], v[128:131], v[180:183], v[36:39]
  buffer_load_dwordx4 v238, s[20:23], s33 offen offset:512 sc1 lds
  v_mfma_f32_16x16x32_bf16 v[40:43], v[132:135], v[176:179], v[40:43]
  ds_read_b128 v[96:99], v243 offset:19456
  v_mfma_f32_16x16x32_bf16 v[44:47], v[132:135], v[180:183], v[44:47]
  v_mfma_f32_16x16x32_bf16 v[48:51], v[136:139], v[176:179], v[48:51]
  ds_read_b128 v[100:103], v243 offset:19712
  v_mfma_f32_16x16x32_bf16 v[52:55], v[136:139], v[180:183], v[52:55]
  buffer_load_dwordx4 v240, s[20:23], s33 offen offset:1536 sc1 lds
  s_waitcnt lgkmcnt(6)
  v_mfma_f32_16x16x32_bf16 v[56:59], v[140:143], v[176:179], v[56:59]
  ds_read_b128 v[104:107], v243 offset:19968
  v_mfma_f32_16x16x32_bf16 v[60:63], v[140:143], v[180:183], v[60:63]
  v_mfma_f32_16x16x32_bf16 v[64:67], v[144:147], v[176:179], v[64:67]
  ds_read_b128 v[108:111], v243 offset:20224
  v_mfma_f32_16x16x32_bf16 v[68:71], v[144:147], v[180:183], v[68:71]
  buffer_load_dwordx4 v239, s[20:23], s33 offen offset:2560 sc1 lds
  v_mfma_f32_16x16x32_bf16 v[72:75], v[148:151], v[176:179], v[72:75]
  ds_read_b128 v[112:115], v243 offset:20480
  v_mfma_f32_16x16x32_bf16 v[76:79], v[148:151], v[180:183], v[76:79]
  buffer_load_dwordx4 v239, s[20:23], s33 offen offset:3584 sc1 lds
  s_add_u32 s33, s33, 294912
  s_waitcnt vmcnt(14)
  s_waitcnt lgkmcnt(6)
  v_mfma_f32_16x16x32_bf16 v[8:11], v[80:83], v[184:187], v[8:11]
  ds_read_b128 v[116:119], v243 offset:27648
  v_mfma_f32_16x16x32_bf16 v[12:15], v[80:83], v[188:191], v[12:15]
  v_mfma_f32_16x16x32_bf16 v[16:19], v[84:87], v[184:187], v[16:19]
  ds_read_b128 v[120:123], v243 offset:27904
  v_mfma_f32_16x16x32_bf16 v[20:23], v[84:87], v[188:191], v[20:23]
  buffer_load_dwordx4 v[168:171], v236, s[24:27], s32 offen offset:0 sc1
  v_mfma_f32_16x16x32_bf16 v[24:27], v[88:91], v[184:187], v[24:27]
  ds_read_b128 v[124:127], v243 offset:28160
  v_mfma_f32_16x16x32_bf16 v[28:31], v[88:91], v[188:191], v[28:31]
  s_waitcnt lgkmcnt(6)
  v_mfma_f32_16x16x32_bf16 v[32:35], v[92:95], v[184:187], v[32:35]
  ds_read_b128 v[128:131], v243 offset:28416
  v_mfma_f32_16x16x32_bf16 v[36:39], v[92:95], v[188:191], v[36:39]
  buffer_load_dwordx4 v[172:175], v237, s[24:27], s32 offen offset:0 sc1
  v_mfma_f32_16x16x32_bf16 v[40:43], v[96:99], v[184:187], v[40:43]
  ds_read_b128 v[132:135], v243 offset:28672
  v_mfma_f32_16x16x32_bf16 v[44:47], v[96:99], v[188:191], v[44:47]
  v_mfma_f32_16x16x32_bf16 v[48:51], v[100:103], v[184:187], v[48:51]
  ds_read_b128 v[136:139], v243 offset:28928
  v_mfma_f32_16x16x32_bf16 v[52:55], v[100:103], v[188:191], v[52:55]
  buffer_load_dwordx4 v[176:179], v236, s[24:27], s32 offen offset:1024 sc1
  s_waitcnt lgkmcnt(6)
  v_mfma_f32_16x16x32_bf16 v[56:59], v[104:107], v[184:187], v[56:59]
  ds_read_b128 v[140:143], v243 offset:29184
  v_mfma_f32_16x16x32_bf16 v[60:63], v[104:107], v[188:191], v[60:63]
  v_mfma_f32_16x16x32_bf16 v[64:67], v[108:111], v[184:187], v[64:67]
  ds_read_b128 v[144:147], v243 offset:29440
  v_mfma_f32_16x16x32_bf16 v[68:71], v[108:111], v[188:191], v[68:71]
  buffer_load_dwordx4 v[180:183], v237, s[24:27], s32 offen offset:1024 sc1
  s_add_u32 s32, s32, 2048
  v_mfma_f32_16x16x32_bf16 v[72:75], v[112:115], v[184:187], v[72:75]
  ds_read_b128 v[148:151], v243 offset:29696
  v_mfma_f32_16x16x32_bf16 v[76:79], v[112:115], v[188:191], v[76:79]
  s_waitcnt lgkmcnt(6)
  v_mfma_f32_16x16x32_bf16 v[8:11], v[116:119], v[192:195], v[8:11]
  s_waitcnt vmcnt(13)
  s_barrier
  ds_read_b128 v[80:83], v244 offset:0
  v_mfma_f32_16x16x32_bf16 v[12:15], v[116:119], v[196:199], v[12:15]
  v_mfma_f32_16x16x32_bf16 v[16:19], v[120:123], v[192:195], v[16:19]
  ds_read_b128 v[84:87], v244 offset:256
  v_mfma_f32_16x16x32_bf16 v[20:23], v[120:123], v[196:199], v[20:23]
  s_add_u32 m0, s34, 0
  s_mov_b64 exec, s[40:41]
  buffer_load_dwordx4 v238, s[20:23], s33 offen sc1 lds
  s_mov_b64 exec, -1
  v_mfma_f32_16x16x32_bf16 v[24:27], v[124:127], v[192:195], v[24:27]
  ds_read_b128 v[88:91], v244 offset:512
  v_mfma_f32_16x16x32_bf16 v[28:31], v[124:127], v[196:199], v[28:31]
  s_waitcnt lgkmcnt(6)
  v_mfma_f32_16x16x32_bf16 v[32:35], v[128:131], v[192:195], v[32:35]
  ds_read_b128 v[92:95], v244 offset:768
  v_mfma_f32_16x16x32_bf16 v[36:39], v[128:131], v[196:199], v[36:39]
  buffer_load_dwordx4 v238, s[20:23], s33 offen offset:512 sc1 lds
  v_mfma_f32_16x16x32_bf16 v[40:43], v[132:135], v[192:195], v[40:43]
  ds_read_b128 v[96:99], v244 offset:1024
  v_mfma_f32_16x16x32_bf16 v[44:47], v[132:135], v[196:199], v[44:47]
  v_mfma_f32_16x16x32_bf16 v[48:51], v[136:139], v[192:195], v[48:51]
  ds_read_b128 v[100:103], v244 offset:1280
  v_mfma_f32_16x16x32_bf16 v[52:55], v[136:139], v[196:199], v[52:55]
  buffer_load_dwordx4 v240, s[20:23], s33 offen offset:1536 sc1 lds
  s_waitcnt lgkmcnt(6)
  v_mfma_f32_16x16x32_bf16 v[56:59], v[140:143], v[192:195], v[56:59]
  ds_read_b128 v[104:107], v244 offset:1536
  v_mfma_f32_16x16x32_bf16 v[60:63], v[140:143], v[196:199], v[60:63]
  v_mfma_f32_16x16x32_bf16 v[64:67], v[144:147], v[192:195], v[64:67]
  ds_read_b128 v[108:111], v244 offset:1792
  v_mfma_f32_16x16x32_bf16 v[68:71], v[144:147], v[196:199], v[68:71]
  buffer_load_dwordx4 v239, s[20:23], s33 offen offset:2560 sc1 lds
  v_mfma_f32_16x16x32_bf16 v[72:75], v[148:151], v[192:195], v[72:75]
  ds_read_b128 v[112:115], v244 offset:2048
  v_mfma_f32_16x16x32_bf16 v[76:79], v[148:151], v[196:199], v[76:79]
  buffer_load_dwordx4 v239, s[20:23], s33 offen offset:3584 sc1 lds
  s_add_u32 s33, s33, 294912
  s_waitcnt vmcnt(14)
  s_waitcnt lgkmcnt(6)
  v_mfma_f32_16x16x32_bf16 v[8:11], v[80:83], v[152:155], v[8:11]
  ds_read_b128 v[116:119], v244 offset:9216
  v_mfma_f32_16x16x32_bf16 v[12:15], v[80:83], v[156:159], v[12:15]
  v_mfma_f32_16x16x32_bf16 v[16:19], v[84:87], v[152:155], v[16:19]
  ds_read_b128 v[120:123], v244 offset:9472
  v_mfma_f32_16x16x32_bf16 v[20:23], v[84:87], v[156:159], v[20:23]
  buffer_load_dwordx4 v[184:187], v236, s[24:27], s32 offen offset:0 sc1
  v_mfma_f32_16x16x32_bf16 v[24:27], v[88:91], v[152:155], v[24:27]
  ds_read_b128 v[124:127], v244 offset:9728
  v_mfma_f32_16x16x32_bf16 v[28:31], v[88:91], v[156:159], v[28:31]
  s_waitcnt lgkmcnt(6)
  v_mfma_f32_16x16x32_bf16 v[32:35], v[92:95], v[152:155], v[32:35]
  ds_read_b128 v[128:131], v244 offset:9984
  v_mfma_f32_16x16x32_bf16 v[36:39], v[92:95], v[156:159], v[36:39]
  buffer_load_dwordx4 v[188:191], v237, s[24:27], s32 offen offset:0 sc1
  v_mfma_f32_16x16x32_bf16 v[40:43], v[96:99], v[152:155], v[40:43]
  ds_read_b128 v[132:135], v244 offset:10240
  v_mfma_f32_16x16x32_bf16 v[44:47], v[96:99], v[156:159], v[44:47]
  v_mfma_f32_16x16x32_bf16 v[48:51], v[100:103], v[152:155], v[48:51]
  ds_read_b128 v[136:139], v244 offset:10496
  v_mfma_f32_16x16x32_bf16 v[52:55], v[100:103], v[156:159], v[52:55]
  buffer_load_dwordx4 v[192:195], v236, s[24:27], s32 offen offset:1024 sc1
  s_waitcnt lgkmcnt(6)
  v_mfma_f32_16x16x32_bf16 v[56:59], v[104:107], v[152:155], v[56:59]
  ds_read_b128 v[140:143], v244 offset:10752
  v_mfma_f32_16x16x32_bf16 v[60:63], v[104:107], v[156:159], v[60:63]
  v_mfma_f32_16x16x32_bf16 v[64:67], v[108:111], v[152:155], v[64:67]
  ds_read_b128 v[144:147], v244 offset:11008
  v_mfma_f32_16x16x32_bf16 v[68:71], v[108:111], v[156:159], v[68:71]
  buffer_load_dwordx4 v[196:199], v237, s[24:27], s32 offen offset:1024 sc1
  s_add_u32 s32, s32, 2048
  v_mfma_f32_16x16x32_bf16 v[72:75], v[112:115], v[152:155], v[72:75]
  ds_read_b128 v[148:151], v244 offset:11264
  v_mfma_f32_16x16x32_bf16 v[76:79], v[112:115], v[156:159], v[76:79]
  s_waitcnt lgkmcnt(6)
  v_mfma_f32_16x16x32_bf16 v[8:11], v[116:119], v[160:163], v[8:11]
  s_waitcnt vmcnt(13)
  s_barrier
  ds_read_b128 v[80:83], v244 offset:18432
  v_mfma_f32_16x16x32_bf16 v[12:15], v[116:119], v[164:167], v[12:15]
  v_mfma_f32_16x16x32_bf16 v[16:19], v[120:123], v[160:163], v[16:19]
  ds_read_b128 v[84:87], v244 offset:18688
  v_mfma_f32_16x16x32_bf16 v[20:23], v[120:123], v[164:167], v[20:23]
  s_add_u32 m0, s34, 18432
  s_mov_b64 exec, s[40:41]
  buffer_load_dwordx4 v238, s[20:23], s33 offen sc1 lds
  s_mov_b64 exec, -1
  v_mfma_f32_16x16x32_bf16 v[24:27], v[124:127], v[160:163], v[24:27]
  ds_read_b128 v[88:91], v244 offset:18944
  v_mfma_f32_16x16x32_bf16 v[28:31], v[124:127], v[164:167], v[28:31]
  s_waitcnt lgkmcnt(6)
  v_mfma_f32_16x16x32_bf16 v[32:35], v[128:131], v[160:163], v[32:35]
  ds_read_b128 v[92:95], v244 offset:19200
  v_mfma_f32_16x16x32_bf16 v[36:39], v[128:131], v[164:167], v[36:39]
  buffer_load_dwordx4 v238, s[20:23], s33 offen offset:512 sc1 lds
  v_mfma_f32_16x16x32_bf16 v[40:43], v[132:135], v[160:163], v[40:43]
  ds_read_b128 v[96:99], v244 offset:19456
  v_mfma_f32_16x16x32_bf16 v[44:47], v[132:135], v[164:167], v[44:47]
  v_mfma_f32_16x16x32_bf16 v[48:51], v[136:139], v[160:163], v[48:51]
  ds_read_b128 v[100:103], v244 offset:19712
  v_mfma_f32_16x16x32_bf16 v[52:55], v[136:139], v[164:167], v[52:55]
  buffer_load_dwordx4 v240, s[20:23], s33 offen offset:1536 sc1 lds
  s_waitcnt lgkmcnt(6)
  v_mfma_f32_16x16x32_bf16 v[56:59], v[140:143], v[160:163], v[56:59]
  ds_read_b128 v[104:107], v244 offset:19968
  v_mfma_f32_16x16x32_bf16 v[60:63], v[140:143], v[164:167], v[60:63]
  v_mfma_f32_16x16x32_bf16 v[64:67], v[144:147], v[160:163], v[64:67]
  ds_read_b128 v[108:111], v244 offset:20224
  v_mfma_f32_16x16x32_bf16 v[68:71], v[144:147], v[164:167], v[68:71]
  buffer_load_dwordx4 v239, s[20:23], s33 offen offset:2560 sc1 lds
  v_mfma_f32_16x16x32_bf16 v[72:75], v[148:151], v[160:163], v[72:75]
  ds_read_b128 v[112:115], v244 offset:20480
  v_mfma_f32_16x16x32_bf16 v[76:79], v[148:151], v[164:167], v[76:79]
  buffer_load_dwordx4 v239, s[20:23], s33 offen offset:3584 sc1 lds
  s_add_u32 s33, s33, 294912
  s_waitcnt vmcnt(14)
  s_waitcnt lgkmcnt(6)
  v_mfma_f32_16x16x32_bf16 v[8:11], v[80:83], v[168:171], v[8:11]
  ds_read_b128 v[116:119], v244 offset:27648
  v_mfma_f32_16x16x32_bf16 v[12:15], v[80:83], v[172:175], v[12:15]
  v_mfma_f32_16x16x32_bf16 v[16:19], v[84:87], v[168:171], v[16:19]
  ds_read_b128 v[120:123], v244 offset:27904
  v_mfma_f32_16x16x32_bf16 v[20:23], v[84:87], v[172:175], v[20:23]
  buffer_load_dwordx4 v[152:155], v236, s[24:27], s32 offen offset:0 sc1
  v_mfma_f32_16x16x32_bf16 v[24:27], v[88:91], v[168:171], v[24:27]
  ds_read_b128 v[124:127], v244 offset:28160
  v_mfma_f32_16x16x32_bf16 v[28:31], v[88:91], v[172:175], v[28:31]
  s_waitcnt lgkmcnt(6)
  v_mfma_f32_16x16x32_bf16 v[32:35], v[92:95], v[168:171], v[32:35]
  ds_read_b128 v[128:131], v244 offset:28416
  v_mfma_f32_16x16x32_bf16 v[36:39], v[92:95], v[172:175], v[36:39]
  buffer_load_dwordx4 v[156:159], v237, s[24:27], s32 offen offset:0 sc1
  v_mfma_f32_16x16x32_bf16 v[40:43], v[96:99], v[168:171], v[40:43]
  ds_read_b128 v[132:135], v244 offset:28672
  v_mfma_f32_16x16x32_bf16 v[44:47], v[96:99], v[172:175], v[44:47]
  v_mfma_f32_16x16x32_bf16 v[48:51], v[100:103], v[168:171], v[48:51]
  ds_read_b128 v[136:139], v244 offset:28928
  v_mfma_f32_16x16x32_bf16 v[52:55], v[100:103], v[172:175], v[52:55]
  buffer_load_dwordx4 v[160:163], v236, s[24:27], s32 offen offset:1024 sc1
  s_waitcnt lgkmcnt(6)
  v_mfma_f32_16x16x32_bf16 v[56:59], v[104:107], v[168:171], v[56:59]
  ds_read_b128 v[140:143], v244 offset:29184
  v_mfma_f32_16x16x32_bf16 v[60:63], v[104:107], v[172:175], v[60:63]
  v_mfma_f32_16x16x32_bf16 v[64:67], v[108:111], v[168:171], v[64:67]
  ds_read_b128 v[144:147], v244 offset:29440
  v_mfma_f32_16x16x32_bf16 v[68:71], v[108:111], v[172:175], v[68:71]
  buffer_load_dwordx4 v[164:167], v237, s[24:27], s32 offen offset:1024 sc1
  s_add_u32 s32, s32, 2048
  v_mfma_f32_16x16x32_bf16 v[72:75], v[112:115], v[168:171], v[72:75]
  ds_read_b128 v[148:151], v244 offset:29696
  v_mfma_f32_16x16x32_bf16 v[76:79], v[112:115], v[172:175], v[76:79]
  s_waitcnt lgkmcnt(6)
  v_mfma_f32_16x16x32_bf16 v[8:11], v[116:119], v[176:179], v[8:11]
  s_waitcnt vmcnt(13)
  s_barrier
  ds_read_b128 v[80:83], v243 offset:0
  v_mfma_f32_16x16x32_bf16 v[12:15], v[116:119], v[180:183], v[12:15]
  v_mfma_f32_16x16x32_bf16 v[16:19], v[120:123], v[176:179], v[16:19]
  ds_read_b128 v[84:87], v243 offset:256
  v_mfma_f32_16x16x32_bf16 v[20:23], v[120:123], v[180:183], v[20:23]
  s_add_u32 m0, s34, 36864
  s_mov_b64 exec, s[40:41]
  buffer_load_dwordx4 v238, s[20:23], s33 offen sc1 lds
  s_mov_b64 exec, -1
  v_mfma_f32_16x16x32_bf16 v[24:27], v[124:127], v[176:179], v[24:27]
  ds_read_b128 v[88:91], v243 offset:512
  v_mfma_f32_16x16x32_bf16 v[28:31], v[124:127], v[180:183], v[28:31]
  s_waitcnt lgkmcnt(6)
  v_mfma_f32_16x16x32_bf16 v[32:35], v[128:131], v[176:179], v[32:35]
  ds_read_b128 v[92:95], v243 offset:768
  v_mfma_f32_16x16x32_bf16 v[36:39], v[128:131], v[180:183], v[36:39]
  buffer_load_dwordx4 v238, s[20:23], s33 offen offset:512 sc1 lds
  v_mfma_f32_16x16x32_bf16 v[40:43], v[132:135], v[176:179], v[40:43]
  ds_read_b128 v[96:99], v243 offset:1024
  v_mfma_f32_16x16x32_bf16 v[44:47], v[132:135], v[180:183], v[44:47]
  v_mfma_f32_16x16x32_bf16 v[48:51], v[136:139], v[176:179], v[48:51]
  ds_read_b128 v[100:103], v243 offset:1280
  v_mfma_f32_16x16x32_bf16 v[52:55], v[136:139], v[180:183], v[52:55]
  buffer_load_dwordx4 v240, s[20:23], s33 offen offset:1536 sc1 lds
  s_waitcnt lgkmcnt(6)
  v_mfma_f32_16x16x32_bf16 v[56:59], v[140:143], v[176:179], v[56:59]
  ds_read_b128 v[104:107], v243 offset:1536
  v_mfma_f32_16x16x32_bf16 v[60:63], v[140:143], v[180:183], v[60:63]
  v_mfma_f32_16x16x32_bf16 v[64:67], v[144:147], v[176:179], v[64:67]
  ds_read_b128 v[108:111], v243 offset:1792
  v_mfma_f32_16x16x32_bf16 v[68:71], v[144:147], v[180:183], v[68:71]
  buffer_load_dwordx4 v239, s[20:23], s33 offen offset:2560 sc1 lds
  v_mfma_f32_16x16x32_bf16 v[72:75], v[148:151], v[176:179], v[72:75]
  ds_read_b128 v[112:115], v243 offset:2048
  v_mfma_f32_16x16x32_bf16 v[76:79], v[148:151], v[180:183], v[76:79]
  buffer_load_dwordx4 v239, s[20:23], s33 offen offset:3584 sc1 lds
  s_add_u32 s33, s33, 294912
  s_waitcnt vmcnt(14)
  s_waitcnt lgkmcnt(6)
  v_mfma_f32_16x16x32_bf16 v[8:11], v[80:83], v[184:187], v[8:11]
  ds_read_b128 v[116:119], v243 offset:9216
  v_mfma_f32_16x16x32_bf16 v[12:15], v[80:83], v[188:191], v[12:15]
  v_mfma_f32_16x16x32_bf16 v[16:19], v[84:87], v[184:187], v[16:19]
  ds_read_b128 v[120:123], v243 offset:9472
  v_mfma_f32_16x16x32_bf16 v[20:23], v[84:87], v[188:191], v[20:23]
  buffer_load_dwordx4 v[168:171], v236, s[24:27], s32 offen offset:0 sc1
  v_mfma_f32_16x16x32_bf16 v[24:27], v[88:91], v[184:187], v[24:27]
  ds_read_b128 v[124:127], v243 offset:9728
  v_mfma_f32_16x16x32_bf16 v[28:31], v[88:91], v[188:191], v[28:31]
  s_waitcnt lgkmcnt(6)
  v_mfma_f32_16x16x32_bf16 v[32:35], v[92:95], v[184:187], v[32:35]
  ds_read_b128 v[128:131], v243 offset:9984
  v_mfma_f32_16x16x32_bf16 v[36:39], v[92:95], v[188:191], v[36:39]
  buffer_load_dwordx4 v[172:175], v237, s[24:27], s32 offen offset:0 sc1
  v_mfma_f32_16x16x32_bf16 v[40:43], v[96:99], v[184:187], v[40:43]
  ds_read_b128 v[132:135], v243 offset:10240
  v_mfma_f32_16x16x32_bf16 v[44:47], v[96:99], v[188:191], v[44:47]
  v_mfma_f32_16x16x32_bf16 v[48:51], v[100:103], v[184:187], v[48:51]
  ds_read_b128 v[136:139], v243 offset:10496
  v_mfma_f32_16x16x32_bf16 v[52:55], v[100:103], v[188:191], v[52:55]
  buffer_load_dwordx4 v[176:179], v236, s[24:27], s32 offen offset:1024 sc1
  s_waitcnt lgkmcnt(6)
  v_mfma_f32_16x16x32_bf16 v[56:59], v[104:107], v[184:187], v[56:59]
  ds_read_b128 v[140:143], v243 offset:10752
  v_mfma_f32_16x16x32_bf16 v[60:63], v[104:107], v[188:191], v[60:63]
  v_mfma_f32_16x16x32_bf16 v[64:67], v[108:111], v[184:187], v[64:67]
  ds_read_b128 v[144:147], v243 offset:11008
  v_mfma_f32_16x16x32_bf16 v[68:71], v[108:111], v[188:191], v[68:71]
  buffer_load_dwordx4 v[180:183], v237, s[24:27], s32 offen offset:1024 sc1
  s_add_u32 s32, s32, 2048
  v_mfma_f32_16x16x32_bf16 v[72:75], v[112:115], v[184:187], v[72:75]
  ds_read_b128 v[148:151], v243 offset:11264
  v_mfma_f32_16x16x32_bf16 v[76:79], v[112:115], v[188:191], v[76:79]
  s_waitcnt lgkmcnt(6)
  v_mfma_f32_16x16x32_bf16 v[8:11], v[116:119], v[192:195], v[8:11]
  s_waitcnt vmcnt(13)
  s_barrier
  ds_read_b128 v[80:83], v243 offset:18432
  v_mfma_f32_16x16x32_bf16 v[12:15], v[116:119], v[196:199], v[12:15]
  v_mfma_f32_16x16x32_bf16 v[16:19], v[120:123], v[192:195], v[16:19]
  ds_read_b128 v[84:87], v243 offset:18688
  v_mfma_f32_16x16x32_bf16 v[20:23], v[120:123], v[196:199], v[20:23]
  s_add_u32 m0, s34, 55296
  s_mov_b64 exec, s[40:41]
  buffer_load_dwordx4 v238, s[20:23], s33 offen sc1 lds
  s_mov_b64 exec, -1
  v_mfma_f32_16x16x32_bf16 v[24:27], v[124:127], v[192:195], v[24:27]
  ds_read_b128 v[88:91], v243 offset:18944
  v_mfma_f32_16x16x32_bf16 v[28:31], v[124:127], v[196:199], v[28:31]
  s_waitcnt lgkmcnt(6)
  v_mfma_f32_16x16x32_bf16 v[32:35], v[128:131], v[192:195], v[32:35]
  ds_read_b128 v[92:95], v243 offset:19200
  v_mfma_f32_16x16x32_bf16 v[36:39], v[128:131], v[196:199], v[36:39]
  buffer_load_dwordx4 v238, s[20:23], s33 offen offset:512 sc1 lds
  v_mfma_f32_16x16x32_bf16 v[40:43], v[132:135], v[192:195], v[40:43]
  ds_read_b128 v[96:99], v243 offset:19456
  v_mfma_f32_16x16x32_bf16 v[44:47], v[132:135], v[196:199], v[44:47]
  v_mfma_f32_16x16x32_bf16 v[48:51], v[136:139], v[192:195], v[48:51]
  ds_read_b128 v[100:103], v243 offset:19712
  v_mfma_f32_16x16x32_bf16 v[52:55], v[136:139], v[196:199], v[52:55]
  buffer_load_dwordx4 v240, s[20:23], s33 offen offset:1536 sc1 lds
  s_waitcnt lgkmcnt(6)
  v_mfma_f32_16x16x32_bf16 v[56:59], v[140:143], v[192:195], v[56:59]
  ds_read_b128 v[104:107], v243 offset:19968
  v_mfma_f32_16x16x32_bf16 v[60:63], v[140:143], v[196:199], v[60:63]
  v_mfma_f32_16x16x32_bf16 v[64:67], v[144:147], v[192:195], v[64:67]
  ds_read_b128 v[108:111], v243 offset:20224
  v_mfma_f32_16x16x32_bf16 v[68:71], v[144:147], v[196:199], v[68:71]
  buffer_load_dwordx4 v239, s[20:23], s33 offen offset:2560 sc1 lds
  v_mfma_f32_16x16x32_bf16 v[72:75], v[148:151], v[192:195], v[72:75]
  ds_read_b128 v[112:115], v243 offset:20480
  v_mfma_f32_16x16x32_bf16 v[76:79], v[148:151], v[196:199], v[76:79]
  buffer_load_dwordx4 v239, s[20:23], s33 offen offset:3584 sc1 lds
  s_add_u32 s33, s33, 294912
  s_waitcnt vmcnt(14)
  s_waitcnt lgkmcnt(6)
  v_mfma_f32_16x16x32_bf16 v[8:11], v[80:83], v[152:155], v[8:11]
  ds_read_b128 v[116:119], v243 offset:27648
  v_mfma_f32_16x16x32_bf16 v[12:15], v[80:83], v[156:159], v[12:15]
  v_mfma_f32_16x16x32_bf16 v[16:19], v[84:87], v[152:155], v[16:19]
  ds_read_b128 v[120:123], v243 offset:27904
  v_mfma_f32_16x16x32_bf16 v[20:23], v[84:87], v[156:159], v[20:23]
  buffer_load_dwordx4 v[184:187], v236, s[24:27], s32 offen offset:0 sc1
  v_mfma_f32_16x16x32_bf16 v[24:27], v[88:91], v[152:155], v[24:27]
  ds_read_b128 v[124:127], v243 offset:28160
  v_mfma_f32_16x16x32_bf16 v[28:31], v[88:91], v[156:159], v[28:31]
  s_waitcnt lgkmcnt(6)
  v_mfma_f32_16x16x32_bf16 v[32:35], v[92:95], v[152:155], v[32:35]
  ds_read_b128 v[128:131], v243 offset:28416
  v_mfma_f32_16x16x32_bf16 v[36:39], v[92:95], v[156:159], v[36:39]
  buffer_load_dwordx4 v[188:191], v237, s[24:27], s32 offen offset:0 sc1
  v_mfma_f32_16x16x32_bf16 v[40:43], v[96:99], v[152:155], v[40:43]
  ds_read_b128 v[132:135], v243 offset:28672
  v_mfma_f32_16x16x32_bf16 v[44:47], v[96:99], v[156:159], v[44:47]
  v_mfma_f32_16x16x32_bf16 v[48:51], v[100:103], v[152:155], v[48:51]
  ds_read_b128 v[136:139], v243 offset:28928
  v_mfma_f32_16x16x32_bf16 v[52:55], v[100:103], v[156:159], v[52:55]
  buffer_load_dwordx4 v[192:195], v236, s[24:27], s32 offen offset:1024 sc1
  s_waitcnt lgkmcnt(6)
  v_mfma_f32_16x16x32_bf16 v[56:59], v[104:107], v[152:155], v[56:59]
  ds_read_b128 v[140:143], v243 offset:29184
  v_mfma_f32_16x16x32_bf16 v[60:63], v[104:107], v[156:159], v[60:63]
  v_mfma_f32_16x16x32_bf16 v[64:67], v[108:111], v[152:155], v[64:67]
  ds_read_b128 v[144:147], v243 offset:29440
  v_mfma_f32_16x16x32_bf16 v[68:71], v[108:111], v[156:159], v[68:71]
  buffer_load_dwordx4 v[196:199], v237, s[24:27], s32 offen offset:1024 sc1
  s_add_u32 s32, s32, 2048
  v_mfma_f32_16x16x32_bf16 v[72:75], v[112:115], v[152:155], v[72:75]
  ds_read_b128 v[148:151], v243 offset:29696
  v_mfma_f32_16x16x32_bf16 v[76:79], v[112:115], v[156:159], v[76:79]
  s_waitcnt lgkmcnt(6)
  v_mfma_f32_16x16x32_bf16 v[8:11], v[116:119], v[160:163], v[8:11]
  s_waitcnt vmcnt(13)
  s_barrier
  ds_read_b128 v[80:83], v244 offset:0
  v_mfma_f32_16x16x32_bf16 v[12:15], v[116:119], v[164:167], v[12:15]
  v_mfma_f32_16x16x32_bf16 v[16:19], v[120:123], v[160:163], v[16:19]
  ds_read_b128 v[84:87], v244 offset:256
  v_mfma_f32_16x16x32_bf16 v[20:23], v[120:123], v[164:167], v[20:23]
  s_add_u32 m0, s34, 0
  s_mov_b64 exec, s[40:41]
  buffer_load_dwordx4 v238, s[20:23], s33 offen sc1 lds
  s_mov_b64 exec, -1
  v_mfma_f32_16x16x32_bf16 v[24:27], v[124:127], v[160:163], v[24:27]
  ds_read_b128 v[88:91], v244 offset:512
  v_mfma_f32_16x16x32_bf16 v[28:31], v[124:127], v[164:167], v[28:31]
  s_waitcnt lgkmcnt(6)
  v_mfma_f32_16x16x32_bf16 v[32:35], v[128:131], v[160:163], v[32:35]
  ds_read_b128 v[92:95], v244 offset:768
  v_mfma_f32_16x16x32_bf16 v[36:39], v[128:131], v[164:167], v[36:39]
  buffer_load_dwordx4 v238, s[20:23], s33 offen offset:512 sc1 lds
  v_mfma_f32_16x16x32_bf16 v[40:43], v[132:135], v[160:163], v[40:43]
  ds_read_b128 v[96:99], v244 offset:1024
  v_mfma_f32_16x16x32_bf16 v[44:47], v[132:135], v[164:167], v[44:47]
  v_mfma_f32_16x16x32_bf16 v[48:51], v[136:139], v[160:163], v[48:51]
  ds_read_b128 v[100:103], v244 offset:1280
  v_mfma_f32_16x16x32_bf16 v[52:55], v[136:139], v[164:167], v[52:55]
  buffer_load_dwordx4 v240, s[20:23], s33 offen offset:1536 sc1 lds
  s_waitcnt lgkmcnt(6)
  v_mfma_f32_16x16x32_bf16 v[56:59], v[140:143], v[160:163], v[56:59]
  ds_read_b128 v[104:107], v244 offset:1536
  v_mfma_f32_16x16x32_bf16 v[60:63], v[140:143], v[164:167], v[60:63]
  v_mfma_f32_16x16x32_bf16 v[64:67], v[144:147], v[160:163], v[64:67]
  ds_read_b128 v[108:111], v244 offset:1792
  v_mfma_f32_16x16x32_bf16 v[68:71], v[144:147], v[164:167], v[68:71]
  buffer_load_dwordx4 v239, s[20:23], s33 offen offset:2560 sc1 lds
  v_mfma_f32_16x16x32_bf16 v[72:75], v[148:151], v[160:163], v[72:75]
  ds_read_b128 v[112:115], v244 offset:2048
  v_mfma_f32_16x16x32_bf16 v[76:79], v[148:151], v[164:167], v[76:79]
  buffer_load_dwordx4 v239, s[20:23], s33 offen offset:3584 sc1 lds
  s_add_u32 s33, s33, 294912
  s_waitcnt vmcnt(14)
  s_waitcnt lgkmcnt(6)
  v_mfma_f32_16x16x32_bf16 v[8:11], v[80:83], v[168:171], v[8:11]
  ds_read_b128 v[116:119], v244 offset:9216
  v_mfma_f32_16x16x32_bf16 v[12:15], v[80:83], v[172:175], v[12:15]
  v_mfma_f32_16x16x32_bf16 v[16:19], v[84:87], v[168:171], v[16:19]
  ds_read_b128 v[120:123], v244 offset:9472
  v_mfma_f32_16x16x32_bf16 v[20:23], v[84:87], v[172:175], v[20:23]
  buffer_load_dwordx4 v[152:155], v236, s[24:27], s32 offen offset:0 sc1
  v_mfma_f32_16x16x32_bf16 v[24:27], v[88:91], v[168:171], v[24:27]
  ds_read_b128 v[124:127], v244 offset:9728
  v_mfma_f32_16x16x32_bf16 v[28:31], v[88:91], v[172:175], v[28:31]
  s_waitcnt lgkmcnt(6)
  v_mfma_f32_16x16x32_bf16 v[32:35], v[92:95], v[168:171], v[32:35]
  ds_read_b128 v[128:131], v244 offset:9984
  v_mfma_f32_16x16x32_bf16 v[36:39], v[92:95], v[172:175], v[36:39]
  buffer_load_dwordx4 v[156:159], v237, s[24:27], s32 offen offset:0 sc1
  v_mfma_f32_16x16x32_bf16 v[40:43], v[96:99], v[168:171], v[40:43]
  ds_read_b128 v[132:135], v244 offset:10240
  v_mfma_f32_16x16x32_bf16 v[44:47], v[96:99], v[172:175], v[44:47]
  v_mfma_f32_16x16x32_bf16 v[48:51], v[100:103], v[168:171], v[48:51]
  ds_read_b128 v[136:139], v244 offset:10496
  v_mfma_f32_16x16x32_bf16 v[52:55], v[100:103], v[172:175], v[52:55]
  buffer_load_dwordx4 v[160:163], v236, s[24:27], s32 offen offset:1024 sc1
  s_waitcnt lgkmcnt(6)
  v_mfma_f32_16x16x32_bf16 v[56:59], v[104:107], v[168:171], v[56:59]
  ds_read_b128 v[140:143], v244 offset:10752
  v_mfma_f32_16x16x32_bf16 v[60:63], v[104:107], v[172:175], v[60:63]
  v_mfma_f32_16x16x32_bf16 v[64:67], v[108:111], v[168:171], v[64:67]
  ds_read_b128 v[144:147], v244 offset:11008
  v_mfma_f32_16x16x32_bf16 v[68:71], v[108:111], v[172:175], v[68:71]
  buffer_load_dwordx4 v[164:167], v237, s[24:27], s32 offen offset:1024 sc1
  s_add_u32 s32, s32, 2048
  v_mfma_f32_16x16x32_bf16 v[72:75], v[112:115], v[168:171], v[72:75]
  ds_read_b128 v[148:151], v244 offset:11264
  v_mfma_f32_16x16x32_bf16 v[76:79], v[112:115], v[172:175], v[76:79]
  s_waitcnt lgkmcnt(6)
  v_mfma_f32_16x16x32_bf16 v[8:11], v[116:119], v[176:179], v[8:11]
  s_waitcnt vmcnt(13)
  s_barrier
  ds_read_b128 v[80:83], v244 offset:18432
  v_mfma_f32_16x16x32_bf16 v[12:15], v[116:119], v[180:183], v[12:15]
  v_mfma_f32_16x16x32_bf16 v[16:19], v[120:123], v[176:179], v[16:19]
  ds_read_b128 v[84:87], v244 offset:18688
  v_mfma_f32_16x16x32_bf16 v[20:23], v[120:123], v[180:183], v[20:23]
  s_add_u32 m0, s34, 18432
  s_mov_b64 exec, s[40:41]
  buffer_load_dwordx4 v238, s[20:23], s33 offen sc1 lds
  s_mov_b64 exec, -1
  v_mfma_f32_16x16x32_bf16 v[24:27], v[124:127], v[176:179], v[24:27]
  ds_read_b128 v[88:91], v244 offset:18944
  v_mfma_f32_16x16x32_bf16 v[28:31], v[124:127], v[180:183], v[28:31]
  s_waitcnt lgkmcnt(6)
  v_mfma_f32_16x16x32_bf16 v[32:35], v[128:131], v[176:179], v[32:35]
  ds_read_b128 v[92:95], v244 offset:19200
  v_mfma_f32_16x16x32_bf16 v[36:39], v[128:131], v[180:183], v[36:39]
  buffer_load_dwordx4 v238, s[20:23], s33 offen offset:512 sc1 lds
  v_mfma_f32_16x16x32_bf16 v[40:43], v[132:135], v[176:179], v[40:43]
  ds_read_b128 v[96:99], v244 offset:19456
  v_mfma_f32_16x16x32_bf16 v[44:47], v[132:135], v[180:183], v[44:47]
  v_mfma_f32_16x16x32_bf16 v[48:51], v[136:139], v[176:179], v[48:51]
  ds_read_b128 v[100:103], v244 offset:19712
  v_mfma_f32_16x16x32_bf16 v[52:55], v[136:139], v[180:183], v[52:55]
  buffer_load_dwordx4 v240, s[20:23], s33 offen offset:1536 sc1 lds
  s_waitcnt lgkmcnt(6)
  v_mfma_f32_16x16x32_bf16 v[56:59], v[140:143], v[176:179], v[56:59]
  ds_read_b128 v[104:107], v244 offset:19968
  v_mfma_f32_16x16x32_bf16 v[60:63], v[140:143], v[180:183], v[60:63]
  v_mfma_f32_16x16x32_bf16 v[64:67], v[144:147], v[176:179], v[64:67]
  ds_read_b128 v[108:111], v244 offset:20224
  v_mfma_f32_16x16x32_bf16 v[68:71], v[144:147], v[180:183], v[68:71]
  buffer_load_dwordx4 v239, s[20:23], s33 offen offset:2560 sc1 lds
  v_mfma_f32_16x16x32_bf16 v[72:75], v[148:151], v[176:179], v[72:75]
  ds_read_b128 v[112:115], v244 offset:20480
  v_mfma_f32_16x16x32_bf16 v[76:79], v[148:151], v[180:183], v[76:79]
  buffer_load_dwordx4 v239, s[20:23], s33 offen offset:3584 sc1 lds
  s_add_u32 s33, s33, 294912
  s_waitcnt vmcnt(14)
  s_waitcnt lgkmcnt(6)
  v_mfma_f32_16x16x32_bf16 v[8:11], v[80:83], v[184:187], v[8:11]
  ds_read_b128 v[116:119], v244 offset:27648
  v_mfma_f32_16x16x32_bf16 v[12:15], v[80:83], v[188:191], v[12:15]
  v_mfma_f32_16x16x32_bf16 v[16:19], v[84:87], v[184:187], v[16:19]
  ds_read_b128 v[120:123], v244 offset:27904
  v_mfma_f32_16x16x32_bf16 v[20:23], v[84:87], v[188:191], v[20:23]
  buffer_load_dwordx4 v[168:171], v236, s[24:27], s32 offen offset:0 sc1
  v_mfma_f32_16x16x32_bf16 v[24:27], v[88:91], v[184:187], v[24:27]
  ds_read_b128 v[124:127], v244 offset:28160
  v_mfma_f32_16x16x32_bf16 v[28:31], v[88:91], v[188:191], v[28:31]
  s_waitcnt lgkmcnt(6)
  v_mfma_f32_16x16x32_bf16 v[32:35], v[92:95], v[184:187], v[32:35]
  ds_read_b128 v[128:131], v244 offset:28416
  v_mfma_f32_16x16x32_bf16 v[36:39], v[92:95], v[188:191], v[36:39]
  buffer_load_dwordx4 v[172:175], v237, s[24:27], s32 offen offset:0 sc1
  v_mfma_f32_16x16x32_bf16 v[40:43], v[96:99], v[184:187], v[40:43]
  ds_read_b128 v[132:135], v244 offset:28672
  v_mfma_f32_16x16x32_bf16 v[44:47], v[96:99], v[188:191], v[44:47]
  v_mfma_f32_16x16x32_bf16 v[48:51], v[100:103], v[184:187], v[48:51]
  ds_read_b128 v[136:139], v244 offset:28928
  v_mfma_f32_16x16x32_bf16 v[52:55], v[100:103], v[188:191], v[52:55]
  buffer_load_dwordx4 v[176:179], v236, s[24:27], s32 offen offset:1024 sc1
  s_waitcnt lgkmcnt(6)
  v_mfma_f32_16x16x32_bf16 v[56:59], v[104:107], v[184:187], v[56:59]
  ds_read_b128 v[140:143], v244 offset:29184
  v_mfma_f32_16x16x32_bf16 v[60:63], v[104:107], v[188:191], v[60:63]
  v_mfma_f32_16x16x32_bf16 v[64:67], v[108:111], v[184:187], v[64:67]
  ds_read_b128 v[144:147], v244 offset:29440
  v_mfma_f32_16x16x32_bf16 v[68:71], v[108:111], v[188:191], v[68:71]
  buffer_load_dwordx4 v[180:183], v237, s[24:27], s32 offen offset:1024 sc1
  s_add_u32 s32, s32, 2048
  v_mfma_f32_16x16x32_bf16 v[72:75], v[112:115], v[184:187], v[72:75]
  ds_read_b128 v[148:151], v244 offset:29696
  v_mfma_f32_16x16x32_bf16 v[76:79], v[112:115], v[188:191], v[76:79]
  s_waitcnt lgkmcnt(6)
  v_mfma_f32_16x16x32_bf16 v[8:11], v[116:119], v[192:195], v[8:11]
  s_waitcnt vmcnt(13)
  s_barrier
  ds_read_b128 v[80:83], v243 offset:0
  v_mfma_f32_16x16x32_bf16 v[12:15], v[116:119], v[196:199], v[12:15]
  v_mfma_f32_16x16x32_bf16 v[16:19], v[120:123], v[192:195], v[16:19]
  ds_read_b128 v[84:87], v243 offset:256
  v_mfma_f32_16x16x32_bf16 v[20:23], v[120:123], v[196:199], v[20:23]
  s_add_u32 m0, s34, 36864
  s_mov_b64 exec, s[40:41]
  buffer_load_dwordx4 v238, s[20:23], s33 offen sc1 lds
  s_mov_b64 exec, -1
  v_mfma_f32_16x16x32_bf16 v[24:27], v[124:127], v[192:195], v[24:27]
  ds_read_b128 v[88:91], v243 offset:512
  v_mfma_f32_16x16x32_bf16 v[28:31], v[124:127], v[196:199], v[28:31]
  s_waitcnt lgkmcnt(6)
  v_mfma_f32_16x16x32_bf16 v[32:35], v[128:131], v[192:195], v[32:35]
  ds_read_b128 v[92:95], v243 offset:768
  v_mfma_f32_16x16x32_bf16 v[36:39], v[128:131], v[196:199], v[36:39]
  buffer_load_dwordx4 v238, s[20:23], s33 offen offset:512 sc1 lds
  v_mfma_f32_16x16x32_bf16 v[40:43], v[132:135], v[192:195], v[40:43]
  ds_read_b128 v[96:99], v243 offset:1024
  v_mfma_f32_16x16x32_bf16 v[44:47], v[132:135], v[196:199], v[44:47]
  v_mfma_f32_16x16x32_bf16 v[48:51], v[136:139], v[192:195], v[48:51]
  ds_read_b128 v[100:103], v243 offset:1280
  v_mfma_f32_16x16x32_bf16 v[52:55], v[136:139], v[196:199], v[52:55]
  buffer_load_dwordx4 v240, s[20:23], s33 offen offset:1536 sc1 lds
  s_waitcnt lgkmcnt(6)
  v_mfma_f32_16x16x32_bf16 v[56:59], v[140:143], v[192:195], v[56:59]
  ds_read_b128 v[104:107], v243 offset:1536
  v_mfma_f32_16x16x32_bf16 v[60:63], v[140:143], v[196:199], v[60:63]
  v_mfma_f32_16x16x32_bf16 v[64:67], v[144:147], v[192:195], v[64:67]
  ds_read_b128 v[108:111], v243 offset:1792
  v_mfma_f32_16x16x32_bf16 v[68:71], v[144:147], v[196:199], v[68:71]
  buffer_load_dwordx4 v239, s[20:23], s33 offen offset:2560 sc1 lds
  v_mfma_f32_16x16x32_bf16 v[72:75], v[148:151], v[192:195], v[72:75]
  ds_read_b128 v[112:115], v243 offset:2048
  v_mfma_f32_16x16x32_bf16 v[76:79], v[148:151], v[196:199], v[76:79]
  buffer_load_dwordx4 v239, s[20:23], s33 offen offset:3584 sc1 lds
  s_add_u32 s33, s33, 294912
  s_sub_u32 s54, s54, 1
  s_cmp_lg_u32 s54, 0
  s_cbranch_scc1 loop_9
  s_waitcnt vmcnt(14)
  s_waitcnt lgkmcnt(6)
  v_mfma_f32_16x16x32_bf16 v[8:11], v[80:83], v[152:155], v[8:11]
  ds_read_b128 v[116:119], v243 offset:9216
  v_mfma_f32_16x16x32_bf16 v[12:15], v[80:83], v[156:159], v[12:15]
  v_mfma_f32_16x16x32_bf16 v[16:19], v[84:87], v[152:155], v[16:19]
  ds_read_b128 v[120:123], v243 offset:9472
  v_mfma_f32_16x16x32_bf16 v[20:23], v[84:87], v[156:159], v[20:23]
  buffer_load_dwordx4 v[184:187], v236, s[24:27], s32 offen offset:0 sc1
  v_mfma_f32_16x16x32_bf16 v[24:27], v[88:91], v[152:155], v[24:27]
  ds_read_b128 v[124:127], v243 offset:9728
  v_mfma_f32_16x16x32_bf16 v[28:31], v[88:91], v[156:159], v[28:31]
  s_waitcnt lgkmcnt(6)
  v_mfma_f32_16x16x32_bf16 v[32:35], v[92:95], v[152:155], v[32:35]
  ds_read_b128 v[128:131], v243 offset:9984
  v_mfma_f32_16x16x32_bf16 v[36:39], v[92:95], v[156:159], v[36:39]
  buffer_load_dwordx4 v[188:191], v237, s[24:27], s32 offen offset:0 sc1
  v_mfma_f32_16x16x32_bf16 v[40:43], v[96:99], v[152:155], v[40:43]
  ds_read_b128 v[132:135], v243 offset:10240
  v_mfma_f32_16x16x32_bf16 v[44:47], v[96:99], v[156:159], v[44:47]
  v_mfma_f32_16x16x32_bf16 v[48:51], v[100:103], v[152:155], v[48:51]
  ds_read_b128 v[136:139], v243 offset:10496
  v_mfma_f32_16x16x32_bf16 v[52:55], v[100:103], v[156:159], v[52:55]
  buffer_load_dwordx4 v[192:195], v236, s[24:27], s32 offen offset:1024 sc1
  s_waitcnt lgkmcnt(6)
  v_mfma_f32_16x16x32_bf16 v[56:59], v[104:107], v[152:155], v[56:59]
  ds_read_b128 v[140:143], v243 offset:10752
  v_mfma_f32_16x16x32_bf16 v[60:63], v[104:107], v[156:159], v[60:63]
  v_mfma_f32_16x16x32_bf16 v[64:67], v[108:111], v[152:155], v[64:67]
  ds_read_b128 v[144:147], v243 offset:11008
  v_mfma_f32_16x16x32_bf16 v[68:71], v[108:111], v[156:159], v[68:71]
  buffer_load_dwordx4 v[196:199], v237, s[24:27], s32 offen offset:1024 sc1
  s_add_u32 s32, s32, 2048
  v_mfma_f32_16x16x32_bf16 v[72:75], v[112:115], v[152:155], v[72:75]
  ds_read_b128 v[148:151], v243 offset:11264
  v_mfma_f32_16x16x32_bf16 v[76:79], v[112:115], v[156:159], v[76:79]
  s_waitcnt lgkmcnt(6)
  v_mfma_f32_16x16x32_bf16 v[8:11], v[116:119], v[160:163], v[8:11]
  s_waitcnt vmcnt(13)
  s_barrier
  ds_read_b128 v[80:83], v243 offset:18432
  v_mfma_f32_16x16x32_bf16 v[12:15], v[116:119], v[164:167], v[12:15]
  v_mfma_f32_16x16x32_bf16 v[16:19], v[120:123], v[160:163], v[16:19]
  ds_read_b128 v[84:87], v243 offset:18688
  v_mfma_f32_16x16x32_bf16 v[20:23], v[120:123], v[164:167], v[20:23]
  s_add_u32 m0, s34, 55296
  s_mov_b64 exec, s[40:41]
  buffer_load_dwordx4 v238, s[20:23], s33 offen sc1 lds
  s_mov_b64 exec, -1
  v_mfma_f32_16x16x32_bf16 v[24:27], v[124:127], v[160:163], v[24:27]
  ds_read_b128 v[88:91], v243 offset:18944
  v_mfma_f32_16x16x32_bf16 v[28:31], v[124:127], v[164:167], v[28:31]
  s_waitcnt lgkmcnt(6)
  v_mfma_f32_16x16x32_bf16 v[32:35], v[128:131], v[160:163], v[32:35]
  ds_read_b128 v[92:95], v243 offset:19200
  v_mfma_f32_16x16x32_bf16 v[36:39], v[128:131], v[164:167], v[36:39]
  buffer_load_dwordx4 v238, s[20:23], s33 offen offset:512 sc1 lds
  v_mfma_f32_16x16x32_bf16 v[40:43], v[132:135], v[160:163], v[40:43]
  ds_read_b128 v[96:99], v243 offset:19456
  v_mfma_f32_16x16x32_bf16 v[44:47], v[132:135], v[164:167], v[44:47]
  v_mfma_f32_16x16x32_bf16 v[48:51], v[136:139], v[160:163], v[48:51]
  ds_read_b128 v[100:103], v243 offset:19712
  v_mfma_f32_16x16x32_bf16 v[52:55], v[136:139], v[164:167], v[52:55]
  buffer_load_dwordx4 v240, s[20:23], s33 offen offset:1536 sc1 lds
  s_waitcnt lgkmcnt(6)
  v_mfma_f32_16x16x32_bf16 v[56:59], v[140:143], v[160:163], v[56:59]
  ds_read_b128 v[104:107], v243 offset:19968
  v_mfma_f32_16x16x32_bf16 v[60:63], v[140:143], v[164:167], v[60:63]
  v_mfma_f32_16x16x32_bf16 v[64:67], v[144:147], v[160:163], v[64:67]
  ds_read_b128 v[108:111], v243 offset:20224
  v_mfma_f32_16x16x32_bf16 v[68:71], v[144:147], v[164:167], v[68:71]
  buffer_load_dwordx4 v239, s[20:23], s33 offen offset:2560 sc1 lds
  v_mfma_f32_16x16x32_bf16 v[72:75], v[148:151], v[160:163], v[72:75]
  ds_read_b128 v[112:115], v243 offset:20480
  v_mfma_f32_16x16x32_bf16 v[76:79], v[148:151], v[164:167], v[76:79]
  buffer_load_dwordx4 v239, s[20:23], s33 offen offset:3584 sc1 lds
  s_add_u32 s33, s33, 294912
  s_waitcnt vmcnt(14)
  s_waitcnt lgkmcnt(6)
  v_mfma_f32_16x16x32_bf16 v[8:11], v[80:83], v[168:171], v[8:11]
  ds_read_b128 v[116:119], v243 offset:27648
  v_mfma_f32_16x16x32_bf16 v[12:15], v[80:83], v[172:175], v[12:15]
  v_mfma_f32_16x16x32_bf16 v[16:19], v[84:87], v[168:171], v[16:19]
  ds_read_b128 v[120:123], v243 offset:27904
  v_mfma_f32_16x16x32_bf16 v[20:23], v[84:87], v[172:175], v[20:23]
  buffer_load_dwordx4 v[152:155], v236, s[24:27], s32 offen offset:0 sc1
  v_mfma_f32_16x16x32_bf16 v[24:27], v[88:91], v[168:171], v[24:27]
  ds_read_b128 v[124:127], v243 offset:28160
  v_mfma_f32_16x16x32_bf16 v[28:31], v[88:91], v[172:175], v[28:31]
  s_waitcnt lgkmcnt(6)
  v_mfma_f32_16x16x32_bf16 v[32:35], v[92:95], v[168:171], v[32:35]
  ds_read_b128 v[128:131], v243 offset:28416
  v_mfma_f32_16x16x32_bf16 v[36:39], v[92:95], v[172:175], v[36:39]
  buffer_load_dwordx4 v[156:159], v237, s[24:27], s32 offen offset:0 sc1
  v_mfma_f32_16x16x32_bf16 v[40:43], v[96:99], v[168:171], v[40:43]
  ds_read_b128 v[132:135], v243 offset:28672
  v_mfma_f32_16x16x32_bf16 v[44:47], v[96:99], v[172:175], v[44:47]
  v_mfma_f32_16x16x32_bf16 v[48:51], v[100:103], v[168:171], v[48:51]
  ds_read_b128 v[136:139], v243 offset:28928
  v_mfma_f32_16x16x32_bf16 v[52:55], v[100:103], v[172:175], v[52:55]
  buffer_load_dwordx4 v[160:163], v236, s[24:27], s32 offen offset:1024 sc1
  s_waitcnt lgkmcnt(6)
  v_mfma_f32_16x16x32_bf16 v[56:59], v[104:107], v[168:171], v[56:59]
  ds_read_b128 v[140:143], v243 offset:29184
  v_mfma_f32_16x16x32_bf16 v[60:63], v[104:107], v[172:175], v[60:63]
  v_mfma_f32_16x16x32_bf16 v[64:67], v[108:111], v[168:171], v[64:67]
  ds_read_b128 v[144:147], v243 offset:29440
  v_mfma_f32_16x16x32_bf16 v[68:71], v[108:111], v[172:175], v[68:71]
  buffer_load_dwordx4 v[164:167], v237, s[24:27], s32 offen offset:1024 sc1
  s_add_u32 s32, s32, 2048
  v_mfma_f32_16x16x32_bf16 v[72:75], v[112:115], v[168:171], v[72:75]
  ds_read_b128 v[148:151], v243 offset:29696
  v_mfma_f32_16x16x32_bf16 v[76:79], v[112:115], v[172:175], v[76:79]
  s_waitcnt lgkmcnt(6)
  v_mfma_f32_16x16x32_bf16 v[8:11], v[116:119], v[176:179], v[8:11]
  s_waitcnt vmcnt(13)
  s_barrier
  ds_read_b128 v[80:83], v244 offset:0
  v_mfma_f32_16x16x32_bf16 v[12:15], v[116:119], v[180:183], v[12:15]
  v_mfma_f32_16x16x32_bf16 v[16:19], v[120:123], v[176:179], v[16:19]
  ds_read_b128 v[84:87], v244 offset:256
  v_mfma_f32_16x16x32_bf16 v[20:23], v[120:123], v[180:183], v[20:23]
  s_add_u32 m0, s34, 0
  s_mov_b64 exec, s[40:41]
  buffer_load_dwordx4 v238, s[20:23], s33 offen sc1 lds
  s_mov_b64 exec, -1
  v_mfma_f32_16x16x32_bf16 v[24:27], v[124:127], v[176:179], v[24:27]
  ds_read_b128 v[88:91], v244 offset:512
  v_mfma_f32_16x16x32_bf16 v[28:31], v[124:127], v[180:183], v[28:31]
  s_waitcnt lgkmcnt(6)
  v_mfma_f32_16x16x32_bf16 v[32:35], v[128:131], v[176:179], v[32:35]
  ds_read_b128 v[92:95], v244 offset:768
  v_mfma_f32_16x16x32_bf16 v[36:39], v[128:131], v[180:183], v[36:39]
  buffer_load_dwordx4 v238, s[20:23], s33 offen offset:512 sc1 lds
  v_mfma_f32_16x16x32_bf16 v[40:43], v[132:135], v[176:179], v[40:43]
  ds_read_b128 v[96:99], v244 offset:1024
  v_mfma_f32_16x16x32_bf16 v[44:47], v[132:135], v[180:183], v[44:47]
  v_mfma_f32_16x16x32_bf16 v[48:51], v[136:139], v[176:179], v[48:51]
  ds_read_b128 v[100:103], v244 offset:1280
  v_mfma_f32_16x16x32_bf16 v[52:55], v[136:139], v[180:183], v[52:55]
  buffer_load_dwordx4 v240, s[20:23], s33 offen offset:1536 sc1 lds
  s_waitcnt lgkmcnt(6)
  v_mfma_f32_16x16x32_bf16 v[56:59], v[140:143], v[176:179], v[56:59]
  ds_read_b128 v[104:107], v244 offset:1536
  v_mfma_f32_16x16x32_bf16 v[60:63], v[140:143], v[180:183], v[60:63]
  v_mfma_f32_16x16x32_bf16 v[64:67], v[144:147], v[176:179], v[64:67]
  ds_read_b128 v[108:111], v244 offset:1792
  v_mfma_f32_16x16x32_bf16 v[68:71], v[144:147], v[180:183], v[68:71]
  buffer_load_dwordx4 v239, s[20:23], s33 offen offset:2560 sc1 lds
  v_mfma_f32_16x16x32_bf16 v[72:75], v[148:151], v[176:179], v[72:75]
  ds_read_b128 v[112:115], v244 offset:2048
  v_mfma_f32_16x16x32_bf16 v[76:79], v[148:151], v[180:183], v[76:79]
  buffer_load_dwordx4 v239, s[20:23], s33 offen offset:3584 sc1 lds
  s_add_u32 s33, s33, 294912
  s_waitcnt vmcnt(14)
  s_waitcnt lgkmcnt(6)
  v_mfma_f32_16x16x32_bf16 v[8:11], v[80:83], v[184:187], v[8:11]
  ds_read_b128 v[116:119], v244 offset:9216
  v_mfma_f32_16x16x32_bf16 v[12:15], v[80:83], v[188:191], v[12:15]
  v_mfma_f32_16x16x32_bf16 v[16:19], v[84:87], v[184:187], v[16:19]
  ds_read_b128 v[120:123], v244 offset:9472
  v_mfma_f32_16x16x32_bf16 v[20:23], v[84:87], v[188:191], v[20:23]
  buffer_load_dwordx4 v[168:171], v236, s[24:27], s32 offen offset:0 sc1
  v_mfma_f32_16x16x32_bf16 v[24:27], v[88:91], v[184:187], v[24:27]
  ds_read_b128 v[124:127], v244 offset:9728
  v_mfma_f32_16x16x32_bf16 v[28:31], v[88:91], v[188:191], v[28:31]
  s_waitcnt lgkmcnt(6)
  v_mfma_f32_16x16x32_bf16 v[32:35], v[92:95], v[184:187], v[32:35]
  ds_read_b128 v[128:131], v244 offset:9984
  v_mfma_f32_16x16x32_bf16 v[36:39], v[92:95], v[188:191], v[36:39]
  buffer_load_dwordx4 v[172:175], v237, s[24:27], s32 offen offset:0 sc1
  v_mfma_f32_16x16x32_bf16 v[40:43], v[96:99], v[184:187], v[40:43]
  ds_read_b128 v[132:135], v244 offset:10240
  v_mfma_f32_16x16x32_bf16 v[44:47], v[96:99], v[188:191], v[44:47]
  v_mfma_f32_16x16x32_bf16 v[48:51], v[100:103], v[184:187], v[48:51]
  ds_read_b128 v[136:139], v244 offset:10496
  v_mfma_f32_16x16x32_bf16 v[52:55], v[100:103], v[188:191], v[52:55]
  buffer_load_dwordx4 v[176:179], v236, s[24:27], s32 offen offset:1024 sc1
  s_waitcnt lgkmcnt(6)
  v_mfma_f32_16x16x32_bf16 v[56:59], v[104:107], v[184:187], v[56:59]
  ds_read_b128 v[140:143], v244 offset:10752
  v_mfma_f32_16x16x32_bf16 v[60:63], v[104:107], v[188:191], v[60:63]
  v_mfma_f32_16x16x32_bf16 v[64:67], v[108:111], v[184:187], v[64:67]
  ds_read_b128 v[144:147], v244 offset:11008
  v_mfma_f32_16x16x32_bf16 v[68:71], v[108:111], v[188:191], v[68:71]
  buffer_load_dwordx4 v[180:183], v237, s[24:27], s32 offen offset:1024 sc1
  s_add_u32 s32, s32, 2048
  v_mfma_f32_16x16x32_bf16 v[72:75], v[112:115], v[184:187], v[72:75]
  ds_read_b128 v[148:151], v244 offset:11264
  v_mfma_f32_16x16x32_bf16 v[76:79], v[112:115], v[188:191], v[76:79]
  s_waitcnt lgkmcnt(6)
  v_mfma_f32_16x16x32_bf16 v[8:11], v[116:119], v[192:195], v[8:11]
  s_waitcnt vmcnt(13)
  s_barrier
  ds_read_b128 v[80:83], v244 offset:18432
  v_mfma_f32_16x16x32_bf16 v[12:15], v[116:119], v[196:199], v[12:15]
  v_mfma_f32_16x16x32_bf16 v[16:19], v[120:123], v[192:195], v[16:19]
  ds_read_b128 v[84:87], v244 offset:18688
  v_mfma_f32_16x16x32_bf16 v[20:23], v[120:123], v[196:199], v[20:23]
  s_add_u32 m0, s34, 18432
  s_mov_b64 exec, s[40:41]
  buffer_load_dwordx4 v238, s[20:23], s33 offen sc1 lds
  s_mov_b64 exec, -1
  v_mfma_f32_16x16x32_bf16 v[24:27], v[124:127], v[192:195], v[24:27]
  ds_read_b128 v[88:91], v244 offset:18944
  v_mfma_f32_16x16x32_bf16 v[28:31], v[124:127], v[196:199], v[28:31]
  s_waitcnt lgkmcnt(6)
  v_mfma_f32_16x16x32_bf16 v[32:35], v[128:131], v[192:195], v[32:35]
  ds_read_b128 v[92:95], v244 offset:19200
  v_mfma_f32_16x16x32_bf16 v[36:39], v[128:131], v[196:199], v[36:39]
  buffer_load_dwordx4 v238, s[20:23], s33 offen offset:512 sc1 lds
  v_mfma_f32_16x16x32_bf16 v[40:43], v[132:135], v[192:195], v[40:43]
  ds_read_b128 v[96:99], v244 offset:19456
  v_mfma_f32_16x16x32_bf16 v[44:47], v[132:135], v[196:199], v[44:47]
  v_mfma_f32_16x16x32_bf16 v[48:51], v[136:139], v[192:195], v[48:51]
  ds_read_b128 v[100:103], v244 offset:19712
  v_mfma_f32_16x16x32_bf16 v[52:55], v[136:139], v[196:199], v[52:55]
  buffer_load_dwordx4 v240, s[20:23], s33 offen offset:1536 sc1 lds
  s_waitcnt lgkmcnt(6)
  v_mfma_f32_16x16x32_bf16 v[56:59], v[140:143], v[192:195], v[56:59]
  ds_read_b128 v[104:107], v244 offset:19968
  v_mfma_f32_16x16x32_bf16 v[60:63], v[140:143], v[196:199], v[60:63]
  v_mfma_f32_16x16x32_bf16 v[64:67], v[144:147], v[192:195], v[64:67]
  ds_read_b128 v[108:111], v244 offset:20224
  v_mfma_f32_16x16x32_bf16 v[68:71], v[144:147], v[196:199], v[68:71]
  buffer_load_dwordx4 v239, s[20:23], s33 offen offset:2560 sc1 lds
  v_mfma_f32_16x16x32_bf16 v[72:75], v[148:151], v[192:195], v[72:75]
  ds_read_b128 v[112:115], v244 offset:20480
  v_mfma_f32_16x16x32_bf16 v[76:79], v[148:151], v[196:199], v[76:79]
  buffer_load_dwordx4 v239, s[20:23], s33 offen offset:3584 sc1 lds
  s_add_u32 s33, s33, 294912
  s_waitcnt vmcnt(14)
  s_waitcnt lgkmcnt(6)
  v_mfma_f32_16x16x32_bf16 v[8:11], v[80:83], v[152:155], v[8:11]
  ds_read_b128 v[116:119], v244 offset:27648
  v_mfma_f32_16x16x32_bf16 v[12:15], v[80:83], v[156:159], v[12:15]
  v_mfma_f32_16x16x32_bf16 v[16:19], v[84:87], v[152:155], v[16:19]
  ds_read_b128 v[120:123], v244 offset:27904
  v_mfma_f32_16x16x32_bf16 v[20:23], v[84:87], v[156:159], v[20:23]
  buffer_load_dwordx4 v[184:187], v236, s[24:27], s32 offen offset:0 sc1
  v_mfma_f32_16x16x32_bf16 v[24:27], v[88:91], v[152:155], v[24:27]
  ds_read_b128 v[124:127], v244 offset:28160
  v_mfma_f32_16x16x32_bf16 v[28:31], v[88:91], v[156:159], v[28:31]
  s_waitcnt lgkmcnt(6)
  v_mfma_f32_16x16x32_bf16 v[32:35], v[92:95], v[152:155], v[32:35]
  ds_read_b128 v[128:131], v244 offset:28416
  v_mfma_f32_16x16x32_bf16 v[36:39], v[92:95], v[156:159], v[36:39]
  buffer_load_dwordx4 v[188:191], v237, s[24:27], s32 offen offset:0 sc1
  v_mfma_f32_16x16x32_bf16 v[40:43], v[96:99], v[152:155], v[40:43]
  ds_read_b128 v[132:135], v244 offset:28672
  v_mfma_f32_16x16x32_bf16 v[44:47], v[96:99], v[156:159], v[44:47]
  v_mfma_f32_16x16x32_bf16 v[48:51], v[100:103], v[152:155], v[48:51]
  ds_read_b128 v[136:139], v244 offset:28928
  v_mfma_f32_16x16x32_bf16 v[52:55], v[100:103], v[156:159], v[52:55]
  buffer_load_dwordx4 v[192:195], v236, s[24:27], s32 offen offset:1024 sc1
  s_waitcnt lgkmcnt(6)
  v_mfma_f32_16x16x32_bf16 v[56:59], v[104:107], v[152:155], v[56:59]
  ds_read_b128 v[140:143], v244 offset:29184
  v_mfma_f32_16x16x32_bf16 v[60:63], v[104:107], v[156:159], v[60:63]
  v_mfma_f32_16x16x32_bf16 v[64:67], v[108:111], v[152:155], v[64:67]
  ds_read_b128 v[144:147], v244 offset:29440
  v_mfma_f32_16x16x32_bf16 v[68:71], v[108:111], v[156:159], v[68:71]
  buffer_load_dwordx4 v[196:199], v237, s[24:27], s32 offen offset:1024 sc1
  s_add_u32 s32, s32, 2048
  v_mfma_f32_16x16x32_bf16 v[72:75], v[112:115], v[152:155], v[72:75]
  ds_read_b128 v[148:151], v244 offset:29696
  v_mfma_f32_16x16x32_bf16 v[76:79], v[112:115], v[156:159], v[76:79]
  s_waitcnt lgkmcnt(6)
  v_mfma_f32_16x16x32_bf16 v[8:11], v[116:119], v[160:163], v[8:11]
  s_waitcnt vmcnt(13)
  s_barrier
  ds_read_b128 v[80:83], v243 offset:0
  v_mfma_f32_16x16x32_bf16 v[12:15], v[116:119], v[164:167], v[12:15]
  v_mfma_f32_16x16x32_bf16 v[16:19], v[120:123], v[160:163], v[16:19]
  ds_read_b128 v[84:87], v243 offset:256
  v_mfma_f32_16x16x32_bf16 v[20:23], v[120:123], v[164:167], v[20:23]
  s_add_u32 m0, s34, 36864
  s_mov_b64 exec, s[40:41]
  buffer_load_dwordx4 v238, s[20:23], s33 offen sc1 lds
  s_mov_b64 exec, -1
  v_mfma_f32_16x16x32_bf16 v[24:27], v[124:127], v[160:163], v[24:27]
  ds_read_b128 v[88:91], v243 offset:512
  v_mfma_f32_16x16x32_bf16 v[28:31], v[124:127], v[164:167], v[28:31]
  s_waitcnt lgkmcnt(6)
  v_mfma_f32_16x16x32_bf16 v[32:35], v[128:131], v[160:163], v[32:35]
  ds_read_b128 v[92:95], v243 offset:768
  v_mfma_f32_16x16x32_bf16 v[36:39], v[128:131], v[164:167], v[36:39]
  buffer_load_dwordx4 v238, s[20:23], s33 offen offset:512 sc1 lds
  v_mfma_f32_16x16x32_bf16 v[40:43], v[132:135], v[160:163], v[40:43]
  ds_read_b128 v[96:99], v243 offset:1024
  v_mfma_f32_16x16x32_bf16 v[44:47], v[132:135], v[164:167], v[44:47]
  v_mfma_f32_16x16x32_bf16 v[48:51], v[136:139], v[160:163], v[48:51]
  ds_read_b128 v[100:103], v243 offset:1280
  v_mfma_f32_16x16x32_bf16 v[52:55], v[136:139], v[164:167], v[52:55]
  buffer_load_dwordx4 v240, s[20:23], s33 offen offset:1536 sc1 lds
  s_waitcnt lgkmcnt(6)
  v_mfma_f32_16x16x32_bf16 v[56:59], v[140:143], v[160:163], v[56:59]
  ds_read_b128 v[104:107], v243 offset:1536
  v_mfma_f32_16x16x32_bf16 v[60:63], v[140:143], v[164:167], v[60:63]
  v_mfma_f32_16x16x32_bf16 v[64:67], v[144:147], v[160:163], v[64:67]
  ds_read_b128 v[108:111], v243 offset:1792
  v_mfma_f32_16x16x32_bf16 v[68:71], v[144:147], v[164:167], v[68:71]
  buffer_load_dwordx4 v239, s[20:23], s33 offen offset:2560 sc1 lds
  v_mfma_f32_16x16x32_bf16 v[72:75], v[148:151], v[160:163], v[72:75]
  ds_read_b128 v[112:115], v243 offset:2048
  v_mfma_f32_16x16x32_bf16 v[76:79], v[148:151], v[164:167], v[76:79]
  buffer_load_dwordx4 v239, s[20:23], s33 offen offset:3584 sc1 lds
  s_add_u32 s33, s33, 294912
  s_waitcnt vmcnt(14)
  s_waitcnt lgkmcnt(6)
  v_mfma_f32_16x16x32_bf16 v[8:11], v[80:83], v[168:171], v[8:11]
  ds_read_b128 v[116:119], v243 offset:9216
  v_mfma_f32_16x16x32_bf16 v[12:15], v[80:83], v[172:175], v[12:15]
  v_mfma_f32_16x16x32_bf16 v[16:19], v[84:87], v[168:171], v[16:19]
  ds_read_b128 v[120:123], v243 offset:9472
  v_mfma_f32_16x16x32_bf16 v[20:23], v[84:87], v[172:175], v[20:23]
  buffer_load_dwordx4 v[152:155], v236, s[24:27], s32 offen offset:0 sc1
  v_mfma_f32_16x16x32_bf16 v[24:27], v[88:91], v[168:171], v[24:27]
  ds_read_b128 v[124:127], v243 offset:9728
  v_mfma_f32_16x16x32_bf16 v[28:31], v[88:91], v[172:175], v[28:31]
  s_waitcnt lgkmcnt(6)
  v_mfma_f32_16x16x32_bf16 v[32:35], v[92:95], v[168:171], v[32:35]
  ds_read_b128 v[128:131], v243 offset:9984
  v_mfma_f32_16x16x32_bf16 v[36:39], v[92:95], v[172:175], v[36:39]
  buffer_load_dwordx4 v[156:159], v237, s[24:27], s32 offen offset:0 sc1
  v_mfma_f32_16x16x32_bf16 v[40:43], v[96:99], v[168:171], v[40:43]
  ds_read_b128 v[132:135], v243 offset:10240
  v_mfma_f32_16x16x32_bf16 v[44:47], v[96:99], v[172:175], v[44:47]
  v_mfma_f32_16x16x32_bf16 v[48:51], v[100:103], v[168:171], v[48:51]
  ds_read_b128 v[136:139], v243 offset:10496
  v_mfma_f32_16x16x32_bf16 v[52:55], v[100:103], v[172:175], v[52:55]
  buffer_load_dwordx4 v[160:163], v236, s[24:27], s32 offen offset:1024 sc1
  s_waitcnt lgkmcnt(6)
  v_mfma_f32_16x16x32_bf16 v[56:59], v[104:107], v[168:171], v[56:59]
  ds_read_b128 v[140:143], v243 offset:10752
  v_mfma_f32_16x16x32_bf16 v[60:63], v[104:107], v[172:175], v[60:63]
  v_mfma_f32_16x16x32_bf16 v[64:67], v[108:111], v[168:171], v[64:67]
  ds_read_b128 v[144:147], v243 offset:11008
  v_mfma_f32_16x16x32_bf16 v[68:71], v[108:111], v[172:175], v[68:71]
  buffer_load_dwordx4 v[164:167], v237, s[24:27], s32 offen offset:1024 sc1
  s_add_u32 s32, s32, 2048
  v_mfma_f32_16x16x32_bf16 v[72:75], v[112:115], v[168:171], v[72:75]
  ds_read_b128 v[148:151], v243 offset:11264
  v_mfma_f32_16x16x32_bf16 v[76:79], v[112:115], v[172:175], v[76:79]
  s_waitcnt lgkmcnt(6)
  v_mfma_f32_16x16x32_bf16 v[8:11], v[116:119], v[176:179], v[8:11]
  s_waitcnt vmcnt(13)
  s_barrier
  ds_read_b128 v[80:83], v243 offset:18432
  v_mfma_f32_16x16x32_bf16 v[12:15], v[116:119], v[180:183], v[12:15]
  v_mfma_f32_16x16x32_bf16 v[16:19], v[120:123], v[176:179], v[16:19]
  ds_read_b128 v[84:87], v243 offset:18688
  v_mfma_f32_16x16x32_bf16 v[20:23], v[120:123], v[180:183], v[20:23]
  s_add_u32 m0, s34, 55296
  s_mov_b64 exec, s[40:41]
  buffer_load_dwordx4 v238, s[20:23], s33 offen sc1 lds
  s_mov_b64 exec, -1
  v_mfma_f32_16x16x32_bf16 v[24:27], v[124:127], v[176:179], v[24:27]
  ds_read_b128 v[88:91], v243 offset:18944
  v_mfma_f32_16x16x32_bf16 v[28:31], v[124:127], v[180:183], v[28:31]
  s_waitcnt lgkmcnt(6)
  v_mfma_f32_16x16x32_bf16 v[32:35], v[128:131], v[176:179], v[32:35]
  ds_read_b128 v[92:95], v243 offset:19200
  v_mfma_f32_16x16x32_bf16 v[36:39], v[128:131], v[180:183], v[36:39]
  buffer_load_dwordx4 v238, s[20:23], s33 offen offset:512 sc1 lds
  v_mfma_f32_16x16x32_bf16 v[40:43], v[132:135], v[176:179], v[40:43]
  ds_read_b128 v[96:99], v243 offset:19456
  v_mfma_f32_16x16x32_bf16 v[44:47], v[132:135], v[180:183], v[44:47]
  v_mfma_f32_16x16x32_bf16 v[48:51], v[136:139], v[176:179], v[48:51]
  ds_read_b128 v[100:103], v243 offset:19712
  v_mfma_f32_16x16x32_bf16 v[52:55], v[136:139], v[180:183], v[52:55]
  buffer_load_dwordx4 v240, s[20:23], s33 offen offset:1536 sc1 lds
  s_waitcnt lgkmcnt(6)
  v_mfma_f32_16x16x32_bf16 v[56:59], v[140:143], v[176:179], v[56:59]
  ds_read_b128 v[104:107], v243 offset:19968
  v_mfma_f32_16x16x32_bf16 v[60:63], v[140:143], v[180:183], v[60:63]
  v_mfma_f32_16x16x32_bf16 v[64:67], v[144:147], v[176:179], v[64:67]
  ds_read_b128 v[108:111], v243 offset:20224
  v_mfma_f32_16x16x32_bf16 v[68:71], v[144:147], v[180:183], v[68:71]
  buffer_load_dwordx4 v239, s[20:23], s33 offen offset:2560 sc1 lds
  v_mfma_f32_16x16x32_bf16 v[72:75], v[148:151], v[176:179], v[72:75]
  ds_read_b128 v[112:115], v243 offset:20480
  v_mfma_f32_16x16x32_bf16 v[76:79], v[148:151], v[180:183], v[76:79]
  buffer_load_dwordx4 v239, s[20:23], s33 offen offset:3584 sc1 lds
  s_add_u32 s33, s33, 294912
  s_waitcnt vmcnt(14)
  s_waitcnt lgkmcnt(6)
  v_mfma_f32_16x16x32_bf16 v[8:11], v[80:83], v[184:187], v[8:11]
  ds_read_b128 v[116:119], v243 offset:27648
  v_mfma_f32_16x16x32_bf16 v[12:15], v[80:83], v[188:191], v[12:15]
  v_mfma_f32_16x16x32_bf16 v[16:19], v[84:87], v[184:187], v[16:19]
  ds_read_b128 v[120:123], v243 offset:27904
  v_mfma_f32_16x16x32_bf16 v[20:23], v[84:87], v[188:191], v[20:23]
  buffer_load_dwordx4 v[168:171], v236, s[24:27], s32 offen offset:0 sc1
  v_mfma_f32_16x16x32_bf16 v[24:27], v[88:91], v[184:187], v[24:27]
  ds_read_b128 v[124:127], v243 offset:28160
  v_mfma_f32_16x16x32_bf16 v[28:31], v[88:91], v[188:191], v[28:31]
  s_waitcnt lgkmcnt(6)
  v_mfma_f32_16x16x32_bf16 v[32:35], v[92:95], v[184:187], v[32:35]
  ds_read_b128 v[128:131], v243 offset:28416
  v_mfma_f32_16x16x32_bf16 v[36:39], v[92:95], v[188:191], v[36:39]
  buffer_load_dwordx4 v[172:175], v237, s[24:27], s32 offen offset:0 sc1
  v_mfma_f32_16x16x32_bf16 v[40:43], v[96:99], v[184:187], v[40:43]
  ds_read_b128 v[132:135], v243 offset:28672
  v_mfma_f32_16x16x32_bf16 v[44:47], v[96:99], v[188:191], v[44:47]
  v_mfma_f32_16x16x32_bf16 v[48:51], v[100:103], v[184:187], v[48:51]
  ds_read_b128 v[136:139], v243 offset:28928
  v_mfma_f32_16x16x32_bf16 v[52:55], v[100:103], v[188:191], v[52:55]
  buffer_load_dwordx4 v[176:179], v236, s[24:27], s32 offen offset:1024 sc1
  s_waitcnt lgkmcnt(6)
  v_mfma_f32_16x16x32_bf16 v[56:59], v[104:107], v[184:187], v[56:59]
  ds_read_b128 v[140:143], v243 offset:29184
  v_mfma_f32_16x16x32_bf16 v[60:63], v[104:107], v[188:191], v[60:63]
  v_mfma_f32_16x16x32_bf16 v[64:67], v[108:111], v[184:187], v[64:67]
  ds_read_b128 v[144:147], v243 offset:29440
  v_mfma_f32_16x16x32_bf16 v[68:71], v[108:111], v[188:191], v[68:71]
  buffer_load_dwordx4 v[180:183], v237, s[24:27], s32 offen offset:1024 sc1
  s_add_u32 s32, s32, 2048
  v_mfma_f32_16x16x32_bf16 v[72:75], v[112:115], v[184:187], v[72:75]
  ds_read_b128 v[148:151], v243 offset:29696
  v_mfma_f32_16x16x32_bf16 v[76:79], v[112:115], v[188:191], v[76:79]
  s_waitcnt lgkmcnt(6)
  v_mfma_f32_16x16x32_bf16 v[8:11], v[116:119], v[192:195], v[8:11]
  s_waitcnt vmcnt(13)
  s_barrier
  ds_read_b128 v[80:83], v244 offset:0
  v_mfma_f32_16x16x32_bf16 v[12:15], v[116:119], v[196:199], v[12:15]
  v_mfma_f32_16x16x32_bf16 v[16:19], v[120:123], v[192:195], v[16:19]
  ds_read_b128 v[84:87], v244 offset:256
  v_mfma_f32_16x16x32_bf16 v[20:23], v[120:123], v[196:199], v[20:23]
  v_mfma_f32_16x16x32_bf16 v[24:27], v[124:127], v[192:195], v[24:27]
  ds_read_b128 v[88:91], v244 offset:512
  v_mfma_f32_16x16x32_bf16 v[28:31], v[124:127], v[196:199], v[28:31]
  s_waitcnt lgkmcnt(6)
  v_mfma_f32_16x16x32_bf16 v[32:35], v[128:131], v[192:195], v[32:35]
  ds_read_b128 v[92:95], v244 offset:768
  v_mfma_f32_16x16x32_bf16 v[36:39], v[128:131], v[196:199], v[36:39]
  v_mfma_f32_16x16x32_bf16 v[40:43], v[132:135], v[192:195], v[40:43]
  ds_read_b128 v[96:99], v244 offset:1024
  v_mfma_f32_16x16x32_bf16 v[44:47], v[132:135], v[196:199], v[44:47]
  v_mfma_f32_16x16x32_bf16 v[48:51], v[136:139], v[192:195], v[48:51]
  ds_read_b128 v[100:103], v244 offset:1280
  v_mfma_f32_16x16x32_bf16 v[52:55], v[136:139], v[196:199], v[52:55]
  s_waitcnt lgkmcnt(6)
  v_mfma_f32_16x16x32_bf16 v[56:59], v[140:143], v[192:195], v[56:59]
  ds_read_b128 v[104:107], v244 offset:1536
  v_mfma_f32_16x16x32_bf16 v[60:63], v[140:143], v[196:199], v[60:63]
  v_mfma_f32_16x16x32_bf16 v[64:67], v[144:147], v[192:195], v[64:67]
  ds_read_b128 v[108:111], v244 offset:1792
  v_mfma_f32_16x16x32_bf16 v[68:71], v[144:147], v[196:199], v[68:71]
  v_mfma_f32_16x16x32_bf16 v[72:75], v[148:151], v[192:195], v[72:75]
  ds_read_b128 v[112:115], v244 offset:2048
  v_mfma_f32_16x16x32_bf16 v[76:79], v[148:151], v[196:199], v[76:79]
  s_waitcnt vmcnt(9)
  s_waitcnt lgkmcnt(6)
  v_mfma_f32_16x16x32_bf16 v[8:11], v[80:83], v[152:155], v[8:11]
  ds_read_b128 v[116:119], v244 offset:9216
  v_mfma_f32_16x16x32_bf16 v[12:15], v[80:83], v[156:159], v[12:15]
  v_mfma_f32_16x16x32_bf16 v[16:19], v[84:87], v[152:155], v[16:19]
  ds_read_b128 v[120:123], v244 offset:9472
  v_mfma_f32_16x16x32_bf16 v[20:23], v[84:87], v[156:159], v[20:23]
  v_mfma_f32_16x16x32_bf16 v[24:27], v[88:91], v[152:155], v[24:27]
  ds_read_b128 v[124:127], v244 offset:9728
  v_mfma_f32_16x16x32_bf16 v[28:31], v[88:91], v[156:159], v[28:31]
  s_waitcnt lgkmcnt(6)
  v_mfma_f32_16x16x32_bf16 v[32:35], v[92:95], v[152:155], v[32:35]
  ds_read_b128 v[128:131], v244 offset:9984
  v_mfma_f32_16x16x32_bf16 v[36:39], v[92:95], v[156:159], v[36:39]
  v_mfma_f32_16x16x32_bf16 v[40:43], v[96:99], v[152:155], v[40:43]
  ds_read_b128 v[132:135], v244 offset:10240
  v_mfma_f32_16x16x32_bf16 v[44:47], v[96:99], v[156:159], v[44:47]
  v_mfma_f32_16x16x32_bf16 v[48:51], v[100:103], v[152:155], v[48:51]
  ds_read_b128 v[136:139], v244 offset:10496
  v_mfma_f32_16x16x32_bf16 v[52:55], v[100:103], v[156:159], v[52:55]
  s_waitcnt lgkmcnt(6)
  v_mfma_f32_16x16x32_bf16 v[56:59], v[104:107], v[152:155], v[56:59]
  ds_read_b128 v[140:143], v244 offset:10752
  v_mfma_f32_16x16x32_bf16 v[60:63], v[104:107], v[156:159], v[60:63]
  v_mfma_f32_16x16x32_bf16 v[64:67], v[108:111], v[152:155], v[64:67]
  ds_read_b128 v[144:147], v244 offset:11008
  v_mfma_f32_16x16x32_bf16 v[68:71], v[108:111], v[156:159], v[68:71]
  v_mfma_f32_16x16x32_bf16 v[72:75], v[112:115], v[152:155], v[72:75]
  ds_read_b128 v[148:151], v244 offset:11264
  v_mfma_f32_16x16x32_bf16 v[76:79], v[112:115], v[156:159], v[76:79]
  s_waitcnt lgkmcnt(6)
  v_mfma_f32_16x16x32_bf16 v[8:11], v[116:119], v[160:163], v[8:11]
  s_waitcnt vmcnt(4)
  s_barrier
  ds_read_b128 v[80:83], v244 offset:18432
  v_mfma_f32_16x16x32_bf16 v[12:15], v[116:119], v[164:167], v[12:15]
  v_mfma_f32_16x16x32_bf16 v[16:19], v[120:123], v[160:163], v[16:19]
  ds_read_b128 v[84:87], v244 offset:18688
  v_mfma_f32_16x16x32_bf16 v[20:23], v[120:123], v[164:167], v[20:23]
  v_mfma_f32_16x16x32_bf16 v[24:27], v[124:127], v[160:163], v[24:27]
  ds_read_b128 v[88:91], v244 offset:18944
  v_mfma_f32_16x16x32_bf16 v[28:31], v[124:127], v[164:167], v[28:31]
  s_waitcnt lgkmcnt(6)
  v_mfma_f32_16x16x32_bf16 v[32:35], v[128:131], v[160:163], v[32:35]
  ds_read_b128 v[92:95], v244 offset:19200
  v_mfma_f32_16x16x32_bf16 v[36:39], v[128:131], v[164:167], v[36:39]
  v_mfma_f32_16x16x32_bf16 v[40:43], v[132:135], v[160:163], v[40:43]
  ds_read_b128 v[96:99], v244 offset:19456
  v_mfma_f32_16x16x32_bf16 v[44:47], v[132:135], v[164:167], v[44:47]
  v_mfma_f32_16x16x32_bf16 v[48:51], v[136:139], v[160:163], v[48:51]
  ds_read_b128 v[100:103], v244 offset:19712
  v_mfma_f32_16x16x32_bf16 v[52:55], v[136:139], v[164:167], v[52:55]
  s_waitcnt lgkmcnt(6)
  v_mfma_f32_16x16x32_bf16 v[56:59], v[140:143], v[160:163], v[56:59]
  ds_read_b128 v[104:107], v244 offset:19968
  v_mfma_f32_16x16x32_bf16 v[60:63], v[140:143], v[164:167], v[60:63]
  v_mfma_f32_16x16x32_bf16 v[64:67], v[144:147], v[160:163], v[64:67]
  ds_read_b128 v[108:111], v244 offset:20224
  v_mfma_f32_16x16x32_bf16 v[68:71], v[144:147], v[164:167], v[68:71]
  v_mfma_f32_16x16x32_bf16 v[72:75], v[148:151], v[160:163], v[72:75]
  ds_read_b128 v[112:115], v244 offset:20480
  v_mfma_f32_16x16x32_bf16 v[76:79], v[148:151], v[164:167], v[76:79]
  s_waitcnt vmcnt(0)
  s_waitcnt lgkmcnt(6)
  v_mfma_f32_16x16x32_bf16 v[8:11], v[80:83], v[168:171], v[8:11]
  ds_read_b128 v[116:119], v244 offset:27648
  v_mfma_f32_16x16x32_bf16 v[12:15], v[80:83], v[172:175], v[12:15]
  v_mfma_f32_16x16x32_bf16 v[16:19], v[84:87], v[168:171], v[16:19]
  ds_read_b128 v[120:123], v244 offset:27904
  v_mfma_f32_16x16x32_bf16 v[20:23], v[84:87], v[172:175], v[20:23]
  v_mfma_f32_16x16x32_bf16 v[24:27], v[88:91], v[168:171], v[24:27]
  ds_read_b128 v[124:127], v244 offset:28160
  v_mfma_f32_16x16x32_bf16 v[28:31], v[88:91], v[172:175], v[28:31]
  s_waitcnt lgkmcnt(6)
  v_mfma_f32_16x16x32_bf16 v[32:35], v[92:95], v[168:171], v[32:35]
  ds_read_b128 v[128:131], v244 offset:28416
  v_mfma_f32_16x16x32_bf16 v[36:39], v[92:95], v[172:175], v[36:39]
  v_mfma_f32_16x16x32_bf16 v[40:43], v[96:99], v[168:171], v[40:43]
  ds_read_b128 v[132:135], v244 offset:28672
  v_mfma_f32_16x16x32_bf16 v[44:47], v[96:99], v[172:175], v[44:47]
  v_mfma_f32_16x16x32_bf16 v[48:51], v[100:103], v[168:171], v[48:51]
  ds_read_b128 v[136:139], v244 offset:28928
  v_mfma_f32_16x16x32_bf16 v[52:55], v[100:103], v[172:175], v[52:55]
  s_waitcnt lgkmcnt(6)
  v_mfma_f32_16x16x32_bf16 v[56:59], v[104:107], v[168:171], v[56:59]
  ds_read_b128 v[140:143], v244 offset:29184
  v_mfma_f32_16x16x32_bf16 v[60:63], v[104:107], v[172:175], v[60:63]
  v_mfma_f32_16x16x32_bf16 v[64:67], v[108:111], v[168:171], v[64:67]
  ds_read_b128 v[144:147], v244 offset:29440
  v_mfma_f32_16x16x32_bf16 v[68:71], v[108:111], v[172:175], v[68:71]
  v_mfma_f32_16x16x32_bf16 v[72:75], v[112:115], v[168:171], v[72:75]
  ds_read_b128 v[148:151], v244 offset:29696
  v_mfma_f32_16x16x32_bf16 v[76:79], v[112:115], v[172:175], v[76:79]
  s_waitcnt lgkmcnt(6)
  v_mfma_f32_16x16x32_bf16 v[8:11], v[116:119], v[176:179], v[8:11]
  v_mfma_f32_16x16x32_bf16 v[12:15], v[116:119], v[180:183], v[12:15]
  v_mfma_f32_16x16x32_bf16 v[16:19], v[120:123], v[176:179], v[16:19]
  v_mfma_f32_16x16x32_bf16 v[20:23], v[120:123], v[180:183], v[20:23]
  v_mfma_f32_16x16x32_bf16 v[24:27], v[124:127], v[176:179], v[24:27]
  v_mfma_f32_16x16x32_bf16 v[28:31], v[124:127], v[180:183], v[28:31]
  s_waitcnt lgkmcnt(3)
  v_mfma_f32_16x16x32_bf16 v[32:35], v[128:131], v[176:179], v[32:35]
  v_mfma_f32_16x16x32_bf16 v[36:39], v[128:131], v[180:183], v[36:39]
  v_mfma_f32_16x16x32_bf16 v[40:43], v[132:135], v[176:179], v[40:43]
  v_mfma_f32_16x16x32_bf16 v[44:47], v[132:135], v[180:183], v[44:47]
  v_mfma_f32_16x16x32_bf16 v[48:51], v[136:139], v[176:179], v[48:51]
  v_mfma_f32_16x16x32_bf16 v[52:55], v[136:139], v[180:183], v[52:55]
  s_waitcnt lgkmcnt(0)
  v_mfma_f32_16x16x32_bf16 v[56:59], v[140:143], v[176:179], v[56:59]
  v_mfma_f32_16x16x32_bf16 v[60:63], v[140:143], v[180:183], v[60:63]
  v_mfma_f32_16x16x32_bf16 v[64:67], v[144:147], v[176:179], v[64:67]
  v_mfma_f32_16x16x32_bf16 v[68:71], v[144:147], v[180:183], v[68:71]
  v_mfma_f32_16x16x32_bf16 v[72:75], v[148:151], v[176:179], v[72:75]
  v_mfma_f32_16x16x32_bf16 v[76:79], v[148:151], v[180:183], v[76:79]
  v_lshlrev_b32 v254, 16, v254
  v_lshlrev_b32 v255, 16, v255
  v_lshrrev_b32 v5, 1, v4
  v_lshlrev_b32 v5, 11, v5
  v_and_b32 v6, 1, v4
  v_lshl_add_u32 v5, v6, 4, v5
  v_add_u32 v5, v5, v3
  v_add_u32 v5, s66, v5
  v_lshlrev_b32 v5, 4, v5
  s_mul_i32 s39, s37, 589824
  s_nop 4
  v_lshlrev_b32 v116, 16, v200
  v_and_b32 v117, 0xffff0000, v200
  v_add_f32 v8, v8, v254
  v_add_f32 v9, v9, v254
  v_pk_mul_f32 v[8:9], v[8:9], v[116:117]
  v_cvt_pk_bf16_f32 v80, v8, v9
  v_lshlrev_b32 v118, 16, v201
  v_and_b32 v119, 0xffff0000, v201
  v_add_f32 v10, v10, v254
  v_add_f32 v11, v11, v254
  v_pk_mul_f32 v[10:11], v[10:11], v[118:119]
  v_cvt_pk_bf16_f32 v81, v10, v11
  v_lshlrev_b32 v120, 16, v202
  v_and_b32 v121, 0xffff0000, v202
  v_add_f32 v12, v12, v255
  v_add_f32 v13, v13, v255
  v_pk_mul_f32 v[12:13], v[12:13], v[120:121]
  v_cvt_pk_bf16_f32 v82, v12, v13
  v_lshlrev_b32 v122, 16, v203
  v_and_b32 v123, 0xffff0000, v203
  v_add_f32 v14, v14, v255
  v_add_f32 v15, v15, v255
  v_pk_mul_f32 v[14:15], v[14:15], v[122:123]
  v_cvt_pk_bf16_f32 v83, v14, v15
  s_nop 1
  v_permlane16_swap_b32 v80, v82
  v_permlane16_swap_b32 v81, v83
  buffer_store_dwordx4 v[80:83], v5, s[72:75], s39 offen sc1
  s_add_u32 s39, s39, 65536
  v_lshlrev_b32 v116, 16, v204
  v_and_b32 v117, 0xffff0000, v204
  v_add_f32 v16, v16, v254
  v_add_f32 v17, v17, v254
  v_pk_mul_f32 v[16:17], v[16:17], v[116:117]
  v_cvt_pk_bf16_f32 v84, v16, v17
  v_lshlrev_b32 v118, 16, v205
  v_and_b32 v119, 0xffff0000, v205
  v_add_f32 v18, v18, v254
  v_add_f32 v19, v19, v254
  v_pk_mul_f32 v[18:19], v[18:19], v[118:119]
  v_cvt_pk_bf16_f32 v85, v18, v19
  v_lshlrev_b32 v120, 16, v206
  v_and_b32 v121, 0xffff0000, v206
  v_add_f32 v20, v20, v255
  v_add_f32 v21, v21, v255
  v_pk_mul_f32 v[20:21], v[20:21], v[120:121]
  v_cvt_pk_bf16_f32 v86, v20, v21
  v_lshlrev_b32 v122, 16, v207
  v_and_b32 v123, 0xffff0000, v207
  v_add_f32 v22, v22, v255
  v_add_f32 v23, v23, v255
  v_pk_mul_f32 v[22:23], v[22:23], v[122:123]
  v_cvt_pk_bf16_f32 v87, v22, v23
  s_nop 1
  v_permlane16_swap_b32 v84, v86
  v_permlane16_swap_b32 v85, v87
  buffer_store_dwordx4 v[84:87], v5, s[72:75], s39 offen sc1
  s_add_u32 s39, s39, 65536
  v_lshlrev_b32 v116, 16, v208
  v_and_b32 v117, 0xffff0000, v208
  v_add_f32 v24, v24, v254
  v_add_f32 v25, v25, v254
  v_pk_mul_f32 v[24:25], v[24:25], v[116:117]
  v_cvt_pk_bf16_f32 v88, v24, v25
  v_lshlrev_b32 v118, 16, v209
  v_and_b32 v119, 0xffff0000, v209
  v_add_f32 v26, v26, v254
  v_add_f32 v27, v27, v254
  v_pk_mul_f32 v[26:27], v[26:27], v[118:119]
  v_cvt_pk_bf16_f32 v89, v26, v27
  v_lshlrev_b32 v120, 16, v210
  v_and_b32 v121, 0xffff0000, v210
  v_add_f32 v28, v28, v255
  v_add_f32 v29, v29, v255
  v_pk_mul_f32 v[28:29], v[28:29], v[120:121]
  v_cvt_pk_bf16_f32 v90, v28, v29
  v_lshlrev_b32 v122, 16, v211
  v_and_b32 v123, 0xffff0000, v211
  v_add_f32 v30, v30, v255
  v_add_f32 v31, v31, v255
  v_pk_mul_f32 v[30:31], v[30:31], v[122:123]
  v_cvt_pk_bf16_f32 v91, v30, v31
  s_nop 1
  v_permlane16_swap_b32 v88, v90
  v_permlane16_swap_b32 v89, v91
  buffer_store_dwordx4 v[88:91], v5, s[72:75], s39 offen sc1
  s_add_u32 s39, s39, 65536
  v_lshlrev_b32 v116, 16, v212
  v_and_b32 v117, 0xffff0000, v212
  v_add_f32 v32, v32, v254
  v_add_f32 v33, v33, v254
  v_pk_mul_f32 v[32:33], v[32:33], v[116:117]
  v_cvt_pk_bf16_f32 v92, v32, v33
  v_lshlrev_b32 v118, 16, v213
  v_and_b32 v119, 0xffff0000, v213
  v_add_f32 v34, v34, v254
  v_add_f32 v35, v35, v254
  v_pk_mul_f32 v[34:35], v[34:35], v[118:119]
  v_cvt_pk_bf16_f32 v93, v34, v35
  v_lshlrev_b32 v120, 16, v214
  v_and_b32 v121, 0xffff0000, v214
  v_add_f32 v36, v36, v255
  v_add_f32 v37, v37, v255
  v_pk_mul_f32 v[36:37], v[36:37], v[120:121]
  v_cvt_pk_bf16_f32 v94, v36, v37
  v_lshlrev_b32 v122, 16, v215
  v_and_b32 v123, 0xffff0000, v215
  v_add_f32 v38, v38, v255
  v_add_f32 v39, v39, v255
  v_pk_mul_f32 v[38:39], v[38:39], v[122:123]
  v_cvt_pk_bf16_f32 v95, v38, v39
  s_nop 1
  v_permlane16_swap_b32 v92, v94
  v_permlane16_swap_b32 v93, v95
  buffer_store_dwordx4 v[92:95], v5, s[72:75], s39 offen sc1
  s_add_u32 s39, s39, 65536
  v_lshlrev_b32 v116, 16, v216
  v_and_b32 v117, 0xffff0000, v216
  v_add_f32 v40, v40, v254
  v_add_f32 v41, v41, v254
  v_pk_mul_f32 v[40:41], v[40:41], v[116:117]
  v_cvt_pk_bf16_f32 v80, v40, v41
  v_lshlrev_b32 v118, 16, v217
  v_and_b32 v119, 0xffff0000, v217
  v_add_f32 v42, v42, v254
  v_add_f32 v43, v43, v254
  v_pk_mul_f32 v[42:43], v[42:43], v[118:119]
  v_cvt_pk_bf16_f32 v81, v42, v43
  v_lshlrev_b32 v120, 16, v218
  v_and_b32 v121, 0xffff0000, v218
  v_add_f32 v44, v44, v255
  v_add_f32 v45, v45, v255
  v_pk_mul_f32 v[44:45], v[44:45], v[120:121]
  v_cvt_pk_bf16_f32 v82, v44, v45
  v_lshlrev_b32 v122, 16, v219
  v_and_b32 v123, 0xffff0000, v219
  v_add_f32 v46, v46, v255
  v_add_f32 v47, v47, v255
  v_pk_mul_f32 v[46:47], v[46:47], v[122:123]
  v_cvt_pk_bf16_f32 v83, v46, v47
  s_nop 1
  v_permlane16_swap_b32 v80, v82
  v_permlane16_swap_b32 v81, v83
  buffer_store_dwordx4 v[80:83], v5, s[72:75], s39 offen sc1
  s_add_u32 s39, s39, 65536
  v_lshlrev_b32 v116, 16, v220
  v_and_b32 v117, 0xffff0000, v220
  v_add_f32 v48, v48, v254
  v_add_f32 v49, v49, v254
  v_pk_mul_f32 v[48:49], v[48:49], v[116:117]
  v_cvt_pk_bf16_f32 v84, v48, v49
  v_lshlrev_b32 v118, 16, v221
  v_and_b32 v119, 0xffff0000, v221
  v_add_f32 v50, v50, v254
  v_add_f32 v51, v51, v254
  v_pk_mul_f32 v[50:51], v[50:51], v[118:119]
  v_cvt_pk_bf16_f32 v85, v50, v51
  v_lshlrev_b32 v120, 16, v222
  v_and_b32 v121, 0xffff0000, v222
  v_add_f32 v52, v52, v255
  v_add_f32 v53, v53, v255
  v_pk_mul_f32 v[52:53], v[52:53], v[120:121]
  v_cvt_pk_bf16_f32 v86, v52, v53
  v_lshlrev_b32 v122, 16, v223
  v_and_b32 v123, 0xffff0000, v223
  v_add_f32 v54, v54, v255
  v_add_f32 v55, v55, v255
  v_pk_mul_f32 v[54:55], v[54:55], v[122:123]
  v_cvt_pk_bf16_f32 v87, v54, v55
  s_nop 1
  v_permlane16_swap_b32 v84, v86
  v_permlane16_swap_b32 v85, v87
  buffer_store_dwordx4 v[84:87], v5, s[72:75], s39 offen sc1
  s_add_u32 s39, s39, 65536
  v_lshlrev_b32 v116, 16, v224
  v_and_b32 v117, 0xffff0000, v224
  v_add_f32 v56, v56, v254
  v_add_f32 v57, v57, v254
  v_pk_mul_f32 v[56:57], v[56:57], v[116:117]
  v_cvt_pk_bf16_f32 v88, v56, v57
  v_lshlrev_b32 v118, 16, v225
  v_and_b32 v119, 0xffff0000, v225
  v_add_f32 v58, v58, v254
  v_add_f32 v59, v59, v254
  v_pk_mul_f32 v[58:59], v[58:59], v[118:119]
  v_cvt_pk_bf16_f32 v89, v58, v59
  v_lshlrev_b32 v120, 16, v226
  v_and_b32 v121, 0xffff0000, v226
  v_add_f32 v60, v60, v255
  v_add_f32 v61, v61, v255
  v_pk_mul_f32 v[60:61], v[60:61], v[120:121]
  v_cvt_pk_bf16_f32 v90, v60, v61
  v_lshlrev_b32 v122, 16, v227
  v_and_b32 v123, 0xffff0000, v227
  v_add_f32 v62, v62, v255
  v_add_f32 v63, v63, v255
  v_pk_mul_f32 v[62:63], v[62:63], v[122:123]
  v_cvt_pk_bf16_f32 v91, v62, v63
  s_nop 1
  v_permlane16_swap_b32 v88, v90
  v_permlane16_swap_b32 v89, v91
  buffer_store_dwordx4 v[88:91], v5, s[72:75], s39 offen sc1
  s_add_u32 s39, s39, 65536
  v_lshlrev_b32 v116, 16, v228
  v_and_b32 v117, 0xffff0000, v228
  v_add_f32 v64, v64, v254
  v_add_f32 v65, v65, v254
  v_pk_mul_f32 v[64:65], v[64:65], v[116:117]
  v_cvt_pk_bf16_f32 v92, v64, v65
  v_lshlrev_b32 v118, 16, v229
  v_and_b32 v119, 0xffff0000, v229
  v_add_f32 v66, v66, v254
  v_add_f32 v67, v67, v254
  v_pk_mul_f32 v[66:67], v[66:67], v[118:119]
  v_cvt_pk_bf16_f32 v93, v66, v67
  v_lshlrev_b32 v120, 16, v230
  v_and_b32 v121, 0xffff0000, v230
  v_add_f32 v68, v68, v255
  v_add_f32 v69, v69, v255
  v_pk_mul_f32 v[68:69], v[68:69], v[120:121]
  v_cvt_pk_bf16_f32 v94, v68, v69
  v_lshlrev_b32 v122, 16, v231
  v_and_b32 v123, 0xffff0000, v231
  v_add_f32 v70, v70, v255
  v_add_f32 v71, v71, v255
  v_pk_mul_f32 v[70:71], v[70:71], v[122:123]
  v_cvt_pk_bf16_f32 v95, v70, v71
  s_nop 1
  v_permlane16_swap_b32 v92, v94
  v_permlane16_swap_b32 v93, v95
  buffer_store_dwordx4 v[92:95], v5, s[72:75], s39 offen sc1
  s_add_u32 s39, s39, 65536
  v_lshlrev_b32 v116, 16, v232
  v_and_b32 v117, 0xffff0000, v232
  v_add_f32 v72, v72, v254
  v_add_f32 v73, v73, v254
  v_pk_mul_f32 v[72:73], v[72:73], v[116:117]
  v_cvt_pk_bf16_f32 v80, v72, v73
  v_lshlrev_b32 v118, 16, v233
  v_and_b32 v119, 0xffff0000, v233
  v_add_f32 v74, v74, v254
  v_add_f32 v75, v75, v254
  v_pk_mul_f32 v[74:75], v[74:75], v[118:119]
  v_cvt_pk_bf16_f32 v81, v74, v75
  v_lshlrev_b32 v120, 16, v234
  v_and_b32 v121, 0xffff0000, v234
  v_add_f32 v76, v76, v255
  v_add_f32 v77, v77, v255
  v_pk_mul_f32 v[76:77], v[76:77], v[120:121]
  v_cvt_pk_bf16_f32 v82, v76, v77
  v_lshlrev_b32 v122, 16, v235
  v_and_b32 v123, 0xffff0000, v235
  v_add_f32 v78, v78, v255
  v_add_f32 v79, v79, v255
  v_pk_mul_f32 v[78:79], v[78:79], v[122:123]
  v_cvt_pk_bf16_f32 v83, v78, v79
  s_nop 1
  v_permlane16_swap_b32 v80, v82
  v_permlane16_swap_b32 v81, v83
  buffer_store_dwordx4 v[80:83], v5, s[72:75], s39 offen sc1
  s_add_u32 s39, s39, 65536
  s_lshl_b32 s68, s36, 1
  s_lshr_b32 s31, s37, 3
  s_add_u32 s68, s68, s31
  s_and_b32 s69, s37, 7
  s_add_u32 s8, s6, 0x2c45000
  s_addc_u32 s9, s7, 0
  s_mov_b32 s10, 0x2d0000
  s_mov_b32 s11, 0x20000
  s_add_u32 s12, s6, 0x1d40000
  s_addc_u32 s13, s7, 0
  s_mov_b32 s14, 0x240000
  s_mov_b32 s15, 0x20000
  s_mov_b32 s16, s62
  s_mov_b32 s17, s63
  s_mov_b32 s18, 0x240000
  s_mov_b32 s19, 0x20000
  s_mov_b32 s20, s64
  s_mov_b32 s21, s65
  s_mov_b32 s22, 0x240000
  s_mov_b32 s23, 0x20000
  s_lshl_b32 s71, s69, 8
  s_add_u32 s71, s71, 8192
  s_add_u32 s24, s6, 0x2f15000
  s_addc_u32 s25, s7, 0
  s_mov_b32 s26, 0x8000
  s_mov_b32 s27, 0x20000
  v_and_b32 v2, 63, v0
  v_and_b32 v3, 15, v2
  v_lshrrev_b32 v4, 4, v2
  s_mul_i32 s38, s69, 72
  s_mul_i32 s39, s35, 18
  s_add_u32 s38, s38, s39
  s_mul_i32 s38, s38, 5120
  v_lshl_add_u32 v1, v2, 4, s38
  s_mov_b32 s40, 0
  s_mov_b32 s41, 0
  buffer_load_dwordx4 v[104:107], v1, s[8:11], s41 offen offset:0 sc1
  buffer_load_dwordx4 v[108:111], v1, s[8:11], s41 offen offset:1024 sc1
  buffer_load_dwordx4 v[112:115], v1, s[8:11], s41 offen offset:2048 sc1
  buffer_load_dwordx4 v[116:119], v1, s[8:11], s41 offen offset:3072 sc1
  s_add_u32 s41, s41, 4096
  buffer_load_dwordx4 v[120:123], v1, s[8:11], s41 offen sc1
  s_add_u32 s41, s41, 1024
  buffer_load_dwordx4 v[140:143], v1, s[8:11], s41 offen offset:0 sc1
  buffer_load_dwordx4 v[144:147], v1, s[8:11], s41 offen offset:1024 sc1
  buffer_load_dwordx4 v[148:151], v1, s[8:11], s41 offen offset:2048 sc1
  buffer_load_dwordx4 v[152:155], v1, s[8:11], s41 offen offset:3072 sc1
  s_add_u32 s41, s41, 4096
  buffer_load_dwordx4 v[156:159], v1, s[8:11], s41 offen sc1
  s_add_u32 s41, s41, 1024
  buffer_load_dwordx4 v[176:179], v1, s[8:11], s41 offen offset:0 sc1
  buffer_load_dwordx4 v[180:183], v1, s[8:11], s41 offen offset:1024 sc1
  buffer_load_dwordx4 v[184:187], v1, s[8:11], s41 offen offset:2048 sc1
  buffer_load_dwordx4 v[188:191], v1, s[8:11], s41 offen offset:3072 sc1
  s_add_u32 s41, s41, 4096
  buffer_load_dwordx4 v[192:195], v1, s[8:11], s41 offen sc1
  s_add_u32 s41, s41, 1024
  s_lshl_b32 s38, s68, 6
  s_lshl_b32 s39, s35, 4
  s_add_u32 s38, s38, s39
  v_add_u32 v5, s38, v3
  v_mul_u32_u24 v5, 1152, v5
  v_lshl_add_u32 v5, v4, 3, v5
  s_mul_i32 s38, s69, 144
  v_add_u32 v5, s38, v5
  buffer_load_dwordx2 v[248:249], v5, s[16:19], 0 offen offset:0
  buffer_load_dwordx2 v[250:251], v5, s[16:19], 0 offen offset:32
  buffer_load_dwordx2 v[252:253], v5, s[16:19], 0 offen offset:64
  buffer_load_dwordx2 v[254:255], v5, s[16:19], 0 offen offset:96
  buffer_load_dwordx2 v[6:7], v5, s[16:19], 0 offen offset:128
  s_lshl_b32 s38, s68, 10
  s_mul_i32 s39, s35, 2359296
  s_add_u32 s38, s38, s39
  v_lshlrev_b32 v5, 15, v4
  v_lshl_add_u32 v5, v3, 4, v5
  s_add_u32 s39, s35, 0
  s_and_b32 s39, s39, 3
  s_lshl_b32 s39, s39, 8
  s_add_u32 s39, s39, s38
  v_add_u32 v232, s39, v5
  s_add_u32 s39, s35, 1
  s_and_b32 s39, s39, 3
  s_lshl_b32 s39, s39, 8
  s_add_u32 s39, s39, s38
  v_add_u32 v233, s39, v5
  s_add_u32 s39, s35, 2
  s_and_b32 s39, s39, 3
  s_lshl_b32 s39, s39, 8
  s_add_u32 s39, s39, s38
  v_add_u32 v234, s39, v5
  s_add_u32 s39, s35, 3
  s_and_b32 s39, s39, 3
  s_lshl_b32 s39, s39, 8
  s_add_u32 s39, s39, s38
  v_add_u32 v235, s39, v5
  s_lshl_b32 s67, s36, 8
  s_add_u32 s67, s67, 4096
  s_waitcnt vmcnt(20)
  s_barrier
  s_cmp_eq_u32 s35, 0
  s_cbranch_scc0 sig_10
  v_mov_b32 v86, s67
  s_mov_b64 s[56:57], exec
  s_mov_b64 exec, 1
  v_mov_b32 v87, 1
  buffer_atomic_add v87, v86, s[44:47], 0 offen sc1
  s_mov_b64 exec, s[56:57]
sig_10:
  s_cmp_eq_u32 s35, 0
  s_cbranch_scc0 wfx_12
  v_mov_b32 v86, s67
  s_mov_b32 s58, 0x8000
wf_11:
  buffer_load_dword v87, v86, s[44:47], 0 offen sc0 sc1
  s_waitcnt vmcnt(0)
  v_readfirstlane_b32 s59, v87
  s_cmp_ge_u32 s59, 16
  s_cbranch_scc1 wfx_12
  s_sleep 2
  s_sub_u32 s58, s58, 1
  s_cmp_lg_u32 s58, 0
  s_cbranch_scc1 wf_11
wfx_12:
  s_barrier
  buffer_load_dwordx4 v[88:91], v232, s[72:75], s40 offen sc1
  buffer_load_dwordx4 v[92:95], v233, s[72:75], s40 offen sc1
  buffer_load_dwordx4 v[96:99], v234, s[72:75], s40 offen sc1
  buffer_load_dwordx4 v[100:103], v235, s[72:75], s40 offen sc1
  s_add_u32 s40, s40, 131072
  buffer_load_dwordx4 v[124:127], v232, s[72:75], s40 offen sc1
  buffer_load_dwordx4 v[128:131], v233, s[72:75], s40 offen sc1
  buffer_load_dwordx4 v[132:135], v234, s[72:75], s40 offen sc1
  buffer_load_dwordx4 v[136:139], v235, s[72:75], s40 offen sc1
  s_add_u32 s40, s40, 131072
  buffer_load_dwordx4 v[160:163], v232, s[72:75], s40 offen sc1
  buffer_load_dwordx4 v[164:167], v233, s[72:75], s40 offen sc1
  buffer_load_dwordx4 v[168:171], v234, s[72:75], s40 offen sc1
  buffer_load_dwordx4 v[172:175], v235, s[72:75], s40 offen sc1
  s_add_u32 s40, s40, 131072
  v_mov_b32 v8, 0
  v_mov_b32 v9, 0
  v_mov_b32 v10, 0
  v_mov_b32 v11, 0
  v_mov_b32 v12, 0
  v_mov_b32 v13, 0
  v_mov_b32 v14, 0
  v_mov_b32 v15, 0
  v_mov_b32 v16, 0
  v_mov_b32 v17, 0
  v_mov_b32 v18, 0
  v_mov_b32 v19, 0
  v_mov_b32 v20, 0
  v_mov_b32 v21, 0
  v_mov_b32 v22, 0
  v_mov_b32 v23, 0
  v_mov_b32 v24, 0
  v_mov_b32 v25, 0
  v_mov_b32 v26, 0
  v_mov_b32 v27, 0
  v_mov_b32 v28, 0
  v_mov_b32 v29, 0
  v_mov_b32 v30, 0
  v_mov_b32 v31, 0
  v_mov_b32 v32, 0
  v_mov_b32 v33, 0
  v_mov_b32 v34, 0
  v_mov_b32 v35, 0
  v_mov_b32 v36, 0
  v_mov_b32 v37, 0
  v_mov_b32 v38, 0
  v_mov_b32 v39, 0
  v_mov_b32 v40, 0
  v_mov_b32 v41, 0
  v_mov_b32 v42, 0
  v_mov_b32 v43, 0
  v_mov_b32 v44, 0
  v_mov_b32 v45, 0
  v_mov_b32 v46, 0
  v_mov_b32 v47, 0
  v_mov_b32 v48, 0
  v_mov_b32 v49, 0
  v_mov_b32 v50, 0
  v_mov_b32 v51, 0
  v_mov_b32 v52, 0
  v_mov_b32 v53, 0
  v_mov_b32 v54, 0
  v_mov_b32 v55, 0
  v_mov_b32 v56, 0
  v_mov_b32 v57, 0
  v_mov_b32 v58, 0
  v_mov_b32 v59, 0
  v_mov_b32 v60, 0
  v_mov_b32 v61, 0
  v_mov_b32 v62, 0
  v_mov_b32 v63, 0
  v_mov_b32 v64, 0
  v_mov_b32 v65, 0
  v_mov_b32 v66, 0
  v_mov_b32 v67, 0
  v_mov_b32 v68, 0
  v_mov_b32 v69, 0
  v_mov_b32 v70, 0
  v_mov_b32 v71, 0
  v_mov_b32 v72, 0
  v_mov_b32 v73, 0
  v_mov_b32 v74, 0
  v_mov_b32 v75, 0
  v_mov_b32 v76, 0
  v_mov_b32 v77, 0
  v_mov_b32 v78, 0
  v_mov_b32 v79, 0
  v_mov_b32 v80, 0
  v_mov_b32 v81, 0
  v_mov_b32 v82, 0
  v_mov_b32 v83, 0
  v_mov_b32 v84, 0
  v_mov_b32 v85, 0
  v_mov_b32 v86, 0
  v_mov_b32 v87, 0
  s_waitcnt vmcnt(8)
  v_mfma_f32_16x16x32_bf16 v[8:11], v[104:107], v[88:91], v[8:11]
  v_mfma_f32_16x16x32_bf16 v[12:15], v[104:107], v[92:95], v[12:15]
  buffer_load_dwordx4 v[196:199], v232, s[72:75], s40 offen sc1
  v_mfma_f32_16x16x32_bf16 v[16:19], v[104:107], v[96:99], v[16:19]
  buffer_load_dwordx4 v[200:203], v233, s[72:75], s40 offen sc1
  v_mfma_f32_16x16x32_bf16 v[20:23], v[104:107], v[100:103], v[20:23]
  buffer_load_dwordx4 v[204:207], v234, s[72:75], s40 offen sc1
  v_mfma_f32_16x16x32_bf16 v[24:27], v[108:111], v[88:91], v[24:27]
  buffer_load_dwordx4 v[208:211], v235, s[72:75], s40 offen sc1
  v_mfma_f32_16x16x32_bf16 v[28:31], v[108:111], v[92:95], v[28:31]
  s_add_u32 s40, s40, 131072
  v_mfma_f32_16x16x32_bf16 v[32:35], v[108:111], v[96:99], v[32:35]
  buffer_load_dwordx4 v[212:215], v1, s[8:11], s41 offen offset:0 sc1
  v_mfma_f32_16x16x32_bf16 v[36:39], v[108:111], v[100:103], v[36:39]
  buffer_load_dwordx4 v[216:219], v1, s[8:11], s41 offen offset:1024 sc1
  v_mfma_f32_16x16x32_bf16 v[40:43], v[112:115], v[88:91], v[40:43]
  buffer_load_dwordx4 v[220:223], v1, s[8:11], s41 offen offset:2048 sc1
  v_mfma_f32_16x16x32_bf16 v[44:47], v[112:115], v[92:95], v[44:47]
  buffer_load_dwordx4 v[224:227], v1, s[8:11], s41 offen offset:3072 sc1
  v_mfma_f32_16x16x32_bf16 v[48:51], v[112:115], v[96:99], v[48:51]
  s_add_u32 s41, s41, 4096
  v_mfma_f32_16x16x32_bf16 v[52:55], v[112:115], v[100:103], v[52:55]
  buffer_load_dwordx4 v[228:231], v1, s[8:11], s41 offen sc1
  v_mfma_f32_16x16x32_bf16 v[56:59], v[116:119], v[88:91], v[56:59]
  s_add_u32 s41, s41, 1024
  v_mfma_f32_16x16x32_bf16 v[60:63], v[116:119], v[92:95], v[60:63]
  v_mfma_f32_16x16x32_bf16 v[64:67], v[116:119], v[96:99], v[64:67]
  v_mfma_f32_16x16x32_bf16 v[68:71], v[116:119], v[100:103], v[68:71]
  v_mfma_f32_16x16x32_bf16 v[72:75], v[120:123], v[88:91], v[72:75]
  v_mfma_f32_16x16x32_bf16 v[76:79], v[120:123], v[92:95], v[76:79]
  v_mfma_f32_16x16x32_bf16 v[80:83], v[120:123], v[96:99], v[80:83]
  v_mfma_f32_16x16x32_bf16 v[84:87], v[120:123], v[100:103], v[84:87]
  s_waitcnt vmcnt(13)
  v_mfma_f32_16x16x32_bf16 v[8:11], v[140:143], v[124:127], v[8:11]
  v_mfma_f32_16x16x32_bf16 v[12:15], v[140:143], v[128:131], v[12:15]
  buffer_load_dwordx4 v[88:91], v232, s[72:75], s40 offen sc1
  v_mfma_f32_16x16x32_bf16 v[16:19], v[140:143], v[132:135], v[16:19]
  buffer_load_dwordx4 v[92:95], v233, s[72:75], s40 offen sc1
  v_mfma_f32_16x16x32_bf16 v[20:23], v[140:143], v[136:139], v[20:23]
  buffer_load_dwordx4 v[96:99], v234, s[72:75], s40 offen sc1
  v_mfma_f32_16x16x32_bf16 v[24:27], v[144:147], v[124:127], v[24:27]
  buffer_load_dwordx4 v[100:103], v235, s[72:75], s40 offen sc1
  v_mfma_f32_16x16x32_bf16 v[28:31], v[144:147], v[128:131], v[28:31]
  s_add_u32 s40, s40, 131072
  v_mfma_f32_16x16x32_bf16 v[32:35], v[144:147], v[132:135], v[32:35]
  buffer_load_dwordx4 v[104:107], v1, s[8:11], s41 offen offset:0 sc1
  v_mfma_f32_16x16x32_bf16 v[36:39], v[144:147], v[136:139], v[36:39]
  buffer_load_dwordx4 v[108:111], v1, s[8:11], s41 offen offset:1024 sc1
  v_mfma_f32_16x16x32_bf16 v[40:43], v[148:151], v[124:127], v[40:43]
  buffer_load_dwordx4 v[112:115], v1, s[8:11], s41 offen offset:2048 sc1
  v_mfma_f32_16x16x32_bf16 v[44:47], v[148:151], v[128:131], v[44:47]
  buffer_load_dwordx4 v[116:119], v1, s[8:11], s41 offen offset:3072 sc1
  v_mfma_f32_16x16x32_bf16 v[48:51], v[148:151], v[132:135], v[48:51]
  s_add_u32 s41, s41, 4096
  v_mfma_f32_16x16x32_bf16 v[52:55], v[148:151], v[136:139], v[52:55]
  buffer_load_dwordx4 v[120:123], v1, s[8:11], s41 offen sc1
  v_mfma_f32_16x16x32_bf16 v[56:59], v[152:155], v[124:127], v[56:59]
  s_add_u32 s41, s41, 1024
  v_mfma_f32_16x16x32_bf16 v[60:63], v[152:155], v[128:131], v[60:63]
  v_mfma_f32_16x16x32_bf16 v[64:67], v[152:155], v[132:135], v[64:67]
  v_mfma_f32_16x16x32_bf16 v[68:71], v[152:155], v[136:139], v[68:71]
  v_mfma_f32_16x16x32_bf16 v[72:75], v[156:159], v[124:127], v[72:75]
  v_mfma_f32_16x16x32_bf16 v[76:79], v[156:159], v[128:131], v[76:79]
  v_mfma_f32_16x16x32_bf16 v[80:83], v[156:159], v[132:135], v[80:83]
  v_mfma_f32_16x16x32_bf16 v[84:87], v[156:159], v[136:139], v[84:87]
  s_waitcnt vmcnt(18)
  v_mfma_f32_16x16x32_bf16 v[8:11], v[176:179], v[160:163], v[8:11]
  v_mfma_f32_16x16x32_bf16 v[12:15], v[176:179], v[164:167], v[12:15]
  buffer_load_dwordx4 v[124:127], v232, s[72:75], s40 offen sc1
  v_mfma_f32_16x16x32_bf16 v[16:19], v[176:179], v[168:171], v[16:19]
  buffer_load_dwordx4 v[128:131], v233, s[72:75], s40 offen sc1
  v_mfma_f32_16x16x32_bf16 v[20:23], v[176:179], v[172:175], v[20:23]
  buffer_load_dwordx4 v[132:135], v234, s[72:75], s40 offen sc1
  v_mfma_f32_16x16x32_bf16 v[24:27], v[180:183], v[160:163], v[24:27]
  buffer_load_dwordx4 v[136:139], v235, s[72:75], s40 offen sc1
  v_mfma_f32_16x16x32_bf16 v[28:31], v[180:183], v[164:167], v[28:31]
  s_add_u32 s40, s40, 131072
  v_mfma_f32_16x16x32_bf16 v[32:35], v[180:183], v[168:171], v[32:35]
  buffer_load_dwordx4 v[140:143], v1, s[8:11], s41 offen offset:0 sc1
  v_mfma_f32_16x16x32_bf16 v[36:39], v[180:183], v[172:175], v[36:39]
  buffer_load_dwordx4 v[144:147], v1, s[8:11], s41 offen offset:1024 sc1
  v_mfma_f32_16x16x32_bf16 v[40:43], v[184:187], v[160:163], v[40:43]
  buffer_load_dwordx4 v[148:151], v1, s[8:11], s41 offen offset:2048 sc1
  v_mfma_f32_16x16x32_bf16 v[44:47], v[184:187], v[164:167], v[44:47]
  buffer_load_dwordx4 v[152:155], v1, s[8:11], s41 offen offset:3072 sc1
  v_mfma_f32_16x16x32_bf16 v[48:51], v[184:187], v[168:171], v[48:51]
  s_add_u32 s41, s41, 4096
  v_mfma_f32_16x16x32_bf16 v[52:55], v[184:187], v[172:175], v[52:55]
  buffer_load_dwordx4 v[156:159], v1, s[8:11], s41 offen sc1
  v_mfma_f32_16x16x32_bf16 v[56:59], v[188:191], v[160:163], v[56:59]
  s_add_u32 s41, s41, 1024
  v_mfma_f32_16x16x32_bf16 v[60:63], v[188:191], v[164:167], v[60:63]
  v_mfma_f32_16x16x32_bf16 v[64:67], v[188:191], v[168:171], v[64:67]
  v_mfma_f32_16x16x32_bf16 v[68:71], v[188:191], v[172:175], v[68:71]
  v_mfma_f32_16x16x32_bf16 v[72:75], v[192:195], v[160:163], v[72:75]
  v_mfma_f32_16x16x32_bf16 v[76:79], v[192:195], v[164:167], v[76:79]
  v_mfma_f32_16x16x32_bf16 v[80:83], v[192:195], v[168:171], v[80:83]
  v_mfma_f32_16x16x32_bf16 v[84:87], v[192:195], v[172:175], v[84:87]
  s_waitcnt vmcnt(18)
  v_mfma_f32_16x16x32_bf16 v[8:11], v[212:215], v[196:199], v[8:11]
  v_mfma_f32_16x16x32_bf16 v[12:15], v[212:215], v[200:203], v[12:15]
  buffer_load_dwordx4 v[160:163], v232, s[72:75], s40 offen sc1
  v_mfma_f32_16x16x32_bf16 v[16:19], v[212:215], v[204:207], v[16:19]
  buffer_load_dwordx4 v[164:167], v233, s[72:75], s40 offen sc1
  v_mfma_f32_16x16x32_bf16 v[20:23], v[212:215], v[208:211], v[20:23]
  buffer_load_dwordx4 v[168:171], v234, s[72:75], s40 offen sc1
  v_mfma_f32_16x16x32_bf16 v[24:27], v[216:219], v[196:199], v[24:27]
  buffer_load_dwordx4 v[172:175], v235, s[72:75], s40 offen sc1
  v_mfma_f32_16x16x32_bf16 v[28:31], v[216:219], v[200:203], v[28:31]
  s_add_u32 s40, s40, 131072
  v_mfma_f32_16x16x32_bf16 v[32:35], v[216:219], v[204:207], v[32:35]
  buffer_load_dwordx4 v[176:179], v1, s[8:11], s41 offen offset:0 sc1
  v_mfma_f32_16x16x32_bf16 v[36:39], v[216:219], v[208:211], v[36:39]
  buffer_load_dwordx4 v[180:183], v1, s[8:11], s41 offen offset:1024 sc1
  v_mfma_f32_16x16x32_bf16 v[40:43], v[220:223], v[196:199], v[40:43]
  buffer_load_dwordx4 v[184:187], v1, s[8:11], s41 offen offset:2048 sc1
  v_mfma_f32_16x16x32_bf16 v[44:47], v[220:223], v[200:203], v[44:47]
  buffer_load_dwordx4 v[188:191], v1, s[8:11], s41 offen offset:3072 sc1
  v_mfma_f32_16x16x32_bf16 v[48:51], v[220:223], v[204:207], v[48:51]
  s_add_u32 s41, s41, 4096
  v_mfma_f32_16x16x32_bf16 v[52:55], v[220:223], v[208:211], v[52:55]
  buffer_load_dwordx4 v[192:195], v1, s[8:11], s41 offen sc1
  v_mfma_f32_16x16x32_bf16 v[56:59], v[224:227], v[196:199], v[56:59]
  s_add_u32 s41, s41, 1024
  v_mfma_f32_16x16x32_bf16 v[60:63], v[224:227], v[200:203], v[60:63]
  v_mfma_f32_16x16x32_bf16 v[64:67], v[224:227], v[204:207], v[64:67]
  v_mfma_f32_16x16x32_bf16 v[68:71], v[224:227], v[208:211], v[68:71]
  v_mfma_f32_16x16x32_bf16 v[72:75], v[228:231], v[196:199], v[72:75]
  v_mfma_f32_16x16x32_bf16 v[76:79], v[228:231], v[200:203], v[76:79]
  v_mfma_f32_16x16x32_bf16 v[80:83], v[228:231], v[204:207], v[80:83]
  v_mfma_f32_16x16x32_bf16 v[84:87], v[228:231], v[208:211], v[84:87]
  s_waitcnt vmcnt(18)
  v_mfma_f32_16x16x32_bf16 v[8:11], v[104:107], v[88:91], v[8:11]
  v_mfma_f32_16x16x32_bf16 v[12:15], v[104:107], v[92:95], v[12:15]
  buffer_load_dwordx4 v[196:199], v232, s[72:75], s40 offen sc1
  v_mfma_f32_16x16x32_bf16 v[16:19], v[104:107], v[96:99], v[16:19]
  buffer_load_dwordx4 v[200:203], v233, s[72:75], s40 offen sc1
  v_mfma_f32_16x16x32_bf16 v[20:23], v[104:107], v[100:103], v[20:23]
  buffer_load_dwordx4 v[204:207], v234, s[72:75], s40 offen sc1
  v_mfma_f32_16x16x32_bf16 v[24:27], v[108:111], v[88:91], v[24:27]
  buffer_load_dwordx4 v[208:211], v235, s[72:75], s40 offen sc1
  v_mfma_f32_16x16x32_bf16 v[28:31], v[108:111], v[92:95], v[28:31]
  s_add_u32 s40, s40, 131072
  v_mfma_f32_16x16x32_bf16 v[32:35], v[108:111], v[96:99], v[32:35]
  buffer_load_dwordx4 v[212:215], v1, s[8:11], s41 offen offset:0 sc1
  v_mfma_f32_16x16x32_bf16 v[36:39], v[108:111], v[100:103], v[36:39]
  buffer_load_dwordx4 v[216:219], v1, s[8:11], s41 offen offset:1024 sc1
  v_mfma_f32_16x16x32_bf16 v[40:43], v[112:115], v[88:91], v[40:43]
  buffer_load_dwordx4 v[220:223], v1, s[8:11], s41 offen offset:2048 sc1
  v_mfma_f32_16x16x32_bf16 v[44:47], v[112:115], v[92:95], v[44:47]
  buffer_load_dwordx4 v[224:227], v1, s[8:11], s41 offen offset:3072 sc1
  v_mfma_f32_16x16x32_bf16 v[48:51], v[112:115], v[96:99], v[48:51]
  s_add_u32 s41, s41, 4096
  v_mfma_f32_16x16x32_bf16 v[52:55], v[112:115], v[100:103], v[52:55]
  buffer_load_dwordx4 v[228:231], v1, s[8:11], s41 offen sc1
  v_mfma_f32_16x16x32_bf16 v[56:59], v[116:119], v[88:91], v[56:59]
  s_add_u32 s41, s41, 1024
  v_mfma_f32_16x16x32_bf16 v[60:63], v[116:119], v[92:95], v[60:63]
  v_mfma_f32_16x16x32_bf16 v[64:67], v[116:119], v[96:99], v[64:67]
  v_mfma_f32_16x16x32_bf16 v[68:71], v[116:119], v[100:103], v[68:71]
  v_mfma_f32_16x16x32_bf16 v[72:75], v[120:123], v[88:91], v[72:75]
  v_mfma_f32_16x16x32_bf16 v[76:79], v[120:123], v[92:95], v[76:79]
  v_mfma_f32_16x16x32_bf16 v[80:83], v[120:123], v[96:99], v[80:83]
  v_mfma_f32_16x16x32_bf16 v[84:87], v[120:123], v[100:103], v[84:87]
  s_waitcnt vmcnt(18)
  v_mfma_f32_16x16x32_bf16 v[8:11], v[140:143], v[124:127], v[8:11]
  v_mfma_f32_16x16x32_bf16 v[12:15], v[140:143], v[128:131], v[12:15]
  buffer_load_dwordx4 v[88:91], v232, s[72:75], s40 offen sc1
  v_mfma_f32_16x16x32_bf16 v[16:19], v[140:143], v[132:135], v[16:19]
  buffer_load_dwordx4 v[92:95], v233, s[72:75], s40 offen sc1
  v_mfma_f32_16x16x32_bf16 v[20:23], v[140:143], v[136:139], v[20:23]
  buffer_load_dwordx4 v[96:99], v234, s[72:75], s40 offen sc1
  v_mfma_f32_16x16x32_bf16 v[24:27], v[144:147], v[124:127], v[24:27]
  buffer_load_dwordx4 v[100:103], v235, s[72:75], s40 offen sc1
  v_mfma_f32_16x16x32_bf16 v[28:31], v[144:147], v[128:131], v[28:31]
  s_add_u32 s40, s40, 131072
  v_mfma_f32_16x16x32_bf16 v[32:35], v[144:147], v[132:135], v[32:35]
  buffer_load_dwordx4 v[104:107], v1, s[8:11], s41 offen offset:0 sc1
  v_mfma_f32_16x16x32_bf16 v[36:39], v[144:147], v[136:139], v[36:39]
  buffer_load_dwordx4 v[108:111], v1, s[8:11], s41 offen offset:1024 sc1
  v_mfma_f32_16x16x32_bf16 v[40:43], v[148:151], v[124:127], v[40:43]
  buffer_load_dwordx4 v[112:115], v1, s[8:11], s41 offen offset:2048 sc1
  v_mfma_f32_16x16x32_bf16 v[44:47], v[148:151], v[128:131], v[44:47]
  buffer_load_dwordx4 v[116:119], v1, s[8:11], s41 offen offset:3072 sc1
  v_mfma_f32_16x16x32_bf16 v[48:51], v[148:151], v[132:135], v[48:51]
  s_add_u32 s41, s41, 4096
  v_mfma_f32_16x16x32_bf16 v[52:55], v[148:151], v[136:139], v[52:55]
  buffer_load_dwordx4 v[120:123], v1, s[8:11], s41 offen sc1
  v_mfma_f32_16x16x32_bf16 v[56:59], v[152:155], v[124:127], v[56:59]
  s_add_u32 s41, s41, 1024
  v_mfma_f32_16x16x32_bf16 v[60:63], v[152:155], v[128:131], v[60:63]
  v_mfma_f32_16x16x32_bf16 v[64:67], v[152:155], v[132:135], v[64:67]
  v_mfma_f32_16x16x32_bf16 v[68:71], v[152:155], v[136:139], v[68:71]
  v_mfma_f32_16x16x32_bf16 v[72:75], v[156:159], v[124:127], v[72:75]
  v_mfma_f32_16x16x32_bf16 v[76:79], v[156:159], v[128:131], v[76:79]
  v_mfma_f32_16x16x32_bf16 v[80:83], v[156:159], v[132:135], v[80:83]
  v_mfma_f32_16x16x32_bf16 v[84:87], v[156:159], v[136:139], v[84:87]
  s_waitcnt vmcnt(18)
  v_mfma_f32_16x16x32_bf16 v[8:11], v[176:179], v[160:163], v[8:11]
  v_mfma_f32_16x16x32_bf16 v[12:15], v[176:179], v[164:167], v[12:15]
  buffer_load_dwordx4 v[124:127], v232, s[72:75], s40 offen sc1
  v_mfma_f32_16x16x32_bf16 v[16:19], v[176:179], v[168:171], v[16:19]
  buffer_load_dwordx4 v[128:131], v233, s[72:75], s40 offen sc1
  v_mfma_f32_16x16x32_bf16 v[20:23], v[176:179], v[172:175], v[20:23]
  buffer_load_dwordx4 v[132:135], v234, s[72:75], s40 offen sc1
  v_mfma_f32_16x16x32_bf16 v[24:27], v[180:183], v[160:163], v[24:27]
  buffer_load_dwordx4 v[136:139], v235, s[72:75], s40 offen sc1
  v_mfma_f32_16x16x32_bf16 v[28:31], v[180:183], v[164:167], v[28:31]
  s_add_u32 s40, s40, 131072
  v_mfma_f32_16x16x32_bf16 v[32:35], v[180:183], v[168:171], v[32:35]
  buffer_load_dwordx4 v[140:143], v1, s[8:11], s41 offen offset:0 sc1
  v_mfma_f32_16x16x32_bf16 v[36:39], v[180:183], v[172:175], v[36:39]
  buffer_load_dwordx4 v[144:147], v1, s[8:11], s41 offen offset:1024 sc1
  v_mfma_f32_16x16x32_bf16 v[40:43], v[184:187], v[160:163], v[40:43]
  buffer_load_dwordx4 v[148:151], v1, s[8:11], s41 offen offset:2048 sc1
  v_mfma_f32_16x16x32_bf16 v[44:47], v[184:187], v[164:167], v[44:47]
  buffer_load_dwordx4 v[152:155], v1, s[8:11], s41 offen offset:3072 sc1
  v_mfma_f32_16x16x32_bf16 v[48:51], v[184:187], v[168:171], v[48:51]
  s_add_u32 s41, s41, 4096
  v_mfma_f32_16x16x32_bf16 v[52:55], v[184:187], v[172:175], v[52:55]
  buffer_load_dwordx4 v[156:159], v1, s[8:11], s41 offen sc1
  v_mfma_f32_16x16x32_bf16 v[56:59], v[188:191], v[160:163], v[56:59]
  s_add_u32 s41, s41, 1024
  v_mfma_f32_16x16x32_bf16 v[60:63], v[188:191], v[164:167], v[60:63]
  v_mfma_f32_16x16x32_bf16 v[64:67], v[188:191], v[168:171], v[64:67]
  v_mfma_f32_16x16x32_bf16 v[68:71], v[188:191], v[172:175], v[68:71]
  v_mfma_f32_16x16x32_bf16 v[72:75], v[192:195], v[160:163], v[72:75]
  v_mfma_f32_16x16x32_bf16 v[76:79], v[192:195], v[164:167], v[76:79]
  v_mfma_f32_16x16x32_bf16 v[80:83], v[192:195], v[168:171], v[80:83]
  v_mfma_f32_16x16x32_bf16 v[84:87], v[192:195], v[172:175], v[84:87]
  s_waitcnt vmcnt(18)
  v_mfma_f32_16x16x32_bf16 v[8:11], v[212:215], v[196:199], v[8:11]
  v_mfma_f32_16x16x32_bf16 v[12:15], v[212:215], v[200:203], v[12:15]
  buffer_load_dwordx4 v[160:163], v232, s[72:75], s40 offen sc1
  v_mfma_f32_16x16x32_bf16 v[16:19], v[212:215], v[204:207], v[16:19]
  buffer_load_dwordx4 v[164:167], v233, s[72:75], s40 offen sc1
  v_mfma_f32_16x16x32_bf16 v[20:23], v[212:215], v[208:211], v[20:23]
  buffer_load_dwordx4 v[168:171], v234, s[72:75], s40 offen sc1
  v_mfma_f32_16x16x32_bf16 v[24:27], v[216:219], v[196:199], v[24:27]
  buffer_load_dwordx4 v[172:175], v235, s[72:75], s40 offen sc1
  v_mfma_f32_16x16x32_bf16 v[28:31], v[216:219], v[200:203], v[28:31]
  s_add_u32 s40, s40, 131072
  v_mfma_f32_16x16x32_bf16 v[32:35], v[216:219], v[204:207], v[32:35]
  buffer_load_dwordx4 v[176:179], v1, s[8:11], s41 offen offset:0 sc1
  v_mfma_f32_16x16x32_bf16 v[36:39], v[216:219], v[208:211], v[36:39]
  buffer_load_dwordx4 v[180:183], v1, s[8:11], s41 offen offset:1024 sc1
  v_mfma_f32_16x16x32_bf16 v[40:43], v[220:223], v[196:199], v[40:43]
  buffer_load_dwordx4 v[184:187], v1, s[8:11], s41 offen offset:2048 sc1
  v_mfma_f32_16x16x32_bf16 v[44:47], v[220:223], v[200:203], v[44:47]
  buffer_load_dwordx4 v[188:191], v1, s[8:11], s41 offen offset:3072 sc1
  v_mfma_f32_16x16x32_bf16 v[48:51], v[220:223], v[204:207], v[48:51]
  s_add_u32 s41, s41, 4096
  v_mfma_f32_16x16x32_bf16 v[52:55], v[220:223], v[208:211], v[52:55]
  buffer_load_dwordx4 v[192:195], v1, s[8:11], s41 offen sc1
  v_mfma_f32_16x16x32_bf16 v[56:59], v[224:227], v[196:199], v[56:59]
  s_add_u32 s41, s41, 1024
  v_mfma_f32_16x16x32_bf16 v[60:63], v[224:227], v[200:203], v[60:63]
  v_mfma_f32_16x16x32_bf16 v[64:67], v[224:227], v[204:207], v[64:67]
  v_mfma_f32_16x16x32_bf16 v[68:71], v[224:227], v[208:211], v[68:71]
  v_mfma_f32_16x16x32_bf16 v[72:75], v[228:231], v[196:199], v[72:75]
  v_mfma_f32_16x16x32_bf16 v[76:79], v[228:231], v[200:203], v[76:79]
  v_mfma_f32_16x16x32_bf16 v[80:83], v[228:231], v[204:207], v[80:83]
  v_mfma_f32_16x16x32_bf16 v[84:87], v[228:231], v[208:211], v[84:87]
  s_waitcnt vmcnt(18)
  v_mfma_f32_16x16x32_bf16 v[8:11], v[104:107], v[88:91], v[8:11]
  v_mfma_f32_16x16x32_bf16 v[12:15], v[104:107], v[92:95], v[12:15]
  buffer_load_dwordx4 v[196:199], v232, s[72:75], s40 offen sc1
  v_mfma_f32_16x16x32_bf16 v[16:19], v[104:107], v[96:99], v[16:19]
  buffer_load_dwordx4 v[200:203], v233, s[72:75], s40 offen sc1
  v_mfma_f32_16x16x32_bf16 v[20:23], v[104:107], v[100:103], v[20:23]
  buffer_load_dwordx4 v[204:207], v234, s[72:75], s40 offen sc1
  v_mfma_f32_16x16x32_bf16 v[24:27], v[108:111], v[88:91], v[24:27]
  buffer_load_dwordx4 v[208:211], v235, s[72:75], s40 offen sc1
  v_mfma_f32_16x16x32_bf16 v[28:31], v[108:111], v[92:95], v[28:31]
  s_add_u32 s40, s40, 131072
  v_mfma_f32_16x16x32_bf16 v[32:35], v[108:111], v[96:99], v[32:35]
  buffer_load_dwordx4 v[212:215], v1, s[8:11], s41 offen offset:0 sc1
  v_mfma_f32_16x16x32_bf16 v[36:39], v[108:111], v[100:103], v[36:39]
  buffer_load_dwordx4 v[216:219], v1, s[8:11], s41 offen offset:1024 sc1
  v_mfma_f32_16x16x32_bf16 v[40:43], v[112:115], v[88:91], v[40:43]
  buffer_load_dwordx4 v[220:223], v1, s[8:11], s41 offen offset:2048 sc1
  v_mfma_f32_16x16x32_bf16 v[44:47], v[112:115], v[92:95], v[44:47]
  buffer_load_dwordx4 v[224:227], v1, s[8:11], s41 offen offset:3072 sc1
  v_mfma_f32_16x16x32_bf16 v[48:51], v[112:115], v[96:99], v[48:51]
  s_add_u32 s41, s41, 4096
  v_mfma_f32_16x16x32_bf16 v[52:55], v[112:115], v[100:103], v[52:55]
  buffer_load_dwordx4 v[228:231], v1, s[8:11], s41 offen sc1
  v_mfma_f32_16x16x32_bf16 v[56:59], v[116:119], v[88:91], v[56:59]
  s_add_u32 s41, s41, 1024
  v_mfma_f32_16x16x32_bf16 v[60:63], v[116:119], v[92:95], v[60:63]
  v_mfma_f32_16x16x32_bf16 v[64:67], v[116:119], v[96:99], v[64:67]
  v_mfma_f32_16x16x32_bf16 v[68:71], v[116:119], v[100:103], v[68:71]
  v_mfma_f32_16x16x32_bf16 v[72:75], v[120:123], v[88:91], v[72:75]
  v_mfma_f32_16x16x32_bf16 v[76:79], v[120:123], v[92:95], v[76:79]
  v_mfma_f32_16x16x32_bf16 v[80:83], v[120:123], v[96:99], v[80:83]
  v_mfma_f32_16x16x32_bf16 v[84:87], v[120:123], v[100:103], v[84:87]
  s_waitcnt vmcnt(18)
  v_mfma_f32_16x16x32_bf16 v[8:11], v[140:143], v[124:127], v[8:11]
  v_mfma_f32_16x16x32_bf16 v[12:15], v[140:143], v[128:131], v[12:15]
  buffer_load_dwordx4 v[88:91], v232, s[72:75], s40 offen sc1
  v_mfma_f32_16x16x32_bf16 v[16:19], v[140:143], v[132:135], v[16:19]
  buffer_load_dwordx4 v[92:95], v233, s[72:75], s40 offen sc1
  v_mfma_f32_16x16x32_bf16 v[20:23], v[140:143], v[136:139], v[20:23]
  buffer_load_dwordx4 v[96:99], v234, s[72:75], s40 offen sc1
  v_mfma_f32_16x16x32_bf16 v[24:27], v[144:147], v[124:127], v[24:27]
  buffer_load_dwordx4 v[100:103], v235, s[72:75], s40 offen sc1
  v_mfma_f32_16x16x32_bf16 v[28:31], v[144:147], v[128:131], v[28:31]
  s_add_u32 s40, s40, 131072
  v_mfma_f32_16x16x32_bf16 v[32:35], v[144:147], v[132:135], v[32:35]
  buffer_load_dwordx4 v[104:107], v1, s[8:11], s41 offen offset:0 sc1
  v_mfma_f32_16x16x32_bf16 v[36:39], v[144:147], v[136:139], v[36:39]
  buffer_load_dwordx4 v[108:111], v1, s[8:11], s41 offen offset:1024 sc1
  v_mfma_f32_16x16x32_bf16 v[40:43], v[148:151], v[124:127], v[40:43]
  buffer_load_dwordx4 v[112:115], v1, s[8:11], s41 offen offset:2048 sc1
  v_mfma_f32_16x16x32_bf16 v[44:47], v[148:151], v[128:131], v[44:47]
  buffer_load_dwordx4 v[116:119], v1, s[8:11], s41 offen offset:3072 sc1
  v_mfma_f32_16x16x32_bf16 v[48:51], v[148:151], v[132:135], v[48:51]
  s_add_u32 s41, s41, 4096
  v_mfma_f32_16x16x32_bf16 v[52:55], v[148:151], v[136:139], v[52:55]
  buffer_load_dwordx4 v[120:123], v1, s[8:11], s41 offen sc1
  v_mfma_f32_16x16x32_bf16 v[56:59], v[152:155], v[124:127], v[56:59]
  s_add_u32 s41, s41, 1024
  v_mfma_f32_16x16x32_bf16 v[60:63], v[152:155], v[128:131], v[60:63]
  v_mfma_f32_16x16x32_bf16 v[64:67], v[152:155], v[132:135], v[64:67]
  v_mfma_f32_16x16x32_bf16 v[68:71], v[152:155], v[136:139], v[68:71]
  v_mfma_f32_16x16x32_bf16 v[72:75], v[156:159], v[124:127], v[72:75]
  v_mfma_f32_16x16x32_bf16 v[76:79], v[156:159], v[128:131], v[76:79]
  v_mfma_f32_16x16x32_bf16 v[80:83], v[156:159], v[132:135], v[80:83]
  v_mfma_f32_16x16x32_bf16 v[84:87], v[156:159], v[136:139], v[84:87]
  s_waitcnt vmcnt(18)
  v_mfma_f32_16x16x32_bf16 v[8:11], v[176:179], v[160:163], v[8:11]
  v_mfma_f32_16x16x32_bf16 v[12:15], v[176:179], v[164:167], v[12:15]
  buffer_load_dwordx4 v[124:127], v232, s[72:75], s40 offen sc1
  v_mfma_f32_16x16x32_bf16 v[16:19], v[176:179], v[168:171], v[16:19]
  buffer_load_dwordx4 v[128:131], v233, s[72:75], s40 offen sc1
  v_mfma_f32_16x16x32_bf16 v[20:23], v[176:179], v[172:175], v[20:23]
  buffer_load_dwordx4 v[132:135], v234, s[72:75], s40 offen sc1
  v_mfma_f32_16x16x32_bf16 v[24:27], v[180:183], v[160:163], v[24:27]
  buffer_load_dwordx4 v[136:139], v235, s[72:75], s40 offen sc1
  v_mfma_f32_16x16x32_bf16 v[28:31], v[180:183], v[164:167], v[28:31]
  s_add_u32 s40, s40, 131072
  v_mfma_f32_16x16x32_bf16 v[32:35], v[180:183], v[168:171], v[32:35]
  buffer_load_dwordx4 v[140:143], v1, s[8:11], s41 offen offset:0 sc1
  v_mfma_f32_16x16x32_bf16 v[36:39], v[180:183], v[172:175], v[36:39]
  buffer_load_dwordx4 v[144:147], v1, s[8:11], s41 offen offset:1024 sc1
  v_mfma_f32_16x16x32_bf16 v[40:43], v[184:187], v[160:163], v[40:43]
  buffer_load_dwordx4 v[148:151], v1, s[8:11], s41 offen offset:2048 sc1
  v_mfma_f32_16x16x32_bf16 v[44:47], v[184:187], v[164:167], v[44:47]
  buffer_load_dwordx4 v[152:155], v1, s[8:11], s41 offen offset:3072 sc1
  v_mfma_f32_16x16x32_bf16 v[48:51], v[184:187], v[168:171], v[48:51]
  s_add_u32 s41, s41, 4096
  v_mfma_f32_16x16x32_bf16 v[52:55], v[184:187], v[172:175], v[52:55]
  buffer_load_dwordx4 v[156:159], v1, s[8:11], s41 offen sc1
  v_mfma_f32_16x16x32_bf16 v[56:59], v[188:191], v[160:163], v[56:59]
  s_add_u32 s41, s41, 1024
  v_mfma_f32_16x16x32_bf16 v[60:63], v[188:191], v[164:167], v[60:63]
  v_mfma_f32_16x16x32_bf16 v[64:67], v[188:191], v[168:171], v[64:67]
  v_mfma_f32_16x16x32_bf16 v[68:71], v[188:191], v[172:175], v[68:71]
  v_mfma_f32_16x16x32_bf16 v[72:75], v[192:195], v[160:163], v[72:75]
  v_mfma_f32_16x16x32_bf16 v[76:79], v[192:195], v[164:167], v[76:79]
  v_mfma_f32_16x16x32_bf16 v[80:83], v[192:195], v[168:171], v[80:83]
  v_mfma_f32_16x16x32_bf16 v[84:87], v[192:195], v[172:175], v[84:87]
  s_waitcnt vmcnt(18)
  v_mfma_f32_16x16x32_bf16 v[8:11], v[212:215], v[196:199], v[8:11]
  v_mfma_f32_16x16x32_bf16 v[12:15], v[212:215], v[200:203], v[12:15]
  buffer_load_dwordx4 v[160:163], v232, s[72:75], s40 offen sc1
  v_mfma_f32_16x16x32_bf16 v[16:19], v[212:215], v[204:207], v[16:19]
  buffer_load_dwordx4 v[164:167], v233, s[72:75], s40 offen sc1
  v_mfma_f32_16x16x32_bf16 v[20:23], v[212:215], v[208:211], v[20:23]
  buffer_load_dwordx4 v[168:171], v234, s[72:75], s40 offen sc1
  v_mfma_f32_16x16x32_bf16 v[24:27], v[216:219], v[196:199], v[24:27]
  buffer_load_dwordx4 v[172:175], v235, s[72:75], s40 offen sc1
  v_mfma_f32_16x16x32_bf16 v[28:31], v[216:219], v[200:203], v[28:31]
  s_add_u32 s40, s40, 131072
  v_mfma_f32_16x16x32_bf16 v[32:35], v[216:219], v[204:207], v[32:35]
  buffer_load_dwordx4 v[176:179], v1, s[8:11], s41 offen offset:0 sc1
  v_mfma_f32_16x16x32_bf16 v[36:39], v[216:219], v[208:211], v[36:39]
  buffer_load_dwordx4 v[180:183], v1, s[8:11], s41 offen offset:1024 sc1
  v_mfma_f32_16x16x32_bf16 v[40:43], v[220:223], v[196:199], v[40:43]
  buffer_load_dwordx4 v[184:187], v1, s[8:11], s41 offen offset:2048 sc1
  v_mfma_f32_16x16x32_bf16 v[44:47], v[220:223], v[200:203], v[44:47]
  buffer_load_dwordx4 v[188:191], v1, s[8:11], s41 offen offset:3072 sc1
  v_mfma_f32_16x16x32_bf16 v[48:51], v[220:223], v[204:207], v[48:51]
  s_add_u32 s41, s41, 4096
  v_mfma_f32_16x16x32_bf16 v[52:55], v[220:223], v[208:211], v[52:55]
  buffer_load_dwordx4 v[192:195], v1, s[8:11], s41 offen sc1
  v_mfma_f32_16x16x32_bf16 v[56:59], v[224:227], v[196:199], v[56:59]
  s_add_u32 s41, s41, 1024
  v_mfma_f32_16x16x32_bf16 v[60:63], v[224:227], v[200:203], v[60:63]
  v_mfma_f32_16x16x32_bf16 v[64:67], v[224:227], v[204:207], v[64:67]
  v_mfma_f32_16x16x32_bf16 v[68:71], v[224:227], v[208:211], v[68:71]
  v_mfma_f32_16x16x32_bf16 v[72:75], v[228:231], v[196:199], v[72:75]
  v_mfma_f32_16x16x32_bf16 v[76:79], v[228:231], v[200:203], v[76:79]
  v_mfma_f32_16x16x32_bf16 v[80:83], v[228:231], v[204:207], v[80:83]
  v_mfma_f32_16x16x32_bf16 v[84:87], v[228:231], v[208:211], v[84:87]
  s_waitcnt vmcnt(18)
  v_mfma_f32_16x16x32_bf16 v[8:11], v[104:107], v[88:91], v[8:11]
  v_mfma_f32_16x16x32_bf16 v[12:15], v[104:107], v[92:95], v[12:15]
  buffer_load_dwordx4 v[196:199], v232, s[72:75], s40 offen sc1
  v_mfma_f32_16x16x32_bf16 v[16:19], v[104:107], v[96:99], v[16:19]
  buffer_load_dwordx4 v[200:203], v233, s[72:75], s40 offen sc1
  v_mfma_f32_16x16x32_bf16 v[20:23], v[104:107], v[100:103], v[20:23]
  buffer_load_dwordx4 v[204:207], v234, s[72:75], s40 offen sc1
  v_mfma_f32_16x16x32_bf16 v[24:27], v[108:111], v[88:91], v[24:27]
  buffer_load_dwordx4 v[208:211], v235, s[72:75], s40 offen sc1
  v_mfma_f32_16x16x32_bf16 v[28:31], v[108:111], v[92:95], v[28:31]
  s_add_u32 s40, s40, 131072
  v_mfma_f32_16x16x32_bf16 v[32:35], v[108:111], v[96:99], v[32:35]
  buffer_load_dwordx4 v[212:215], v1, s[8:11], s41 offen offset:0 sc1
  v_mfma_f32_16x16x32_bf16 v[36:39], v[108:111], v[100:103], v[36:39]
  buffer_load_dwordx4 v[216:219], v1, s[8:11], s41 offen offset:1024 sc1
  v_mfma_f32_16x16x32_bf16 v[40:43], v[112:115], v[88:91], v[40:43]
  buffer_load_dwordx4 v[220:223], v1, s[8:11], s41 offen offset:2048 sc1
  v_mfma_f32_16x16x32_bf16 v[44:47], v[112:115], v[92:95], v[44:47]
  buffer_load_dwordx4 v[224:227], v1, s[8:11], s41 offen offset:3072 sc1
  v_mfma_f32_16x16x32_bf16 v[48:51], v[112:115], v[96:99], v[48:51]
  s_add_u32 s41, s41, 4096
  v_mfma_f32_16x16x32_bf16 v[52:55], v[112:115], v[100:103], v[52:55]
  buffer_load_dwordx4 v[228:231], v1, s[8:11], s41 offen sc1
  v_mfma_f32_16x16x32_bf16 v[56:59], v[116:119], v[88:91], v[56:59]
  s_add_u32 s41, s41, 1024
  v_mfma_f32_16x16x32_bf16 v[60:63], v[116:119], v[92:95], v[60:63]
  v_mfma_f32_16x16x32_bf16 v[64:67], v[116:119], v[96:99], v[64:67]
  v_mfma_f32_16x16x32_bf16 v[68:71], v[116:119], v[100:103], v[68:71]
  v_mfma_f32_16x16x32_bf16 v[72:75], v[120:123], v[88:91], v[72:75]
  v_mfma_f32_16x16x32_bf16 v[76:79], v[120:123], v[92:95], v[76:79]
  v_mfma_f32_16x16x32_bf16 v[80:83], v[120:123], v[96:99], v[80:83]
  v_mfma_f32_16x16x32_bf16 v[84:87], v[120:123], v[100:103], v[84:87]
  s_waitcnt vmcnt(18)
  v_mfma_f32_16x16x32_bf16 v[8:11], v[140:143], v[124:127], v[8:11]
  v_mfma_f32_16x16x32_bf16 v[12:15], v[140:143], v[128:131], v[12:15]
  buffer_load_dwordx4 v[88:91], v232, s[72:75], s40 offen sc1
  v_mfma_f32_16x16x32_bf16 v[16:19], v[140:143], v[132:135], v[16:19]
  buffer_load_dwordx4 v[92:95], v233, s[72:75], s40 offen sc1
  v_mfma_f32_16x16x32_bf16 v[20:23], v[140:143], v[136:139], v[20:23]
  buffer_load_dwordx4 v[96:99], v234, s[72:75], s40 offen sc1
  v_mfma_f32_16x16x32_bf16 v[24:27], v[144:147], v[124:127], v[24:27]
  buffer_load_dwordx4 v[100:103], v235, s[72:75], s40 offen sc1
  v_mfma_f32_16x16x32_bf16 v[28:31], v[144:147], v[128:131], v[28:31]
  s_add_u32 s40, s40, 131072
  v_mfma_f32_16x16x32_bf16 v[32:35], v[144:147], v[132:135], v[32:35]
  buffer_load_dwordx4 v[104:107], v1, s[8:11], s41 offen offset:0 sc1
  v_mfma_f32_16x16x32_bf16 v[36:39], v[144:147], v[136:139], v[36:39]
  buffer_load_dwordx4 v[108:111], v1, s[8:11], s41 offen offset:1024 sc1
  v_mfma_f32_16x16x32_bf16 v[40:43], v[148:151], v[124:127], v[40:43]
  buffer_load_dwordx4 v[112:115], v1, s[8:11], s41 offen offset:2048 sc1
  v_mfma_f32_16x16x32_bf16 v[44:47], v[148:151], v[128:131], v[44:47]
  buffer_load_dwordx4 v[116:119], v1, s[8:11], s41 offen offset:3072 sc1
  v_mfma_f32_16x16x32_bf16 v[48:51], v[148:151], v[132:135], v[48:51]
  s_add_u32 s41, s41, 4096
  v_mfma_f32_16x16x32_bf16 v[52:55], v[148:151], v[136:139], v[52:55]
  buffer_load_dwordx4 v[120:123], v1, s[8:11], s41 offen sc1
  v_mfma_f32_16x16x32_bf16 v[56:59], v[152:155], v[124:127], v[56:59]
  s_add_u32 s41, s41, 1024
  v_mfma_f32_16x16x32_bf16 v[60:63], v[152:155], v[128:131], v[60:63]
  v_mfma_f32_16x16x32_bf16 v[64:67], v[152:155], v[132:135], v[64:67]
  v_mfma_f32_16x16x32_bf16 v[68:71], v[152:155], v[136:139], v[68:71]
  v_mfma_f32_16x16x32_bf16 v[72:75], v[156:159], v[124:127], v[72:75]
  v_mfma_f32_16x16x32_bf16 v[76:79], v[156:159], v[128:131], v[76:79]
  v_mfma_f32_16x16x32_bf16 v[80:83], v[156:159], v[132:135], v[80:83]
  v_mfma_f32_16x16x32_bf16 v[84:87], v[156:159], v[136:139], v[84:87]
  s_waitcnt vmcnt(18)
  v_mov_b32 v5, s71
  buffer_load_dword v247, v5, s[24:27], 0 offen sc0 sc1
  v_mfma_f32_16x16x32_bf16 v[8:11], v[176:179], v[160:163], v[8:11]
  v_mfma_f32_16x16x32_bf16 v[12:15], v[176:179], v[164:167], v[12:15]
  buffer_load_dwordx4 v[124:127], v232, s[72:75], s40 offen sc1
  v_mfma_f32_16x16x32_bf16 v[16:19], v[176:179], v[168:171], v[16:19]
  buffer_load_dwordx4 v[128:131], v233, s[72:75], s40 offen sc1
  v_mfma_f32_16x16x32_bf16 v[20:23], v[176:179], v[172:175], v[20:23]
  buffer_load_dwordx4 v[132:135], v234, s[72:75], s40 offen sc1
  v_mfma_f32_16x16x32_bf16 v[24:27], v[180:183], v[160:163], v[24:27]
  buffer_load_dwordx4 v[136:139], v235, s[72:75], s40 offen sc1
  v_mfma_f32_16x16x32_bf16 v[28:31], v[180:183], v[164:167], v[28:31]
  s_add_u32 s40, s40, 131072
  v_mfma_f32_16x16x32_bf16 v[32:35], v[180:183], v[168:171], v[32:35]
  buffer_load_dwordx4 v[140:143], v1, s[8:11], s41 offen offset:0 sc1
  v_mfma_f32_16x16x32_bf16 v[36:39], v[180:183], v[172:175], v[36:39]
  buffer_load_dwordx4 v[144:147], v1, s[8:11], s41 offen offset:1024 sc1
  v_mfma_f32_16x16x32_bf16 v[40:43], v[184:187], v[160:163], v[40:43]
  buffer_load_dwordx4 v[148:151], v1, s[8:11], s41 offen offset:2048 sc1
  v_mfma_f32_16x16x32_bf16 v[44:47], v[184:187], v[164:167], v[44:47]
  buffer_load_dwordx4 v[152:155], v1, s[8:11], s41 offen offset:3072 sc1
  v_mfma_f32_16x16x32_bf16 v[48:51], v[184:187], v[168:171], v[48:51]
  s_add_u32 s41, s41, 4096
  v_mfma_f32_16x16x32_bf16 v[52:55], v[184:187], v[172:175], v[52:55]
  buffer_load_dwordx4 v[156:159], v1, s[8:11], s41 offen sc1
  v_mfma_f32_16x16x32_bf16 v[56:59], v[188:191], v[160:163], v[56:59]
  s_add_u32 s41, s41, 1024
  v_mfma_f32_16x16x32_bf16 v[60:63], v[188:191], v[164:167], v[60:63]
  v_mfma_f32_16x16x32_bf16 v[64:67], v[188:191], v[168:171], v[64:67]
  v_mfma_f32_16x16x32_bf16 v[68:71], v[188:191], v[172:175], v[68:71]
  v_mfma_f32_16x16x32_bf16 v[72:75], v[192:195], v[160:163], v[72:75]
  v_mfma_f32_16x16x32_bf16 v[76:79], v[192:195], v[164:167], v[76:79]
  v_mfma_f32_16x16x32_bf16 v[80:83], v[192:195], v[168:171], v[80:83]
  v_mfma_f32_16x16x32_bf16 v[84:87], v[192:195], v[172:175], v[84:87]
  s_waitcnt vmcnt(19)
  v_mfma_f32_16x16x32_bf16 v[8:11], v[212:215], v[196:199], v[8:11]
  v_mfma_f32_16x16x32_bf16 v[12:15], v[212:215], v[200:203], v[12:15]
  v_mfma_f32_16x16x32_bf16 v[16:19], v[212:215], v[204:207], v[16:19]
  v_mfma_f32_16x16x32_bf16 v[20:23], v[212:215], v[208:211], v[20:23]
  v_mfma_f32_16x16x32_bf16 v[24:27], v[216:219], v[196:199], v[24:27]
  v_mfma_f32_16x16x32_bf16 v[28:31], v[216:219], v[200:203], v[28:31]
  v_mfma_f32_16x16x32_bf16 v[32:35], v[216:219], v[204:207], v[32:35]
  v_mfma_f32_16x16x32_bf16 v[36:39], v[216:219], v[208:211], v[36:39]
  v_mfma_f32_16x16x32_bf16 v[40:43], v[220:223], v[196:199], v[40:43]
  v_mfma_f32_16x16x32_bf16 v[44:47], v[220:223], v[200:203], v[44:47]
  v_mfma_f32_16x16x32_bf16 v[48:51], v[220:223], v[204:207], v[48:51]
  v_mfma_f32_16x16x32_bf16 v[52:55], v[220:223], v[208:211], v[52:55]
  v_mfma_f32_16x16x32_bf16 v[56:59], v[224:227], v[196:199], v[56:59]
  v_mfma_f32_16x16x32_bf16 v[60:63], v[224:227], v[200:203], v[60:63]
  v_mfma_f32_16x16x32_bf16 v[64:67], v[224:227], v[204:207], v[64:67]
  v_mfma_f32_16x16x32_bf16 v[68:71], v[224:227], v[208:211], v[68:71]
  v_mfma_f32_16x16x32_bf16 v[72:75], v[228:231], v[196:199], v[72:75]
  v_mfma_f32_16x16x32_bf16 v[76:79], v[228:231], v[200:203], v[76:79]
  v_mfma_f32_16x16x32_bf16 v[80:83], v[228:231], v[204:207], v[80:83]
  v_mfma_f32_16x16x32_bf16 v[84:87], v[228:231], v[208:211], v[84:87]
  s_waitcnt vmcnt(9)
  s_mov_b32 s38, 0x8000
sfl_13:
  v_readfirstlane_b32 s39, v247
  s_cmp_ge_u32 s39, 72
  s_cbranch_scc1 sflx_14
  s_sleep 1
  v_mov_b32 v5, s71
  buffer_load_dword v247, v5, s[24:27], 0 offen sc0 sc1
  s_waitcnt vmcnt(0)
  s_sub_u32 s38, s38, 1
  s_cmp_lg_u32 s38, 0
  s_cbranch_scc1 sfl_13
sflx_14:
  v_lshrrev_b32 v5, 3, v0
  v_lshlrev_b32 v5, 12, v5
  v_and_b32 v236, 7, v0
  v_lshl_add_u32 v5, v236, 4, v5
  s_mul_i32 s38, s69, 294912
  s_lshl_b32 s39, s68, 7
  s_add_u32 s38, s38, s39
  buffer_load_dwordx4 v[236:239], v5, s[12:15], s38 offen sc1
  s_add_u32 s38, s38, 131072
  buffer_load_dwordx4 v[240:243], v5, s[12:15], s38 offen sc1
  s_add_u32 s38, s38, 131072
  buffer_load_dwordx4 v[244:247], v5, s[12:15], s38 offen sc1
  s_add_u32 s38, s38, 131072
  v_mfma_f32_16x16x32_bf16 v[8:11], v[104:107], v[88:91], v[8:11]
  v_mfma_f32_16x16x32_bf16 v[12:15], v[104:107], v[92:95], v[12:15]
  v_mfma_f32_16x16x32_bf16 v[16:19], v[104:107], v[96:99], v[16:19]
  v_mfma_f32_16x16x32_bf16 v[20:23], v[104:107], v[100:103], v[20:23]
  v_mfma_f32_16x16x32_bf16 v[24:27], v[108:111], v[88:91], v[24:27]
  v_mfma_f32_16x16x32_bf16 v[28:31], v[108:111], v[92:95], v[28:31]
  v_mfma_f32_16x16x32_bf16 v[32:35], v[108:111], v[96:99], v[32:35]
  v_mfma_f32_16x16x32_bf16 v[36:39], v[108:111], v[100:103], v[36:39]
  v_mfma_f32_16x16x32_bf16 v[40:43], v[112:115], v[88:91], v[40:43]
  v_mfma_f32_16x16x32_bf16 v[44:47], v[112:115], v[92:95], v[44:47]
  v_mfma_f32_16x16x32_bf16 v[48:51], v[112:115], v[96:99], v[48:51]
  v_mfma_f32_16x16x32_bf16 v[52:55], v[112:115], v[100:103], v[52:55]
  v_mfma_f32_16x16x32_bf16 v[56:59], v[116:119], v[88:91], v[56:59]
  v_mfma_f32_16x16x32_bf16 v[60:63], v[116:119], v[92:95], v[60:63]
  v_mfma_f32_16x16x32_bf16 v[64:67], v[116:119], v[96:99], v[64:67]
  v_mfma_f32_16x16x32_bf16 v[68:71], v[116:119], v[100:103], v[68:71]
  v_mfma_f32_16x16x32_bf16 v[72:75], v[120:123], v[88:91], v[72:75]
  v_mfma_f32_16x16x32_bf16 v[76:79], v[120:123], v[92:95], v[76:79]
  v_mfma_f32_16x16x32_bf16 v[80:83], v[120:123], v[96:99], v[80:83]
  v_mfma_f32_16x16x32_bf16 v[84:87], v[120:123], v[100:103], v[84:87]
  s_waitcnt vmcnt(3)
  v_mfma_f32_16x16x32_bf16 v[8:11], v[140:143], v[124:127], v[8:11]
  v_mfma_f32_16x16x32_bf16 v[12:15], v[140:143], v[128:131], v[12:15]
  v_mfma_f32_16x16x32_bf16 v[16:19], v[140:143], v[132:135], v[16:19]
  v_mfma_f32_16x16x32_bf16 v[20:23], v[140:143], v[136:139], v[20:23]
  v_mfma_f32_16x16x32_bf16 v[24:27], v[144:147], v[124:127], v[24:27]
  v_mfma_f32_16x16x32_bf16 v[28:31], v[144:147], v[128:131], v[28:31]
  v_mfma_f32_16x16x32_bf16 v[32:35], v[144:147], v[132:135], v[32:35]
  v_mfma_f32_16x16x32_bf16 v[36:39], v[144:147], v[136:139], v[36:39]
  v_mfma_f32_16x16x32_bf16 v[40:43], v[148:151], v[124:127], v[40:43]
  v_mfma_f32_16x16x32_bf16 v[44:47], v[148:151], v[128:131], v[44:47]
  v_mfma_f32_16x16x32_bf16 v[48:51], v[148:151], v[132:135], v[48:51]
  v_mfma_f32_16x16x32_bf16 v[52:55], v[148:151], v[136:139], v[52:55]
  v_mfma_f32_16x16x32_bf16 v[56:59], v[152:155], v[124:127], v[56:59]
  v_mfma_f32_16x16x32_bf16 v[60:63], v[152:155], v[128:131], v[60:63]
  v_mfma_f32_16x16x32_bf16 v[64:67], v[152:155], v[132:135], v[64:67]
  v_mfma_f32_16x16x32_bf16 v[68:71], v[152:155], v[136:139], v[68:71]
  v_mfma_f32_16x16x32_bf16 v[72:75], v[156:159], v[124:127], v[72:75]
  v_mfma_f32_16x16x32_bf16 v[76:79], v[156:159], v[128:131], v[76:79]
  v_mfma_f32_16x16x32_bf16 v[80:83], v[156:159], v[132:135], v[80:83]
  v_mfma_f32_16x16x32_bf16 v[84:87], v[156:159], v[136:139], v[84:87]
  v_mul_u32_u24 v5, 304, v3
  v_lshl_add_u32 v5, v4, 4, v5
  v_lshrrev_b32 v1, 3, v0
  v_mul_u32_u24 v1, 160, v1
  v_and_b32 v88, 7, v0
  v_lshl_add_u32 v1, v88, 4, v1
  v_add_u32 v1, 58368, v1
  s_waitcnt vmcnt(0)
  ds_write_b128 v1, v[236:239]
  ds_write_b128 v1, v[240:243] offset:5120
  v_cmp_gt_u32 vcc, 128, v0
  s_and_saveexec_b64 s[42:43], vcc
  ds_write_b128 v1, v[244:247] offset:10240
  s_mov_b64 exec, s[42:43]
  v_cmp_gt_u32 vcc, 2, v4
  s_add_u32 s39, s35, 1
  s_and_b32 s39, s39, 3
  s_mul_i32 s39, s39, 14592
  v_add_u32 v1, s39, v5
  ds_write_b128 v1, v[12:15] offset:0
  ds_write_b128 v1, v[28:31] offset:64
  ds_write_b128 v1, v[44:47] offset:128
  ds_write_b128 v1, v[60:63] offset:192
  s_and_saveexec_b64 s[42:43], vcc
  ds_write_b128 v1, v[76:79] offset:256
  s_mov_b64 exec, s[42:43]
  s_add_u32 s39, s35, 2
  s_and_b32 s39, s39, 3
  s_mul_i32 s39, s39, 14592
  v_add_u32 v1, s39, v5
  ds_write_b128 v1, v[16:19] offset:4864
  ds_write_b128 v1, v[32:35] offset:4928
  ds_write_b128 v1, v[48:51] offset:4992
  ds_write_b128 v1, v[64:67] offset:5056
  s_and_saveexec_b64 s[42:43], vcc
  ds_write_b128 v1, v[80:83] offset:5120
  s_mov_b64 exec, s[42:43]
  s_add_u32 s39, s35, 3
  s_and_b32 s39, s39, 3
  s_mul_i32 s39, s39, 14592
  v_add_u32 v1, s39, v5
  ds_write_b128 v1, v[20:23] offset:9728
  ds_write_b128 v1, v[36:39] offset:9792
  ds_write_b128 v1, v[52:55] offset:9856
  ds_write_b128 v1, v[68:71] offset:9920
  s_and_saveexec_b64 s[42:43], vcc
  ds_write_b128 v1, v[84:87] offset:9984
  s_mov_b64 exec, s[42:43]
  s_lshl_b32 s38, s68, 6
  s_lshl_b32 s39, s35, 4
  s_add_u32 s38, s38, s39
  v_add_u32 v232, s38, v3
  v_mul_u32_u24 v232, 1152, v232
  v_lshl_add_u32 v232, v4, 3, v232
  s_mul_i32 s38, s69, 144
  v_add_u32 v232, s38, v232
  s_waitcnt lgkmcnt(0)
  s_barrier
  s_mul_i32 s39, s35, 14592
  v_add_u32 v1, s39, v5
  ds_read_b128 v[100:103], v1 offset:0
  ds_read_b128 v[104:107], v1 offset:64
  ds_read_b128 v[108:111], v1 offset:128
  ds_read_b128 v[112:115], v1 offset:192
  ds_read_b128 v[116:119], v1 offset:256
  ds_read_b128 v[120:123], v1 offset:4864
  ds_read_b128 v[124:127], v1 offset:4928
  ds_read_b128 v[128:131], v1 offset:4992
  ds_read_b128 v[132:135], v1 offset:5056
  ds_read_b128 v[136:139], v1 offset:5120
  ds_read_b128 v[140:143], v1 offset:9728
  ds_read_b128 v[144:147], v1 offset:9792
  ds_read_b128 v[148:151], v1 offset:9856
  ds_read_b128 v[152:155], v1 offset:9920
  ds_read_b128 v[156:159], v1 offset:9984
  v_lshrrev_b32 v1, 2, v3
  v_lshl_add_u32 v1, v4, 2, v1
  v_mul_u32_u24 v1, 160, v1
  v_and_b32 v88, 3, v2
  v_lshl_add_u32 v1, v88, 3, v1
  s_lshl_b32 s38, s35, 5
  v_add_u32 v1, s38, v1
  v_add_u32 v1, 58368, v1
  ds_read_b64_tr_b16 v[160:161], v1 offset:0
  ds_read_b64_tr_b16 v[162:163], v1 offset:2560
  ds_read_b64_tr_b16 v[164:165], v1 offset:5120
  ds_read_b64_tr_b16 v[166:167], v1 offset:7680
  ds_read_b64_tr_b16 v[168:169], v1 offset:10240
  s_mov_b32 s44, 0xbfb8aa3b
  s_mov_b32 s45, s44
  s_mov_b32 s46, 1.0
  s_mov_b32 s47, 1.0
  s_waitcnt lgkmcnt(0) vmcnt(0)
  v_pk_add_f32 v[8:9], v[8:9], v[100:101]
  v_pk_add_f32 v[8:9], v[8:9], v[120:121]
  v_pk_add_f32 v[8:9], v[8:9], v[140:141]
  v_pk_add_f32 v[10:11], v[10:11], v[102:103]
  v_pk_add_f32 v[10:11], v[10:11], v[122:123]
  v_pk_add_f32 v[10:11], v[10:11], v[142:143]
  v_pk_add_f32 v[24:25], v[24:25], v[104:105]
  v_pk_add_f32 v[24:25], v[24:25], v[124:125]
  v_pk_add_f32 v[24:25], v[24:25], v[144:145]
  v_pk_add_f32 v[26:27], v[26:27], v[106:107]
  v_pk_add_f32 v[26:27], v[26:27], v[126:127]
  v_pk_add_f32 v[26:27], v[26:27], v[146:147]
  v_pk_add_f32 v[40:41], v[40:41], v[108:109]
  v_pk_add_f32 v[40:41], v[40:41], v[128:129]
  v_pk_add_f32 v[40:41], v[40:41], v[148:149]
  v_pk_add_f32 v[42:43], v[42:43], v[110:111]
  v_pk_add_f32 v[42:43], v[42:43], v[130:131]
  v_pk_add_f32 v[42:43], v[42:43], v[150:151]
  v_pk_add_f32 v[56:57], v[56:57], v[112:113]
  v_pk_add_f32 v[56:57], v[56:57], v[132:133]
  v_pk_add_f32 v[56:57], v[56:57], v[152:153]
  v_pk_add_f32 v[58:59], v[58:59], v[114:115]
  v_pk_add_f32 v[58:59], v[58:59], v[134:135]
  v_pk_add_f32 v[58:59], v[58:59], v[154:155]
  v_pk_add_f32 v[72:73], v[72:73], v[116:117]
  v_pk_add_f32 v[72:73], v[72:73], v[136:137]
  v_pk_add_f32 v[72:73], v[72:73], v[156:157]
  v_pk_add_f32 v[74:75], v[74:75], v[118:119]
  v_pk_add_f32 v[74:75], v[74:75], v[138:139]
  v_pk_add_f32 v[74:75], v[74:75], v[158:159]
  v_cvt_pk_bf16_f32 v172, v8, v9
  v_lshlrev_b32 v8, 16, v172
  v_and_b32 v9, 0xffff0000, v172
  v_pk_mul_f32 v[172:173], v[8:9], s[44:45]
  v_cvt_pk_bf16_f32 v174, v10, v11
  v_lshlrev_b32 v10, 16, v174
  v_and_b32 v11, 0xffff0000, v174
  v_pk_mul_f32 v[174:175], v[10:11], s[44:45]
  v_cvt_pk_bf16_f32 v176, v24, v25
  v_lshlrev_b32 v24, 16, v176
  v_and_b32 v25, 0xffff0000, v176
  v_pk_mul_f32 v[176:177], v[24:25], s[44:45]
  v_cvt_pk_bf16_f32 v178, v26, v27
  v_lshlrev_b32 v26, 16, v178
  v_and_b32 v27, 0xffff0000, v178
  v_pk_mul_f32 v[178:179], v[26:27], s[44:45]
  v_cvt_pk_bf16_f32 v180, v40, v41
  v_lshlrev_b32 v40, 16, v180
  v_and_b32 v41, 0xffff0000, v180
  v_pk_mul_f32 v[180:181], v[40:41], s[44:45]
  v_cvt_pk_bf16_f32 v182, v42, v43
  v_lshlrev_b32 v42, 16, v182
  v_and_b32 v43, 0xffff0000, v182
  v_pk_mul_f32 v[182:183], v[42:43], s[44:45]
  v_cvt_pk_bf16_f32 v184, v56, v57
  v_lshlrev_b32 v56, 16, v184
  v_and_b32 v57, 0xffff0000, v184
  v_pk_mul_f32 v[184:185], v[56:57], s[44:45]
  v_cvt_pk_bf16_f32 v186, v58, v59
  v_lshlrev_b32 v58, 16, v186
  v_and_b32 v59, 0xffff0000, v186
  v_pk_mul_f32 v[186:187], v[58:59], s[44:45]
  v_cvt_pk_bf16_f32 v188, v72, v73
  v_lshlrev_b32 v72, 16, v188
  v_and_b32 v73, 0xffff0000, v188
  v_pk_mul_f32 v[188:189], v[72:73], s[44:45]
  v_cvt_pk_bf16_f32 v190, v74, v75
  v_lshlrev_b32 v74, 16, v190
  v_and_b32 v75, 0xffff0000, v190
  v_pk_mul_f32 v[190:191], v[74:75], s[44:45]
  v_exp_f32 v172, v172
  v_exp_f32 v173, v173
  v_exp_f32 v174, v174
  v_exp_f32 v175, v175
  v_exp_f32 v176, v176
  v_exp_f32 v177, v177
  v_exp_f32 v178, v178
  v_exp_f32 v179, v179
  v_exp_f32 v180, v180
  v_exp_f32 v181, v181
  v_exp_f32 v182, v182
  v_exp_f32 v183, v183
  v_exp_f32 v184, v184
  v_exp_f32 v185, v185
  v_exp_f32 v186, v186
  v_exp_f32 v187, v187
  v_exp_f32 v188, v188
  v_exp_f32 v189, v189
  v_exp_f32 v190, v190
  v_exp_f32 v191, v191
  v_pk_add_f32 v[172:173], v[172:173], s[46:47]
  v_pk_add_f32 v[174:175], v[174:175], s[46:47]
  v_pk_add_f32 v[176:177], v[176:177], s[46:47]
  v_pk_add_f32 v[178:179], v[178:179], s[46:47]
  v_pk_add_f32 v[180:181], v[180:181], s[46:47]
  v_pk_add_f32 v[182:183], v[182:183], s[46:47]
  v_pk_add_f32 v[184:185], v[184:185], s[46:47]
  v_pk_add_f32 v[186:187], v[186:187], s[46:47]
  v_pk_add_f32 v[188:189], v[188:189], s[46:47]
  v_pk_add_f32 v[190:191], v[190:191], s[46:47]
  v_rcp_f32 v172, v172
  v_rcp_f32 v173, v173
  v_rcp_f32 v174, v174
  v_rcp_f32 v175, v175
  v_rcp_f32 v176, v176
  v_rcp_f32 v177, v177
  v_rcp_f32 v178, v178
  v_rcp_f32 v179, v179
  v_rcp_f32 v180, v180
  v_rcp_f32 v181, v181
  v_rcp_f32 v182, v182
  v_rcp_f32 v183, v183
  v_rcp_f32 v184, v184
  v_rcp_f32 v185, v185
  v_rcp_f32 v186, v186
  v_rcp_f32 v187, v187
  v_rcp_f32 v188, v188
  v_rcp_f32 v189, v189
  v_rcp_f32 v190, v190
  v_rcp_f32 v191, v191
  v_pk_mul_f32 v[8:9], v[8:9], v[172:173]
  v_lshlrev_b32 v192, 16, v160
  v_and_b32 v193, 0xffff0000, v160
  v_lshlrev_b32 v194, 16, v248
  v_and_b32 v195, 0xffff0000, v248
  v_pk_fma_f32 v[8:9], v[8:9], v[192:193], v[194:195]
  v_cvt_pk_bf16_f32 v200, v8, v9
  v_pk_mul_f32 v[10:11], v[10:11], v[174:175]
  v_lshlrev_b32 v196, 16, v161
  v_and_b32 v197, 0xffff0000, v161
  v_lshlrev_b32 v198, 16, v249
  v_and_b32 v199, 0xffff0000, v249
  v_pk_fma_f32 v[10:11], v[10:11], v[196:197], v[198:199]
  v_cvt_pk_bf16_f32 v201, v10, v11
  v_pk_mul_f32 v[24:25], v[24:25], v[176:177]
  v_lshlrev_b32 v192, 16, v162
  v_and_b32 v193, 0xffff0000, v162
  v_lshlrev_b32 v194, 16, v250
  v_and_b32 v195, 0xffff0000, v250
  v_pk_fma_f32 v[24:25], v[24:25], v[192:193], v[194:195]
  v_cvt_pk_bf16_f32 v202, v24, v25
  v_pk_mul_f32 v[26:27], v[26:27], v[178:179]
  v_lshlrev_b32 v196, 16, v163
  v_and_b32 v197, 0xffff0000, v163
  v_lshlrev_b32 v198, 16, v251
  v_and_b32 v199, 0xffff0000, v251
  v_pk_fma_f32 v[26:27], v[26:27], v[196:197], v[198:199]
  v_cvt_pk_bf16_f32 v203, v26, v27
  v_pk_mul_f32 v[40:41], v[40:41], v[180:181]
  v_lshlrev_b32 v192, 16, v164
  v_and_b32 v193, 0xffff0000, v164
  v_lshlrev_b32 v194, 16, v252
  v_and_b32 v195, 0xffff0000, v252
  v_pk_fma_f32 v[40:41], v[40:41], v[192:193], v[194:195]
  v_cvt_pk_bf16_f32 v204, v40, v41
  v_pk_mul_f32 v[42:43], v[42:43], v[182:183]
  v_lshlrev_b32 v196, 16, v165
  v_and_b32 v197, 0xffff0000, v165
  v_lshlrev_b32 v198, 16, v253
  v_and_b32 v199, 0xffff0000, v253
  v_pk_fma_f32 v[42:43], v[42:43], v[196:197], v[198:199]
  v_cvt_pk_bf16_f32 v205, v42, v43
  v_pk_mul_f32 v[56:57], v[56:57], v[184:185]
  v_lshlrev_b32 v192, 16, v166
  v_and_b32 v193, 0xffff0000, v166
  v_lshlrev_b32 v194, 16, v254
  v_and_b32 v195, 0xffff0000, v254
  v_pk_fma_f32 v[56:57], v[56:57], v[192:193], v[194:195]
  v_cvt_pk_bf16_f32 v206, v56, v57
  v_pk_mul_f32 v[58:59], v[58:59], v[186:187]
  v_lshlrev_b32 v196, 16, v167
  v_and_b32 v197, 0xffff0000, v167
  v_lshlrev_b32 v198, 16, v255
  v_and_b32 v199, 0xffff0000, v255
  v_pk_fma_f32 v[58:59], v[58:59], v[196:197], v[198:199]
  v_cvt_pk_bf16_f32 v207, v58, v59
  v_pk_mul_f32 v[72:73], v[72:73], v[188:189]
  v_lshlrev_b32 v192, 16, v168
  v_and_b32 v193, 0xffff0000, v168
  v_lshlrev_b32 v194, 16, v6
  v_and_b32 v195, 0xffff0000, v6
  v_pk_fma_f32 v[72:73], v[72:73], v[192:193], v[194:195]
  v_cvt_pk_bf16_f32 v208, v72, v73
  v_pk_mul_f32 v[74:75], v[74:75], v[190:191]
  v_lshlrev_b32 v196, 16, v169
  v_and_b32 v197, 0xffff0000, v169
  v_lshlrev_b32 v198, 16, v7
  v_and_b32 v199, 0xffff0000, v7
  v_pk_fma_f32 v[74:75], v[74:75], v[196:197], v[198:199]
  v_cvt_pk_bf16_f32 v209, v74, v75
  v_cmp_gt_u32 vcc, 2, v4
  buffer_store_dwordx2 v[200:201], v232, s[20:23], 0 offen offset:0
  buffer_store_dwordx2 v[202:203], v232, s[20:23], 0 offen offset:32
  buffer_store_dwordx2 v[204:205], v232, s[20:23], 0 offen offset:64
  buffer_store_dwordx2 v[206:207], v232, s[20:23], 0 offen offset:96
  s_and_saveexec_b64 s[42:43], vcc
  buffer_store_dwordx2 v[208:209], v232, s[20:23], 0 offen offset:128
  s_mov_b64 exec, s[42:43]
  s_endpgm
km_kernel_cv:
  s_sub_u32 s70, s2, 256
  s_load_dwordx2 s[6:7], s[0:1], 112
  s_load_dwordx2 s[4:5], s[0:1], 72
  s_load_dwordx2 s[60:61], s[0:1], 88
  s_load_dwordx4 s[8:11], s[0:1], 8
  s_load_dwordx4 s[12:15], s[0:1], 24
  s_load_dwordx4 s[16:19], s[0:1], 40
  v_lshrrev_b32 v1, 6, v0
  v_and_b32 v2, 63, v0
  v_readfirstlane_b32 s35, v1
  v_and_b32 v3, 15, v2
  v_lshrrev_b32 v4, 4, v2
  s_waitcnt lgkmcnt(0)
  s_mov_b32 s24, s8
  s_mov_b32 s25, s9
  s_mov_b32 s26, 0x24000
  s_mov_b32 s27, 0x20000
  s_mov_b32 s28, s10
  s_mov_b32 s29, s11
  s_mov_b32 s30, 0x24000
  s_mov_b32 s31, 0x20000
  s_mov_b32 s36, s12
  s_mov_b32 s37, s13
  s_mov_b32 s38, 0x24000
  s_mov_b32 s39, 0x20000
  s_mov_b32 s40, s14
  s_mov_b32 s41, s15
  s_mov_b32 s42, 0x24000
  s_mov_b32 s43, 0x20000
  s_mov_b32 s48, s16
  s_mov_b32 s49, s17
  s_mov_b32 s50, 0x480
  s_mov_b32 s51, 0x20000
  s_mov_b32 s52, s18
  s_mov_b32 s53, s19
  s_mov_b32 s54, 0x480
  s_mov_b32 s55, 0x20000
  s_add_u32 s72, s6, 0x1b00000
  s_addc_u32 s73, s7, 0
  s_mov_b32 s74, 0x240000
  s_mov_b32 s75, 0x20000
  s_add_u32 s20, s6, 0x1d40000
  s_addc_u32 s21, s7, 0
  s_mov_b32 s22, 0x240000
  s_mov_b32 s23, 0x20000
  s_add_u32 s44, s6, 0x2f15000
  s_addc_u32 s45, s7, 0
  s_mov_b32 s46, 0x4000
  s_mov_b32 s47, 0x20000
  s_mov_b32 s8, s4
  s_mov_b32 s9, s5
  s_mov_b32 s10, 0x800000
  s_mov_b32 s11, 0x20000
  s_add_u32 s12, s6, 0x1fc4000
  s_addc_u32 s13, s7, 0
  s_mov_b32 s14, 0x800000
  s_mov_b32 s15, 0x20000
  s_mov_b32 s16, s60
  s_mov_b32 s17, s61
  s_mov_b32 s18, 0x288000
  s_mov_b32 s19, 0x20000
  s_add_u32 s60, s6, 0x2c45000
  s_addc_u32 s61, s7, 0
  s_mov_b32 s62, 0x2d0000
  s_mov_b32 s63, 0x20000
  v_lshlrev_b32 v216, 1, v2
  v_mov_b32 v217, 0
  v_mul_u32_u24 v218, 9216, v0
  s_cmp_ge_u32 s70, 192
  s_cbranch_scc1 bal_15
  s_mov_b32 s66, -1
  s_mov_b32 s67, -1
  v_lshrrev_b32 v5, 3, v2
  v_and_b32 v6, 7, v2
  s_lshr_b32 s97, s70, 1
  s_and_b32 s98, s70, 1
  s_lshl_b32 s99, s98, 10
  s_lshl_b32 s100, s35, 8
  s_add_u32 s99, s99, s100
  s_lshl_b32 s100, s97, 16
  s_lshl_b32 s101, s99, 1
  s_add_u32 s100, s100, s101
  v_lshlrev_b32 v7, 12, v5
  v_lshl_add_u32 v7, v6, 4, v7
  v_add_u32 v8, 0x8000, v7
  buffer_load_dwordx4 v[16:19], v7, s[8:11], s100 offen offset:0 nt
  buffer_load_dwordx4 v[20:23], v8, s[8:11], s100 offen offset:0 nt
  buffer_load_dwordx4 v[24:27], v7, s[8:11], s100 offen offset:128 nt
  buffer_load_dwordx4 v[28:31], v8, s[8:11], s100 offen offset:128 nt
  buffer_load_dwordx4 v[32:35], v7, s[8:11], s100 offen offset:256 nt
  buffer_load_dwordx4 v[36:39], v8, s[8:11], s100 offen offset:256 nt
  buffer_load_dwordx4 v[40:43], v7, s[8:11], s100 offen offset:384 nt
  buffer_load_dwordx4 v[44:47], v8, s[8:11], s100 offen offset:384 nt
  s_cmp_ge_u32 s70, 144
  s_cbranch_scc1 nowot_17
  s_lshl_b32 s101, s70, 2
  s_add_u32 s101, s101, s35
  s_mul_i32 s59, s101, 911
  s_lshr_b32 s59, s59, 16
  s_mul_i32 s58, s59, 72
  s_sub_u32 s58, s101, s58
  s_mul_i32 s59, s59, 144
  s_mul_i32 s58, s58, 36864
  s_add_u32 s59, s59, s58
  s_mul_i32 s58, s35, 5120
  v_add_u32 v9, 0, v2
  v_mul_u32_u24 v10, 6554, v9
  v_lshrrev_b32 v10, 16, v10
  v_mul_u32_u24 v11, 10, v10
  v_sub_u32 v11, v9, v11
  v_and_b32 v9, 0x13, v10
  v_bfe_u32 v12, v10, 2, 1
  v_lshl_or_b32 v9, v12, 3, v9
  v_bfe_u32 v12, v10, 3, 1
  v_lshl_or_b32 v9, v12, 2, v9
  v_mul_u32_u24 v9, 1152, v9
  v_lshl_add_u32 v9, v11, 4, v9
  s_add_u32 m0, s58, 0
  s_nop 0
  buffer_load_dwordx4 v9, s[16:19], s59 offen lds
  v_add_u32 v9, 64, v2
  v_mul_u32_u24 v10, 6554, v9
  v_lshrrev_b32 v10, 16, v10
  v_mul_u32_u24 v11, 10, v10
  v_sub_u32 v11, v9, v11
  v_and_b32 v9, 0x13, v10
  v_bfe_u32 v12, v10, 2, 1
  v_lshl_or_b32 v9, v12, 3, v9
  v_bfe_u32 v12, v10, 3, 1
  v_lshl_or_b32 v9, v12, 2, v9
  v_mul_u32_u24 v9, 1152, v9
  v_lshl_add_u32 v9, v11, 4, v9
  s_add_u32 m0, s58, 1024
  s_nop 0
  buffer_load_dwordx4 v9, s[16:19], s59 offen lds
  v_add_u32 v9, 128, v2
  v_mul_u32_u24 v10, 6554, v9
  v_lshrrev_b32 v10, 16, v10
  v_mul_u32_u24 v11, 10, v10
  v_sub_u32 v11, v9, v11
  v_and_b32 v9, 0x13, v10
  v_bfe_u32 v12, v10, 2, 1
  v_lshl_or_b32 v9, v12, 3, v9
  v_bfe_u32 v12, v10, 3, 1
  v_lshl_or_b32 v9, v12, 2, v9
  v_mul_u32_u24 v9, 1152, v9
  v_lshl_add_u32 v9, v11, 4, v9
  s_add_u32 m0, s58, 2048
  s_nop 0
  buffer_load_dwordx4 v9, s[16:19], s59 offen lds
  v_add_u32 v9, 192, v2
  v_mul_u32_u24 v10, 6554, v9
  v_lshrrev_b32 v10, 16, v10
  v_mul_u32_u24 v11, 10, v10
  v_sub_u32 v11, v9, v11
  v_and_b32 v9, 0x13, v10
  v_bfe_u32 v12, v10, 2, 1
  v_lshl_or_b32 v9, v12, 3, v9
  v_bfe_u32 v12, v10, 3, 1
  v_lshl_or_b32 v9, v12, 2, v9
  v_mul_u32_u24 v9, 1152, v9
  v_lshl_add_u32 v9, v11, 4, v9
  s_add_u32 m0, s58, 3072
  s_nop 0
  buffer_load_dwordx4 v9, s[16:19], s59 offen lds
  v_add_u32 v9, 256, v2
  v_mul_u32_u24 v10, 6554, v9
  v_lshrrev_b32 v10, 16, v10
  v_mul_u32_u24 v11, 10, v10
  v_sub_u32 v11, v9, v11
  v_and_b32 v9, 0x13, v10
  v_bfe_u32 v12, v10, 2, 1
  v_lshl_or_b32 v9, v12, 3, v9
  v_bfe_u32 v12, v10, 3, 1
  v_lshl_or_b32 v9, v12, 2, v9
  v_mul_u32_u24 v9, 1152, v9
  v_lshl_add_u32 v9, v11, 4, v9
  s_add_u32 m0, s58, 4096
  s_nop 0
  buffer_load_dwordx4 v9, s[16:19], s59 offen lds
nowot_17:
  s_lshl_b32 s96, s70, 8
  buffer_load_ushort v200, v216, s[24:27], s96 offen offset:0
  buffer_load_ushort v201, v216, s[28:31], s96 offen offset:0
  buffer_load_ushort v202, v216, s[36:39], s96 offen offset:0
  buffer_load_ushort v203, v216, s[40:43], s96 offen offset:0
  buffer_load_ushort v204, v216, s[24:27], s96 offen offset:128
  buffer_load_ushort v205, v216, s[28:31], s96 offen offset:128
  buffer_load_ushort v206, v216, s[36:39], s96 offen offset:128
  buffer_load_ushort v207, v216, s[40:43], s96 offen offset:128
  s_lshl_b32 s96, s70, 1
  buffer_load_ushort v208, v217, s[48:51], s96 offen
  buffer_load_ushort v209, v217, s[52:55], s96 offen
  s_lshl_b32 s96, s70, 4
  buffer_load_dwordx4 v[212:215], v218, s[72:75], s96 offen
  s_waitcnt vmcnt(11)
  s_lshl_b32 s100, s97, 16
  s_lshl_b32 s99, s99, 5
  s_add_u32 s100, s100, s99
  v_lshrrev_b32 v7, 2, v6
  v_lshlrev_b32 v7, 10, v7
  v_and_b32 v8, 3, v6
  v_lshl_add_u32 v7, v8, 8, v7
  v_lshl_add_u32 v7, v5, 4, v7
  buffer_store_dwordx4 v[16:19], v7, s[12:15], s100 offen offset:0 sc1
  buffer_store_dwordx4 v[20:23], v7, s[12:15], s100 offen offset:128 sc1
  buffer_store_dwordx4 v[24:27], v7, s[12:15], s100 offen offset:2048 sc1
  buffer_store_dwordx4 v[28:31], v7, s[12:15], s100 offen offset:2176 sc1
  s_add_u32 s100, s100, 4096
  buffer_store_dwordx4 v[32:35], v7, s[12:15], s100 offen offset:0 sc1
  buffer_store_dwordx4 v[36:39], v7, s[12:15], s100 offen offset:128 sc1
  buffer_store_dwordx4 v[40:43], v7, s[12:15], s100 offen offset:2048 sc1
  buffer_store_dwordx4 v[44:47], v7, s[12:15], s100 offen offset:2176 sc1
  s_lshr_b32 s66, s70, 4
  s_lshl_b32 s66, s66, 8
  s_add_u32 s66, s66, 10240
  s_cmp_ge_u32 s70, 144
  s_cbranch_scc1 nowot_18
  v_lshrrev_b32 v5, 1, v4
  v_lshlrev_b32 v5, 4, v5
  v_and_b32 v6, 1, v4
  v_lshl_add_u32 v5, v6, 2, v5
  v_lshrrev_b32 v6, 2, v3
  v_add_u32 v5, v5, v6
  v_mul_u32_u24 v5, 160, v5
  v_and_b32 v6, 3, v2
  v_lshl_add_u32 v5, v6, 3, v5
  v_add_u32 v5, s58, v5
  ds_read_b64_tr_b16 v[48:49], v5 offset:0
  ds_read_b64_tr_b16 v[50:51], v5 offset:1280
  ds_read_b64_tr_b16 v[52:53], v5 offset:32
  ds_read_b64_tr_b16 v[54:55], v5 offset:1312
  ds_read_b64_tr_b16 v[56:57], v5 offset:64
  ds_read_b64_tr_b16 v[58:59], v5 offset:1344
  ds_read_b64_tr_b16 v[60:61], v5 offset:96
  ds_read_b64_tr_b16 v[62:63], v5 offset:1376
  ds_read_b64_tr_b16 v[64:65], v5 offset:128
  ds_read_b64_tr_b16 v[66:67], v5 offset:1408
  s_mul_i32 s101, s101, 5120
  v_lshlrev_b32 v6, 4, v2
  s_waitcnt lgkmcnt(0)
  buffer_store_dwordx4 v[48:51], v6, s[60:63], s101 offen offset:0 sc1
  buffer_store_dwordx4 v[52:55], v6, s[60:63], s101 offen offset:1024 sc1
  buffer_store_dwordx4 v[56:59], v6, s[60:63], s101 offen offset:2048 sc1
  buffer_store_dwordx4 v[60:63], v6, s[60:63], s101 offen offset:3072 sc1
  s_add_u32 s101, s101, 4096
  buffer_store_dwordx4 v[64:67], v6, s[60:63], s101 offen offset:0 sc1
  s_mul_i32 s67, s70, 3641
  s_lshr_b32 s67, s67, 16
  s_lshl_b32 s67, s67, 8
  s_add_u32 s67, s67, 14336
nowot_18:
  s_cmp_ge_u32 s70, 64
  s_cbranch_scc1 bal_16
  s_waitcnt vmcnt(0)
  s_barrier
  s_cmp_eq_u32 s35, 0
  s_cbranch_scc0 pf_19
  s_mov_b64 s[56:57], exec
  s_mov_b64 exec, 1
  v_mov_b32 v249, 1
  s_cmp_eq_u32 s66, -1
  s_cbranch_scc1 pf_20
  v_mov_b32 v248, s66
  buffer_atomic_add v249, v248, s[44:47], 0 offen sc1
pf_20:
  s_cmp_eq_u32 s67, -1
  s_cbranch_scc1 pf_21
  v_mov_b32 v248, s67
  buffer_atomic_add v249, v248, s[44:47], 0 offen sc1
pf_21:
  s_mov_b64 exec, s[56:57]
pf_19:
  s_mov_b32 s66, -1
  s_mov_b32 s67, -1
  s_add_u32 s68, s70, 192
  s_mov_b32 s66, -1
  s_mov_b32 s67, -1
  v_lshrrev_b32 v5, 3, v2
  v_and_b32 v6, 7, v2
  s_lshr_b32 s97, s68, 1
  s_and_b32 s98, s68, 1
  s_lshl_b32 s99, s98, 10
  s_lshl_b32 s100, s35, 8
  s_add_u32 s99, s99, s100
  s_lshl_b32 s100, s97, 16
  s_lshl_b32 s101, s99, 1
  s_add_u32 s100, s100, s101
  v_lshlrev_b32 v7, 12, v5
  v_lshl_add_u32 v7, v6, 4, v7
  v_add_u32 v8, 0x8000, v7
  buffer_load_dwordx4 v[16:19], v7, s[8:11], s100 offen offset:0 nt
  buffer_load_dwordx4 v[20:23], v8, s[8:11], s100 offen offset:0 nt
  buffer_load_dwordx4 v[24:27], v7, s[8:11], s100 offen offset:128 nt
  buffer_load_dwordx4 v[28:31], v8, s[8:11], s100 offen offset:128 nt
  buffer_load_dwordx4 v[32:35], v7, s[8:11], s100 offen offset:256 nt
  buffer_load_dwordx4 v[36:39], v8, s[8:11], s100 offen offset:256 nt
  buffer_load_dwordx4 v[40:43], v7, s[8:11], s100 offen offset:384 nt
  buffer_load_dwordx4 v[44:47], v8, s[8:11], s100 offen offset:384 nt
  s_waitcnt vmcnt(0)
  s_lshl_b32 s100, s97, 16
  s_lshl_b32 s99, s99, 5
  s_add_u32 s100, s100, s99
  v_lshrrev_b32 v7, 2, v6
  v_lshlrev_b32 v7, 10, v7
  v_and_b32 v8, 3, v6
  v_lshl_add_u32 v7, v8, 8, v7
  v_lshl_add_u32 v7, v5, 4, v7
  buffer_store_dwordx4 v[16:19], v7, s[12:15], s100 offen offset:0 sc1
  buffer_store_dwordx4 v[20:23], v7, s[12:15], s100 offen offset:128 sc1
  buffer_store_dwordx4 v[24:27], v7, s[12:15], s100 offen offset:2048 sc1
  buffer_store_dwordx4 v[28:31], v7, s[12:15], s100 offen offset:2176 sc1
  s_add_u32 s100, s100, 4096
  buffer_store_dwordx4 v[32:35], v7, s[12:15], s100 offen offset:0 sc1
  buffer_store_dwordx4 v[36:39], v7, s[12:15], s100 offen offset:128 sc1
  buffer_store_dwordx4 v[40:43], v7, s[12:15], s100 offen offset:2048 sc1
  buffer_store_dwordx4 v[44:47], v7, s[12:15], s100 offen offset:2176 sc1
  s_lshr_b32 s66, s68, 4
  s_lshl_b32 s66, s66, 8
  s_add_u32 s66, s66, 10240
  s_branch bal_16
bal_15:
  s_lshl_b32 s96, s70, 8
  buffer_load_ushort v200, v216, s[24:27], s96 offen offset:0
  buffer_load_ushort v201, v216, s[28:31], s96 offen offset:0
  buffer_load_ushort v202, v216, s[36:39], s96 offen offset:0
  buffer_load_ushort v203, v216, s[40:43], s96 offen offset:0
  buffer_load_ushort v204, v216, s[24:27], s96 offen offset:128
  buffer_load_ushort v205, v216, s[28:31], s96 offen offset:128
  buffer_load_ushort v206, v216, s[36:39], s96 offen offset:128
  buffer_load_ushort v207, v216, s[40:43], s96 offen offset:128
  s_lshl_b32 s96, s70, 1
  buffer_load_ushort v208, v217, s[48:51], s96 offen
  buffer_load_ushort v209, v217, s[52:55], s96 offen
  s_lshl_b32 s96, s70, 4
  buffer_load_dwordx4 v[212:215], v218, s[72:75], s96 offen
  s_mov_b32 s66, -1
  s_mov_b32 s67, -1
bal_16:
  v_lshlrev_b32 v5, 3, v0
  v_sub_u32 v5, 2047, v5
  v_mov_b32 v12, 1
  v_subrev_u32 v6, 0, v5
  v_cvt_f32_u32 v6, v6
  v_cvt_pk_bf16_f32 v6, v6, v6
  v_and_b32 v6, 0xffff0000, v6
  v_cvt_u32_f32 v6, v6
  v_lshrrev_b32 v7, 7, v6
  v_and_b32 v8, 7, v6
  v_bfe_u32 v6, v6, 3, 4
  v_max_u32 v9, 1, v7
  v_ffbh_u32 v9, v9
  v_sub_u32 v9, 31, v9
  v_min_u32 v9, 3, v9
  v_lshlrev_b32 v10, v9, v12
  v_sub_u32 v7, v7, v10
  v_sub_u32 v10, 3, v9
  v_lshlrev_b32 v7, v10, v7
  v_lshrrev_b32 v8, v9, v8
  v_add_u32 v7, v7, v8
  v_lshl_add_u32 v7, v9, 3, v7
  v_add_u32 v7, 8, v7
  v_lshl_add_u32 v7, v7, 4, v6
  v_lshlrev_b32 v7, 1, v7
  v_add_u32 v220, 50688, v7
  v_subrev_u32 v6, 1, v5
  v_cvt_f32_u32 v6, v6
  v_cvt_pk_bf16_f32 v6, v6, v6
  v_and_b32 v6, 0xffff0000, v6
  v_cvt_u32_f32 v6, v6
  v_lshrrev_b32 v7, 7, v6
  v_and_b32 v8, 7, v6
  v_bfe_u32 v6, v6, 3, 4
  v_max_u32 v9, 1, v7
  v_ffbh_u32 v9, v9
  v_sub_u32 v9, 31, v9
  v_min_u32 v9, 3, v9
  v_lshlrev_b32 v10, v9, v12
  v_sub_u32 v7, v7, v10
  v_sub_u32 v10, 3, v9
  v_lshlrev_b32 v7, v10, v7
  v_lshrrev_b32 v8, v9, v8
  v_add_u32 v7, v7, v8
  v_lshl_add_u32 v7, v9, 3, v7
  v_add_u32 v7, 8, v7
  v_lshl_add_u32 v7, v7, 4, v6
  v_lshlrev_b32 v7, 1, v7
  v_add_u32 v221, 50688, v7
  v_subrev_u32 v6, 2, v5
  v_cvt_f32_u32 v6, v6
  v_cvt_pk_bf16_f32 v6, v6, v6
  v_and_b32 v6, 0xffff0000, v6
  v_cvt_u32_f32 v6, v6
  v_lshrrev_b32 v7, 7, v6
  v_and_b32 v8, 7, v6
  v_bfe_u32 v6, v6, 3, 4
  v_max_u32 v9, 1, v7
  v_ffbh_u32 v9, v9
  v_sub_u32 v9, 31, v9
  v_min_u32 v9, 3, v9
  v_lshlrev_b32 v10, v9, v12
  v_sub_u32 v7, v7, v10
  v_sub_u32 v10, 3, v9
  v_lshlrev_b32 v7, v10, v7
  v_lshrrev_b32 v8, v9, v8
  v_add_u32 v7, v7, v8
  v_lshl_add_u32 v7, v9, 3, v7
  v_add_u32 v7, 8, v7
  v_lshl_add_u32 v7, v7, 4, v6
  v_lshlrev_b32 v7, 1, v7
  v_add_u32 v222, 50688, v7
  v_subrev_u32 v6, 3, v5
  v_cvt_f32_u32 v6, v6
  v_cvt_pk_bf16_f32 v6, v6, v6
  v_and_b32 v6, 0xffff0000, v6
  v_cvt_u32_f32 v6, v6
  v_lshrrev_b32 v7, 7, v6
  v_and_b32 v8, 7, v6
  v_bfe_u32 v6, v6, 3, 4
  v_max_u32 v9, 1, v7
  v_ffbh_u32 v9, v9
  v_sub_u32 v9, 31, v9
  v_min_u32 v9, 3, v9
  v_lshlrev_b32 v10, v9, v12
  v_sub_u32 v7, v7, v10
  v_sub_u32 v10, 3, v9
  v_lshlrev_b32 v7, v10, v7
  v_lshrrev_b32 v8, v9, v8
  v_add_u32 v7, v7, v8
  v_lshl_add_u32 v7, v9, 3, v7
  v_add_u32 v7, 8, v7
  v_lshl_add_u32 v7, v7, 4, v6
  v_lshlrev_b32 v7, 1, v7
  v_add_u32 v223, 50688, v7
  v_subrev_u32 v6, 4, v5
  v_cvt_f32_u32 v6, v6
  v_cvt_pk_bf16_f32 v6, v6, v6
  v_and_b32 v6, 0xffff0000, v6
  v_cvt_u32_f32 v6, v6
  v_lshrrev_b32 v7, 7, v6
  v_and_b32 v8, 7, v6
  v_bfe_u32 v6, v6, 3, 4
  v_max_u32 v9, 1, v7
  v_ffbh_u32 v9, v9
  v_sub_u32 v9, 31, v9
  v_min_u32 v9, 3, v9
  v_lshlrev_b32 v10, v9, v12
  v_sub_u32 v7, v7, v10
  v_sub_u32 v10, 3, v9
  v_lshlrev_b32 v7, v10, v7
  v_lshrrev_b32 v8, v9, v8
  v_add_u32 v7, v7, v8
  v_lshl_add_u32 v7, v9, 3, v7
  v_add_u32 v7, 8, v7
  v_lshl_add_u32 v7, v7, 4, v6
  v_lshlrev_b32 v7, 1, v7
  v_add_u32 v224, 50688, v7
  v_subrev_u32 v6, 5, v5
  v_cvt_f32_u32 v6, v6
  v_cvt_pk_bf16_f32 v6, v6, v6
  v_and_b32 v6, 0xffff0000, v6
  v_cvt_u32_f32 v6, v6
  v_lshrrev_b32 v7, 7, v6
  v_and_b32 v8, 7, v6
  v_bfe_u32 v6, v6, 3, 4
  v_max_u32 v9, 1, v7
  v_ffbh_u32 v9, v9
  v_sub_u32 v9, 31, v9
  v_min_u32 v9, 3, v9
  v_lshlrev_b32 v10, v9, v12
  v_sub_u32 v7, v7, v10
  v_sub_u32 v10, 3, v9
  v_lshlrev_b32 v7, v10, v7
  v_lshrrev_b32 v8, v9, v8
  v_add_u32 v7, v7, v8
  v_lshl_add_u32 v7, v9, 3, v7
  v_add_u32 v7, 8, v7
  v_lshl_add_u32 v7, v7, 4, v6
  v_lshlrev_b32 v7, 1, v7
  v_add_u32 v225, 50688, v7
  v_subrev_u32 v6, 6, v5
  v_cvt_f32_u32 v6, v6
  v_cvt_pk_bf16_f32 v6, v6, v6
  v_and_b32 v6, 0xffff0000, v6
  v_cvt_u32_f32 v6, v6
  v_lshrrev_b32 v7, 7, v6
  v_and_b32 v8, 7, v6
  v_bfe_u32 v6, v6, 3, 4
  v_max_u32 v9, 1, v7
  v_ffbh_u32 v9, v9
  v_sub_u32 v9, 31, v9
  v_min_u32 v9, 3, v9
  v_lshlrev_b32 v10, v9, v12
  v_sub_u32 v7, v7, v10
  v_sub_u32 v10, 3, v9
  v_lshlrev_b32 v7, v10, v7
  v_lshrrev_b32 v8, v9, v8
  v_add_u32 v7, v7, v8
  v_lshl_add_u32 v7, v9, 3, v7
  v_add_u32 v7, 8, v7
  v_lshl_add_u32 v7, v7, 4, v6
  v_lshlrev_b32 v7, 1, v7
  v_add_u32 v226, 50688, v7
  v_subrev_u32 v6, 7, v5
  v_cvt_f32_u32 v6, v6
  v_cvt_pk_bf16_f32 v6, v6, v6
  v_and_b32 v6, 0xffff0000, v6
  v_cvt_u32_f32 v6, v6
  v_lshrrev_b32 v7, 7, v6
  v_and_b32 v8, 7, v6
  v_bfe_u32 v6, v6, 3, 4
  v_max_u32 v9, 1, v7
  v_ffbh_u32 v9, v9
  v_sub_u32 v9, 31, v9
  v_min_u32 v9, 3, v9
  v_lshlrev_b32 v10, v9, v12
  v_sub_u32 v7, v7, v10
  v_sub_u32 v10, 3, v9
  v_lshlrev_b32 v7, v10, v7
  v_lshrrev_b32 v8, v9, v8
  v_add_u32 v7, v7, v8
  v_lshl_add_u32 v7, v9, 3, v7
  v_add_u32 v7, 8, v7
  v_lshl_add_u32 v7, v7, 4, v6
  v_lshlrev_b32 v7, 1, v7
  v_add_u32 v227, 50688, v7
  v_lshlrev_b32 v228, 2, v2
  v_mul_u32_u24 v5, 528, v3
  v_lshl_add_u32 v5, v4, 4, v5
  s_mul_i32 s96, s35, 8448
  v_add_u32 v229, s96, v5
  v_add_u32 v230, 25344, v5
  s_lshl_b32 s96, s35, 10
  v_lshlrev_b32 v5, 8, v4
  v_lshl_add_u32 v5, v3, 1, v5
  v_add_u32 v5, s96, v5
  v_add_u32 v231, 50688, v5
  v_lshrrev_b32 v5, 2, v0
  v_mul_u32_u24 v5, 96, v5
  v_and_b32 v6, 3, v0
  v_lshl_add_u32 v5, v6, 4, v5
  v_add_u32 v232, 55296, v5
  v_lshlrev_b32 v233, 4, v0
  v_sub_u32 v5, 7, v3
  v_and_b32 v5, 7, v5
  v_mul_u32_u24 v5, 4160, v5
  v_lshrrev_b32 v6, 3, v3
  v_sub_u32 v6, v4, v6
  v_add_u32 v6, 253, v6
  v_lshl_add_u32 v5, v6, 4, v5
  s_lshl_b32 s96, s35, 6
  v_subrev_u32 v234, s96, v5
  v_add_u32 v5, 16, v3
  v_subrev_u32 v5, s35, v5
  v_mul_u32_u24 v5, 96, v5
  v_lshl_add_u32 v5, v4, 4, v5
  v_add_u32 v235, 55296, v5
  v_mov_b32 v240, 0
  v_mov_b32 v241, 0
  v_mov_b32 v242, 0
  v_mov_b32 v243, 0
  v_cmp_gt_u32 vcc, 64, v0
  s_and_saveexec_b64 s[56:57], vcc
  ds_write_b128 v232, v[240:243]
  s_mov_b64 exec, s[56:57]
  s_waitcnt vmcnt(0)
  s_barrier
  s_cmp_eq_u32 s35, 0
  s_cbranch_scc0 pf_22
  s_mov_b64 s[56:57], exec
  s_mov_b64 exec, 1
  v_mov_b32 v249, 1
  s_cmp_eq_u32 s66, -1
  s_cbranch_scc1 pf_23
  v_mov_b32 v248, s66
  buffer_atomic_add v249, v248, s[44:47], 0 offen sc1
pf_23:
  s_cmp_eq_u32 s67, -1
  s_cbranch_scc1 pf_24
  v_mov_b32 v248, s67
  buffer_atomic_add v249, v248, s[44:47], 0 offen sc1
pf_24:
  s_mov_b64 exec, s[56:57]
pf_22:
  s_mov_b32 s66, -1
  s_mov_b32 s67, -1
chl_25:
  s_waitcnt vmcnt(2)
  s_barrier
  ds_write_b128 v232, v[212:215] offset:1536
  v_lshlrev_b32 v10, 16, v200
  v_lshlrev_b32 v11, 16, v201
  v_lshlrev_b32 v12, 16, v202
  v_lshlrev_b32 v13, 16, v203
  v_lshlrev_b32 v14, 16, v204
  v_lshlrev_b32 v15, 16, v205
  v_lshlrev_b32 v16, 16, v206
  v_lshlrev_b32 v17, 16, v207
  v_lshlrev_b32 v18, 16, v208
  v_lshlrev_b32 v19, 16, v209
  s_mov_b32 s69, s70
  s_cmp_ge_u32 s69, 512
  s_cselect_b32 s70, 9999, s69
  s_cbranch_scc1 nx_26
  s_cmp_lt_u32 s69, 256
  s_cselect_b32 s96, 256, 64
  s_add_u32 s70, s69, s96
  s_cmp_ge_u32 s70, 512
  s_cbranch_scc1 nx_26_l
  s_cmp_eq_u32 s96, 256
  s_cbranch_scc1 nx_26_l
  s_mov_b32 s70, 9999
  s_branch nx_26
nx_26_l:
  s_waitcnt lgkmcnt(0)
  s_lshl_b32 s96, s70, 8
  buffer_load_ushort v200, v216, s[24:27], s96 offen offset:0
  buffer_load_ushort v201, v216, s[28:31], s96 offen offset:0
  buffer_load_ushort v202, v216, s[36:39], s96 offen offset:0
  buffer_load_ushort v203, v216, s[40:43], s96 offen offset:0
  buffer_load_ushort v204, v216, s[24:27], s96 offen offset:128
  buffer_load_ushort v205, v216, s[28:31], s96 offen offset:128
  buffer_load_ushort v206, v216, s[36:39], s96 offen offset:128
  buffer_load_ushort v207, v216, s[40:43], s96 offen offset:128
  s_lshl_b32 s96, s70, 1
  buffer_load_ushort v208, v217, s[48:51], s96 offen
  buffer_load_ushort v209, v217, s[52:55], s96 offen
  s_lshl_b32 s96, s70, 4
  buffer_load_dwordx4 v[212:215], v218, s[72:75], s96 offen
nx_26:
  v_mul_f32 v18, 0x3fb8aa3b, v18
  v_exp_f32 v18, v18
  v_add_f32 v20, abs(v12), abs(v13)
  v_add_f32 v21, abs(v16), abs(v17)
  v_add_f32 v20, v20, v21
  v_cvt_pk_bf16_f32 v18, v18, v18
  v_and_b32 v18, 0xffff0000, v18
  v_mul_f32 v10, 0x3fb8aa3b, v10
  v_mul_f32 v14, 0x3fb8aa3b, v14
  v_exp_f32 v10, v10
  v_exp_f32 v14, v14
  s_nop 1
  v_add_f32_dpp v20, v20, v20 row_ror:8 row_mask:0xf bank_mask:0xf
  s_nop 1
  v_add_f32_dpp v20, v20, v20 row_ror:4 row_mask:0xf bank_mask:0xf
  s_nop 1
  v_add_f32_dpp v20, v20, v20 row_ror:2 row_mask:0xf bank_mask:0xf
  s_nop 1
  v_add_f32_dpp v20, v20, v20 row_ror:1 row_mask:0xf bank_mask:0xf
  v_mov_b32 v21, v20
  s_nop 1
  v_permlane16_swap_b32 v20, v21
  s_nop 1
  v_add_f32 v20, v20, v21
  v_mov_b32 v21, v20
  s_nop 1
  v_permlane32_swap_b32 v20, v21
  s_nop 1
  v_add_f32 v20, v20, v21
  v_max_f32 v20, 0xda24260, v20
  v_rcp_f32 v21, v20
  v_cvt_pk_bf16_f32 v10, v10, v10
  v_and_b32 v10, 0xffff0000, v10
  v_mul_f32 v10, v10, v18
  v_mul_f32 v10, 0xbfb8aa3b, v10
  v_mul_f32 v11, v11, v18
  v_mul_f32 v11, 0x3e22f983, v11
  v_cvt_pk_bf16_f32 v14, v14, v14
  v_and_b32 v14, 0xffff0000, v14
  v_mul_f32 v14, v14, v18
  v_mul_f32 v14, 0xbfb8aa3b, v14
  v_mul_f32 v15, v15, v18
  v_mul_f32 v15, 0x3e22f983, v15
  v_mul_f32 v21, 0x44800000, v21
  v_mul_f32 v8, v18, v20
  v_mul_f32 v8, 0x3b000000, v8
  v_mov_b32 v9, v19
  v_mul_f32 v12, v12, v21
  v_mul_f32 v13, v13, v21
  v_mul_f32 v16, v16, v21
  v_mul_f32 v17, v17, v21
  s_cmp_eq_u32 s35, 1
  s_cbranch_scc1 kw_27
  s_cmp_eq_u32 s35, 2
  s_cbranch_scc1 kw_28
  s_cmp_eq_u32 s35, 3
  s_cbranch_scc1 kw_29
  s_mov_b32 s96, 0x41000000
  s_mov_b32 s97, 0xc1000000
  v_mul_f32 v44, s96, v10
  v_mul_f32 v45, s97, v11
  v_mul_f32 v46, s96, v14
  v_mul_f32 v47, s97, v15
  v_exp_f32 v44, v44
  v_fract_f32 v45, v45
  v_exp_f32 v46, v46
  v_fract_f32 v47, v47
  v_cos_f32 v28, v45
  v_sin_f32 v29, v45
  v_cos_f32 v30, v47
  v_sin_f32 v31, v47
  s_nop 0
  v_mul_f32 v28, v28, v44
  v_mul_f32 v29, v29, v44
  v_mul_f32 v30, v30, v46
  v_mul_f32 v31, v31, v46
  v_mov_b32 v24, 1.0
  v_mov_b32 v25, 0
  v_mov_b32 v26, 1.0
  v_mov_b32 v27, 0
  v_cvt_pk_f16_f32 v48, v24, v25
  v_cvt_pk_f16_f32 v49, v26, v27
  ds_write_b32 v228, v48 offset:25344
  ds_write_b32 v228, v49 offset:25600
  v_mul_f32 v44, v24, v28
  v_mul_f32 v45, v24, v29
  v_mul_f32 v46, v26, v30
  v_mul_f32 v47, v26, v31
  v_fma_f32 v24, -v25, v29, v44
  v_fma_f32 v25, v25, v28, v45
  v_fma_f32 v26, -v27, v31, v46
  v_fma_f32 v27, v27, v30, v47
  v_cvt_pk_f16_f32 v50, v24, v25
  v_cvt_pk_f16_f32 v51, v26, v27
  ds_write_b32 v228, v50 offset:25872
  ds_write_b32 v228, v51 offset:26128
  v_mul_f32 v44, v24, v28
  v_mul_f32 v45, v24, v29
  v_mul_f32 v46, v26, v30
  v_mul_f32 v47, v26, v31
  v_fma_f32 v24, -v25, v29, v44
  v_fma_f32 v25, v25, v28, v45
  v_fma_f32 v26, -v27, v31, v46
  v_fma_f32 v27, v27, v30, v47
  v_cvt_pk_f16_f32 v48, v24, v25
  v_cvt_pk_f16_f32 v49, v26, v27
  ds_write_b32 v228, v48 offset:26400
  ds_write_b32 v228, v49 offset:26656
  v_mul_f32 v44, v24, v28
  v_mul_f32 v45, v24, v29
  v_mul_f32 v46, v26, v30
  v_mul_f32 v47, v26, v31
  v_fma_f32 v24, -v25, v29, v44
  v_fma_f32 v25, v25, v28, v45
  v_fma_f32 v26, -v27, v31, v46
  v_fma_f32 v27, v27, v30, v47
  v_cvt_pk_f16_f32 v50, v24, v25
  v_cvt_pk_f16_f32 v51, v26, v27
  ds_write_b32 v228, v50 offset:26928
  ds_write_b32 v228, v51 offset:27184
  v_mul_f32 v44, v24, v28
  v_mul_f32 v45, v24, v29
  v_mul_f32 v46, v26, v30
  v_mul_f32 v47, v26, v31
  v_fma_f32 v24, -v25, v29, v44
  v_fma_f32 v25, v25, v28, v45
  v_fma_f32 v26, -v27, v31, v46
  v_fma_f32 v27, v27, v30, v47
  v_cvt_pk_f16_f32 v48, v24, v25
  v_cvt_pk_f16_f32 v49, v26, v27
  ds_write_b32 v228, v48 offset:27456
  ds_write_b32 v228, v49 offset:27712
  v_mul_f32 v44, v24, v28
  v_mul_f32 v45, v24, v29
  v_mul_f32 v46, v26, v30
  v_mul_f32 v47, v26, v31
  v_fma_f32 v24, -v25, v29, v44
  v_fma_f32 v25, v25, v28, v45
  v_fma_f32 v26, -v27, v31, v46
  v_fma_f32 v27, v27, v30, v47
  v_cvt_pk_f16_f32 v50, v24, v25
  v_cvt_pk_f16_f32 v51, v26, v27
  ds_write_b32 v228, v50 offset:27984
  ds_write_b32 v228, v51 offset:28240
  v_mul_f32 v44, v24, v28
  v_mul_f32 v45, v24, v29
  v_mul_f32 v46, v26, v30
  v_mul_f32 v47, v26, v31
  v_fma_f32 v24, -v25, v29, v44
  v_fma_f32 v25, v25, v28, v45
  v_fma_f32 v26, -v27, v31, v46
  v_fma_f32 v27, v27, v30, v47
  v_cvt_pk_f16_f32 v48, v24, v25
  v_cvt_pk_f16_f32 v49, v26, v27
  ds_write_b32 v228, v48 offset:28512
  ds_write_b32 v228, v49 offset:28768
  v_mul_f32 v44, v24, v28
  v_mul_f32 v45, v24, v29
  v_mul_f32 v46, v26, v30
  v_mul_f32 v47, v26, v31
  v_fma_f32 v24, -v25, v29, v44
  v_fma_f32 v25, v25, v28, v45
  v_fma_f32 v26, -v27, v31, v46
  v_fma_f32 v27, v27, v30, v47
  v_cvt_pk_f16_f32 v50, v24, v25
  v_cvt_pk_f16_f32 v51, v26, v27
  ds_write_b32 v228, v50 offset:29040
  ds_write_b32 v228, v51 offset:29296
  v_mul_f32 v44, v24, v28
  v_mul_f32 v45, v24, v29
  v_mul_f32 v46, v26, v30
  v_mul_f32 v47, v26, v31
  v_fma_f32 v24, -v25, v29, v44
  v_fma_f32 v25, v25, v28, v45
  v_fma_f32 v26, -v27, v31, v46
  v_fma_f32 v27, v27, v30, v47
  v_cvt_pk_f16_f32 v48, v24, v25
  v_cvt_pk_f16_f32 v49, v26, v27
  ds_write_b32 v228, v48 offset:29568
  ds_write_b32 v228, v49 offset:29824
  v_mul_f32 v44, v24, v28
  v_mul_f32 v45, v24, v29
  v_mul_f32 v46, v26, v30
  v_mul_f32 v47, v26, v31
  v_fma_f32 v24, -v25, v29, v44
  v_fma_f32 v25, v25, v28, v45
  v_fma_f32 v26, -v27, v31, v46
  v_fma_f32 v27, v27, v30, v47
  v_cvt_pk_f16_f32 v50, v24, v25
  v_cvt_pk_f16_f32 v51, v26, v27
  ds_write_b32 v228, v50 offset:30096
  ds_write_b32 v228, v51 offset:30352
  v_mul_f32 v44, v24, v28
  v_mul_f32 v45, v24, v29
  v_mul_f32 v46, v26, v30
  v_mul_f32 v47, v26, v31
  v_fma_f32 v24, -v25, v29, v44
  v_fma_f32 v25, v25, v28, v45
  v_fma_f32 v26, -v27, v31, v46
  v_fma_f32 v27, v27, v30, v47
  v_cvt_pk_f16_f32 v48, v24, v25
  v_cvt_pk_f16_f32 v49, v26, v27
  ds_write_b32 v228, v48 offset:30624
  ds_write_b32 v228, v49 offset:30880
  v_mul_f32 v44, v24, v28
  v_mul_f32 v45, v24, v29
  v_mul_f32 v46, v26, v30
  v_mul_f32 v47, v26, v31
  v_fma_f32 v24, -v25, v29, v44
  v_fma_f32 v25, v25, v28, v45
  v_fma_f32 v26, -v27, v31, v46
  v_fma_f32 v27, v27, v30, v47
  v_cvt_pk_f16_f32 v50, v24, v25
  v_cvt_pk_f16_f32 v51, v26, v27
  ds_write_b32 v228, v50 offset:31152
  ds_write_b32 v228, v51 offset:31408
  v_mul_f32 v44, v24, v28
  v_mul_f32 v45, v24, v29
  v_mul_f32 v46, v26, v30
  v_mul_f32 v47, v26, v31
  v_fma_f32 v24, -v25, v29, v44
  v_fma_f32 v25, v25, v28, v45
  v_fma_f32 v26, -v27, v31, v46
  v_fma_f32 v27, v27, v30, v47
  v_cvt_pk_f16_f32 v48, v24, v25
  v_cvt_pk_f16_f32 v49, v26, v27
  ds_write_b32 v228, v48 offset:31680
  ds_write_b32 v228, v49 offset:31936
  v_mul_f32 v44, v24, v28
  v_mul_f32 v45, v24, v29
  v_mul_f32 v46, v26, v30
  v_mul_f32 v47, v26, v31
  v_fma_f32 v24, -v25, v29, v44
  v_fma_f32 v25, v25, v28, v45
  v_fma_f32 v26, -v27, v31, v46
  v_fma_f32 v27, v27, v30, v47
  v_cvt_pk_f16_f32 v50, v24, v25
  v_cvt_pk_f16_f32 v51, v26, v27
  ds_write_b32 v228, v50 offset:32208
  ds_write_b32 v228, v51 offset:32464
  v_mul_f32 v44, v24, v28
  v_mul_f32 v45, v24, v29
  v_mul_f32 v46, v26, v30
  v_mul_f32 v47, v26, v31
  v_fma_f32 v24, -v25, v29, v44
  v_fma_f32 v25, v25, v28, v45
  v_fma_f32 v26, -v27, v31, v46
  v_fma_f32 v27, v27, v30, v47
  v_cvt_pk_f16_f32 v48, v24, v25
  v_cvt_pk_f16_f32 v49, v26, v27
  ds_write_b32 v228, v48 offset:32736
  ds_write_b32 v228, v49 offset:32992
  v_mul_f32 v44, v24, v28
  v_mul_f32 v45, v24, v29
  v_mul_f32 v46, v26, v30
  v_mul_f32 v47, v26, v31
  v_fma_f32 v24, -v25, v29, v44
  v_fma_f32 v25, v25, v28, v45
  v_fma_f32 v26, -v27, v31, v46
  v_fma_f32 v27, v27, v30, v47
  v_cvt_pk_f16_f32 v50, v24, v25
  v_cvt_pk_f16_f32 v51, v26, v27
  ds_write_b32 v228, v50 offset:33264
  ds_write_b32 v228, v51 offset:33520
  s_branch kw_30
kw_27:
  s_mov_b32 s96, 0x3f800000
  s_mov_b32 s97, 0x3f800000
  v_mul_f32 v44, s96, v10
  v_mul_f32 v45, s97, v11
  v_mul_f32 v46, s96, v14
  v_mul_f32 v47, s97, v15
  v_exp_f32 v44, v44
  v_fract_f32 v45, v45
  v_exp_f32 v46, v46
  v_fract_f32 v47, v47
  v_cos_f32 v28, v45
  v_sin_f32 v29, v45
  v_cos_f32 v30, v47
  v_sin_f32 v31, v47
  s_nop 0
  v_mul_f32 v28, v28, v44
  v_mul_f32 v29, v29, v44
  v_mul_f32 v30, v30, v46
  v_mul_f32 v31, v31, v46
  s_mov_b32 s96, 0x43000000
  s_mov_b32 s97, 0x43000000
  v_mul_f32 v44, s96, v10
  v_mul_f32 v45, s97, v11
  v_mul_f32 v46, s96, v14
  v_mul_f32 v47, s97, v15
  v_exp_f32 v44, v44
  v_fract_f32 v45, v45
  v_exp_f32 v46, v46
  v_fract_f32 v47, v47
  v_cos_f32 v32, v45
  v_sin_f32 v33, v45
  v_cos_f32 v34, v47
  v_sin_f32 v35, v47
  s_nop 0
  v_mul_f32 v32, v32, v44
  v_mul_f32 v33, v33, v44
  v_mul_f32 v34, v34, v46
  v_mul_f32 v35, v35, v46
  v_mov_b32 v24, v12
  v_mov_b32 v25, v13
  v_mov_b32 v26, v16
  v_mov_b32 v27, v17
  v_mul_f32 v44, v32, v24
  v_mul_f32 v45, v32, v25
  v_mul_f32 v46, v34, v26
  v_mul_f32 v47, v34, v27
  v_fma_f32 v32, -v33, v25, v44
  v_fma_f32 v33, v33, v24, v45
  v_fma_f32 v34, -v35, v27, v46
  v_fma_f32 v35, v35, v26, v47
  v_cvt_pk_f16_f32 v48, v24, v25
  v_cvt_pk_f16_f32 v49, v26, v27
  ds_write_b32 v228, v48 offset:0
  ds_write_b32 v228, v49 offset:256
  v_cvt_pk_f16_f32 v50, v32, v33
  v_cvt_pk_f16_f32 v51, v34, v35
  ds_write_b32 v228, v50 offset:4224
  ds_write_b32 v228, v51 offset:4480
  v_mul_f32 v44, v24, v28
  v_mul_f32 v45, v24, v29
  v_mul_f32 v46, v26, v30
  v_mul_f32 v47, v26, v31
  v_fma_f32 v24, -v25, v29, v44
  v_fma_f32 v25, v25, v28, v45
  v_fma_f32 v26, -v27, v31, v46
  v_fma_f32 v27, v27, v30, v47
  v_mul_f32 v44, v32, v28
  v_mul_f32 v45, v32, v29
  v_mul_f32 v46, v34, v30
  v_mul_f32 v47, v34, v31
  v_fma_f32 v32, -v33, v29, v44
  v_fma_f32 v33, v33, v28, v45
  v_fma_f32 v34, -v35, v31, v46
  v_fma_f32 v35, v35, v30, v47
  v_cvt_pk_f16_f32 v48, v24, v25
  v_cvt_pk_f16_f32 v49, v26, v27
  ds_write_b32 v228, v48 offset:528
  ds_write_b32 v228, v49 offset:784
  v_cvt_pk_f16_f32 v50, v32, v33
  v_cvt_pk_f16_f32 v51, v34, v35
  ds_write_b32 v228, v50 offset:4752
  ds_write_b32 v228, v51 offset:5008
  v_mul_f32 v44, v24, v28
  v_mul_f32 v45, v24, v29
  v_mul_f32 v46, v26, v30
  v_mul_f32 v47, v26, v31
  v_fma_f32 v24, -v25, v29, v44
  v_fma_f32 v25, v25, v28, v45
  v_fma_f32 v26, -v27, v31, v46
  v_fma_f32 v27, v27, v30, v47
  v_mul_f32 v44, v32, v28
  v_mul_f32 v45, v32, v29
  v_mul_f32 v46, v34, v30
  v_mul_f32 v47, v34, v31
  v_fma_f32 v32, -v33, v29, v44
  v_fma_f32 v33, v33, v28, v45
  v_fma_f32 v34, -v35, v31, v46
  v_fma_f32 v35, v35, v30, v47
  v_cvt_pk_f16_f32 v48, v24, v25
  v_cvt_pk_f16_f32 v49, v26, v27
  ds_write_b32 v228, v48 offset:1056
  ds_write_b32 v228, v49 offset:1312
  v_cvt_pk_f16_f32 v50, v32, v33
  v_cvt_pk_f16_f32 v51, v34, v35
  ds_write_b32 v228, v50 offset:5280
  ds_write_b32 v228, v51 offset:5536
  v_mul_f32 v44, v24, v28
  v_mul_f32 v45, v24, v29
  v_mul_f32 v46, v26, v30
  v_mul_f32 v47, v26, v31
  v_fma_f32 v24, -v25, v29, v44
  v_fma_f32 v25, v25, v28, v45
  v_fma_f32 v26, -v27, v31, v46
  v_fma_f32 v27, v27, v30, v47
  v_mul_f32 v44, v32, v28
  v_mul_f32 v45, v32, v29
  v_mul_f32 v46, v34, v30
  v_mul_f32 v47, v34, v31
  v_fma_f32 v32, -v33, v29, v44
  v_fma_f32 v33, v33, v28, v45
  v_fma_f32 v34, -v35, v31, v46
  v_fma_f32 v35, v35, v30, v47
  v_cvt_pk_f16_f32 v48, v24, v25
  v_cvt_pk_f16_f32 v49, v26, v27
  ds_write_b32 v228, v48 offset:1584
  ds_write_b32 v228, v49 offset:1840
  v_cvt_pk_f16_f32 v50, v32, v33
  v_cvt_pk_f16_f32 v51, v34, v35
  ds_write_b32 v228, v50 offset:5808
  ds_write_b32 v228, v51 offset:6064
  v_mul_f32 v44, v24, v28
  v_mul_f32 v45, v24, v29
  v_mul_f32 v46, v26, v30
  v_mul_f32 v47, v26, v31
  v_fma_f32 v24, -v25, v29, v44
  v_fma_f32 v25, v25, v28, v45
  v_fma_f32 v26, -v27, v31, v46
  v_fma_f32 v27, v27, v30, v47
  v_mul_f32 v44, v32, v28
  v_mul_f32 v45, v32, v29
  v_mul_f32 v46, v34, v30
  v_mul_f32 v47, v34, v31
  v_fma_f32 v32, -v33, v29, v44
  v_fma_f32 v33, v33, v28, v45
  v_fma_f32 v34, -v35, v31, v46
  v_fma_f32 v35, v35, v30, v47
  v_cvt_pk_f16_f32 v48, v24, v25
  v_cvt_pk_f16_f32 v49, v26, v27
  ds_write_b32 v228, v48 offset:2112
  ds_write_b32 v228, v49 offset:2368
  v_cvt_pk_f16_f32 v50, v32, v33
  v_cvt_pk_f16_f32 v51, v34, v35
  ds_write_b32 v228, v50 offset:6336
  ds_write_b32 v228, v51 offset:6592
  v_mul_f32 v44, v24, v28
  v_mul_f32 v45, v24, v29
  v_mul_f32 v46, v26, v30
  v_mul_f32 v47, v26, v31
  v_fma_f32 v24, -v25, v29, v44
  v_fma_f32 v25, v25, v28, v45
  v_fma_f32 v26, -v27, v31, v46
  v_fma_f32 v27, v27, v30, v47
  v_mul_f32 v44, v32, v28
  v_mul_f32 v45, v32, v29
  v_mul_f32 v46, v34, v30
  v_mul_f32 v47, v34, v31
  v_fma_f32 v32, -v33, v29, v44
  v_fma_f32 v33, v33, v28, v45
  v_fma_f32 v34, -v35, v31, v46
  v_fma_f32 v35, v35, v30, v47
  v_cvt_pk_f16_f32 v48, v24, v25
  v_cvt_pk_f16_f32 v49, v26, v27
  ds_write_b32 v228, v48 offset:2640
  ds_write_b32 v228, v49 offset:2896
  v_cvt_pk_f16_f32 v50, v32, v33
  v_cvt_pk_f16_f32 v51, v34, v35
  ds_write_b32 v228, v50 offset:6864
  ds_write_b32 v228, v51 offset:7120
  v_mul_f32 v44, v24, v28
  v_mul_f32 v45, v24, v29
  v_mul_f32 v46, v26, v30
  v_mul_f32 v47, v26, v31
  v_fma_f32 v24, -v25, v29, v44
  v_fma_f32 v25, v25, v28, v45
  v_fma_f32 v26, -v27, v31, v46
  v_fma_f32 v27, v27, v30, v47
  v_mul_f32 v44, v32, v28
  v_mul_f32 v45, v32, v29
  v_mul_f32 v46, v34, v30
  v_mul_f32 v47, v34, v31
  v_fma_f32 v32, -v33, v29, v44
  v_fma_f32 v33, v33, v28, v45
  v_fma_f32 v34, -v35, v31, v46
  v_fma_f32 v35, v35, v30, v47
  v_cvt_pk_f16_f32 v48, v24, v25
  v_cvt_pk_f16_f32 v49, v26, v27
  ds_write_b32 v228, v48 offset:3168
  ds_write_b32 v228, v49 offset:3424
  v_cvt_pk_f16_f32 v50, v32, v33
  v_cvt_pk_f16_f32 v51, v34, v35
  ds_write_b32 v228, v50 offset:7392
  ds_write_b32 v228, v51 offset:7648
  v_mul_f32 v44, v24, v28
  v_mul_f32 v45, v24, v29
  v_mul_f32 v46, v26, v30
  v_mul_f32 v47, v26, v31
  v_fma_f32 v24, -v25, v29, v44
  v_fma_f32 v25, v25, v28, v45
  v_fma_f32 v26, -v27, v31, v46
  v_fma_f32 v27, v27, v30, v47
  v_mul_f32 v44, v32, v28
  v_mul_f32 v45, v32, v29
  v_mul_f32 v46, v34, v30
  v_mul_f32 v47, v34, v31
  v_fma_f32 v32, -v33, v29, v44
  v_fma_f32 v33, v33, v28, v45
  v_fma_f32 v34, -v35, v31, v46
  v_fma_f32 v35, v35, v30, v47
  v_cvt_pk_f16_f32 v48, v24, v25
  v_cvt_pk_f16_f32 v49, v26, v27
  ds_write_b32 v228, v48 offset:3696
  ds_write_b32 v228, v49 offset:3952
  v_cvt_pk_f16_f32 v50, v32, v33
  v_cvt_pk_f16_f32 v51, v34, v35
  ds_write_b32 v228, v50 offset:7920
  ds_write_b32 v228, v51 offset:8176
  s_branch kw_30
kw_28:
  s_mov_b32 s96, 0x43000000
  s_mov_b32 s97, 0x43000000
  v_mul_f32 v44, s96, v10
  v_mul_f32 v45, s97, v11
  v_mul_f32 v46, s96, v14
  v_mul_f32 v47, s97, v15
  v_exp_f32 v44, v44
  v_fract_f32 v45, v45
  v_exp_f32 v46, v46
  v_fract_f32 v47, v47
  v_cos_f32 v28, v45
  v_sin_f32 v29, v45
  v_cos_f32 v30, v47
  v_sin_f32 v31, v47
  s_nop 0
  v_mul_f32 v28, v28, v44
  v_mul_f32 v29, v29, v44
  v_mul_f32 v30, v30, v46
  v_mul_f32 v31, v31, v46
  s_mov_b32 s96, 0x43800000
  s_mov_b32 s97, 0x43800000
  v_mul_f32 v44, s96, v10
  v_mul_f32 v45, s97, v11
  v_mul_f32 v46, s96, v14
  v_mul_f32 v47, s97, v15
  v_exp_f32 v44, v44
  v_fract_f32 v45, v45
  v_exp_f32 v46, v46
  v_fract_f32 v47, v47
  v_cos_f32 v32, v45
  v_sin_f32 v33, v45
  v_cos_f32 v34, v47
  v_sin_f32 v35, v47
  s_nop 0
  v_mul_f32 v32, v32, v44
  v_mul_f32 v33, v33, v44
  v_mul_f32 v34, v34, v46
  v_mul_f32 v35, v35, v46
  s_mov_b32 s96, 0x40000000
  s_mov_b32 s97, 0x40000000
  v_mul_f32 v44, s96, v10
  v_mul_f32 v45, s97, v11
  v_mul_f32 v46, s96, v14
  v_mul_f32 v47, s97, v15
  v_exp_f32 v44, v44
  v_fract_f32 v45, v45
  v_exp_f32 v46, v46
  v_fract_f32 v47, v47
  v_cos_f32 v36, v45
  v_sin_f32 v37, v45
  v_cos_f32 v38, v47
  v_sin_f32 v39, v47
  s_nop 0
  v_mul_f32 v36, v36, v44
  v_mul_f32 v37, v37, v44
  v_mul_f32 v38, v38, v46
  v_mul_f32 v39, v39, v46
  v_mov_b32 v24, v12
  v_mov_b32 v25, v13
  v_mov_b32 v26, v16
  v_mov_b32 v27, v17
  v_mul_f32 v44, v32, v24
  v_mul_f32 v45, v32, v25
  v_mul_f32 v46, v34, v26
  v_mul_f32 v47, v34, v27
  v_fma_f32 v32, -v33, v25, v44
  v_fma_f32 v33, v33, v24, v45
  v_fma_f32 v34, -v35, v27, v46
  v_fma_f32 v35, v35, v26, v47
  v_mul_f32 v44, v36, v36
  v_mul_f32 v45, v36, v37
  v_mul_f32 v46, v38, v38
  v_mul_f32 v47, v38, v39
  v_fma_f32 v52, -v37, v37, v44
  v_fma_f32 v41, v37, v36, v45
  v_fma_f32 v53, -v39, v39, v46
  v_fma_f32 v43, v39, v38, v47
  v_mov_b32 v40, v52
  v_mov_b32 v42, v53
  v_cvt_pk_f16_f32 v48, v32, v33
  v_cvt_pk_f16_f32 v49, v34, v35
  ds_write_b32 v228, v48 offset:8448
  ds_write_b32 v228, v49 offset:8704
  v_mul_f32 v44, v32, v36
  v_mul_f32 v45, v32, v37
  v_mul_f32 v46, v34, v38
  v_mul_f32 v47, v34, v39
  v_fma_f32 v52, -v33, v37, v44
  v_fma_f32 v25, v33, v36, v45
  v_fma_f32 v53, -v35, v39, v46
  v_fma_f32 v27, v35, v38, v47
  v_mov_b32 v24, v52
  v_mov_b32 v26, v53
  v_cvt_pk_f16_f32 v50, v24, v25
  v_cvt_pk_f16_f32 v51, v26, v27
  ds_write_b32 v228, v50 offset:8976
  ds_write_b32 v228, v51 offset:9232
  v_mul_f32 v44, v24, v36
  v_mul_f32 v45, v24, v37
  v_mul_f32 v46, v26, v38
  v_mul_f32 v47, v26, v39
  v_fma_f32 v24, -v25, v37, v44
  v_fma_f32 v25, v25, v36, v45
  v_fma_f32 v26, -v27, v39, v46
  v_fma_f32 v27, v27, v38, v47
  v_cvt_pk_f16_f32 v48, v24, v25
  v_cvt_pk_f16_f32 v49, v26, v27
  ds_write_b32 v228, v48 offset:9504
  ds_write_b32 v228, v49 offset:9760
  v_mul_f32 v44, v24, v36
  v_mul_f32 v45, v24, v37
  v_mul_f32 v46, v26, v38
  v_mul_f32 v47, v26, v39
  v_fma_f32 v24, -v25, v37, v44
  v_fma_f32 v25, v25, v36, v45
  v_fma_f32 v26, -v27, v39, v46
  v_fma_f32 v27, v27, v38, v47
  v_cvt_pk_f16_f32 v50, v24, v25
  v_cvt_pk_f16_f32 v51, v26, v27
  ds_write_b32 v228, v50 offset:10032
  ds_write_b32 v228, v51 offset:10288
  v_mul_f32 v44, v32, v28
  v_mul_f32 v45, v32, v29
  v_mul_f32 v46, v34, v30
  v_mul_f32 v47, v34, v31
  v_fma_f32 v32, -v33, v29, v44
  v_fma_f32 v33, v33, v28, v45
  v_fma_f32 v34, -v35, v31, v46
  v_fma_f32 v35, v35, v30, v47
  v_cvt_pk_f16_f32 v48, v32, v33
  v_cvt_pk_f16_f32 v49, v34, v35
  ds_write_b32 v228, v48 offset:10560
  ds_write_b32 v228, v49 offset:10816
  v_mul_f32 v44, v32, v36
  v_mul_f32 v45, v32, v37
  v_mul_f32 v46, v34, v38
  v_mul_f32 v47, v34, v39
  v_fma_f32 v52, -v33, v37, v44
  v_fma_f32 v25, v33, v36, v45
  v_fma_f32 v53, -v35, v39, v46
  v_fma_f32 v27, v35, v38, v47
  v_mov_b32 v24, v52
  v_mov_b32 v26, v53
  v_cvt_pk_f16_f32 v50, v24, v25
  v_cvt_pk_f16_f32 v51, v26, v27
  ds_write_b32 v228, v50 offset:11088
  ds_write_b32 v228, v51 offset:11344
  v_mul_f32 v44, v24, v36
  v_mul_f32 v45, v24, v37
  v_mul_f32 v46, v26, v38
  v_mul_f32 v47, v26, v39
  v_fma_f32 v24, -v25, v37, v44
  v_fma_f32 v25, v25, v36, v45
  v_fma_f32 v26, -v27, v39, v46
  v_fma_f32 v27, v27, v38, v47
  v_cvt_pk_f16_f32 v48, v24, v25
  v_cvt_pk_f16_f32 v49, v26, v27
  ds_write_b32 v228, v48 offset:11616
  ds_write_b32 v228, v49 offset:11872
  v_mul_f32 v44, v24, v36
  v_mul_f32 v45, v24, v37
  v_mul_f32 v46, v26, v38
  v_mul_f32 v47, v26, v39
  v_fma_f32 v24, -v25, v37, v44
  v_fma_f32 v25, v25, v36, v45
  v_fma_f32 v26, -v27, v39, v46
  v_fma_f32 v27, v27, v38, v47
  v_cvt_pk_f16_f32 v50, v24, v25
  v_cvt_pk_f16_f32 v51, v26, v27
  ds_write_b32 v228, v50 offset:12144
  ds_write_b32 v228, v51 offset:12400
  v_mul_f32 v44, v32, v28
  v_mul_f32 v45, v32, v29
  v_mul_f32 v46, v34, v30
  v_mul_f32 v47, v34, v31
  v_fma_f32 v32, -v33, v29, v44
  v_fma_f32 v33, v33, v28, v45
  v_fma_f32 v34, -v35, v31, v46
  v_fma_f32 v35, v35, v30, v47
  v_cvt_pk_f16_f32 v48, v32, v33
  v_cvt_pk_f16_f32 v49, v34, v35
  ds_write_b32 v228, v48 offset:12672
  ds_write_b32 v228, v49 offset:12928
  v_mul_f32 v44, v32, v40
  v_mul_f32 v45, v32, v41
  v_mul_f32 v46, v34, v42
  v_mul_f32 v47, v34, v43
  v_fma_f32 v52, -v33, v41, v44
  v_fma_f32 v25, v33, v40, v45
  v_fma_f32 v53, -v35, v43, v46
  v_fma_f32 v27, v35, v42, v47
  v_mov_b32 v24, v52
  v_mov_b32 v26, v53
  v_cvt_pk_f16_f32 v50, v24, v25
  v_cvt_pk_f16_f32 v51, v26, v27
  ds_write_b32 v228, v50 offset:13200
  ds_write_b32 v228, v51 offset:13456
  v_mul_f32 v44, v32, v28
  v_mul_f32 v45, v32, v29
  v_mul_f32 v46, v34, v30
  v_mul_f32 v47, v34, v31
  v_fma_f32 v32, -v33, v29, v44
  v_fma_f32 v33, v33, v28, v45
  v_fma_f32 v34, -v35, v31, v46
  v_fma_f32 v35, v35, v30, v47
  v_cvt_pk_f16_f32 v48, v32, v33
  v_cvt_pk_f16_f32 v49, v34, v35
  ds_write_b32 v228, v48 offset:13728
  ds_write_b32 v228, v49 offset:13984
  v_mul_f32 v44, v32, v40
  v_mul_f32 v45, v32, v41
  v_mul_f32 v46, v34, v42
  v_mul_f32 v47, v34, v43
  v_fma_f32 v52, -v33, v41, v44
  v_fma_f32 v25, v33, v40, v45
  v_fma_f32 v53, -v35, v43, v46
  v_fma_f32 v27, v35, v42, v47
  v_mov_b32 v24, v52
  v_mov_b32 v26, v53
  v_cvt_pk_f16_f32 v50, v24, v25
  v_cvt_pk_f16_f32 v51, v26, v27
  ds_write_b32 v228, v50 offset:14256
  ds_write_b32 v228, v51 offset:14512
  v_mul_f32 v44, v32, v28
  v_mul_f32 v45, v32, v29
  v_mul_f32 v46, v34, v30
  v_mul_f32 v47, v34, v31
  v_fma_f32 v32, -v33, v29, v44
  v_fma_f32 v33, v33, v28, v45
  v_fma_f32 v34, -v35, v31, v46
  v_fma_f32 v35, v35, v30, v47
  v_cvt_pk_f16_f32 v48, v32, v33
  v_cvt_pk_f16_f32 v49, v34, v35
  ds_write_b32 v228, v48 offset:14784
  ds_write_b32 v228, v49 offset:15040
  v_mul_f32 v44, v32, v40
  v_mul_f32 v45, v32, v41
  v_mul_f32 v46, v34, v42
  v_mul_f32 v47, v34, v43
  v_fma_f32 v52, -v33, v41, v44
  v_fma_f32 v25, v33, v40, v45
  v_fma_f32 v53, -v35, v43, v46
  v_fma_f32 v27, v35, v42, v47
  v_mov_b32 v24, v52
  v_mov_b32 v26, v53
  v_cvt_pk_f16_f32 v50, v24, v25
  v_cvt_pk_f16_f32 v51, v26, v27
  ds_write_b32 v228, v50 offset:15312
  ds_write_b32 v228, v51 offset:15568
  v_mul_f32 v44, v32, v28
  v_mul_f32 v45, v32, v29
  v_mul_f32 v46, v34, v30
  v_mul_f32 v47, v34, v31
  v_fma_f32 v32, -v33, v29, v44
  v_fma_f32 v33, v33, v28, v45
  v_fma_f32 v34, -v35, v31, v46
  v_fma_f32 v35, v35, v30, v47
  v_cvt_pk_f16_f32 v48, v32, v33
  v_cvt_pk_f16_f32 v49, v34, v35
  ds_write_b32 v228, v48 offset:15840
  ds_write_b32 v228, v49 offset:16096
  v_mul_f32 v44, v32, v40
  v_mul_f32 v45, v32, v41
  v_mul_f32 v46, v34, v42
  v_mul_f32 v47, v34, v43
  v_fma_f32 v52, -v33, v41, v44
  v_fma_f32 v25, v33, v40, v45
  v_fma_f32 v53, -v35, v43, v46
  v_fma_f32 v27, v35, v42, v47
  v_mov_b32 v24, v52
  v_mov_b32 v26, v53
  v_cvt_pk_f16_f32 v50, v24, v25
  v_cvt_pk_f16_f32 v51, v26, v27
  ds_write_b32 v228, v50 offset:16368
  ds_write_b32 v228, v51 offset:16624
  s_branch kw_30
kw_29:
  s_mov_b32 s96, 0x43000000
  s_mov_b32 s97, 0x43000000
  v_mul_f32 v44, s96, v10
  v_mul_f32 v45, s97, v11
  v_mul_f32 v46, s96, v14
  v_mul_f32 v47, s97, v15
  v_exp_f32 v44, v44
  v_fract_f32 v45, v45
  v_exp_f32 v46, v46
  v_fract_f32 v47, v47
  v_cos_f32 v28, v45
  v_sin_f32 v29, v45
  v_cos_f32 v30, v47
  v_sin_f32 v31, v47
  s_nop 0
  v_mul_f32 v28, v28, v44
  v_mul_f32 v29, v29, v44
  v_mul_f32 v30, v30, v46
  v_mul_f32 v31, v31, v46
  s_mov_b32 s96, 0x44800000
  s_mov_b32 s97, 0x44800000
  v_mul_f32 v44, s96, v10
  v_mul_f32 v45, s97, v11
  v_mul_f32 v46, s96, v14
  v_mul_f32 v47, s97, v15
  v_exp_f32 v44, v44
  v_fract_f32 v45, v45
  v_exp_f32 v46, v46
  v_fract_f32 v47, v47
  v_cos_f32 v32, v45
  v_sin_f32 v33, v45
  v_cos_f32 v34, v47
  v_sin_f32 v35, v47
  s_nop 0
  v_mul_f32 v32, v32, v44
  v_mul_f32 v33, v33, v44
  v_mul_f32 v34, v34, v46
  v_mul_f32 v35, v35, v46
  v_mov_b32 v24, v12
  v_mov_b32 v25, v13
  v_mov_b32 v26, v16
  v_mov_b32 v27, v17
  v_mul_f32 v44, v32, v24
  v_mul_f32 v45, v32, v25
  v_mul_f32 v46, v34, v26
  v_mul_f32 v47, v34, v27
  v_fma_f32 v32, -v33, v25, v44
  v_fma_f32 v33, v33, v24, v45
  v_fma_f32 v34, -v35, v27, v46
  v_fma_f32 v35, v35, v26, v47
  v_cvt_pk_f16_f32 v48, v32, v33
  v_cvt_pk_f16_f32 v49, v34, v35
  ds_write_b32 v228, v48 offset:16896
  ds_write_b32 v228, v49 offset:17152
  v_mul_f32 v44, v32, v28
  v_mul_f32 v45, v32, v29
  v_mul_f32 v46, v34, v30
  v_mul_f32 v47, v34, v31
  v_fma_f32 v32, -v33, v29, v44
  v_fma_f32 v33, v33, v28, v45
  v_fma_f32 v34, -v35, v31, v46
  v_fma_f32 v35, v35, v30, v47
  v_cvt_pk_f16_f32 v50, v32, v33
  v_cvt_pk_f16_f32 v51, v34, v35
  ds_write_b32 v228, v50 offset:17424
  ds_write_b32 v228, v51 offset:17680
  v_mul_f32 v44, v32, v28
  v_mul_f32 v45, v32, v29
  v_mul_f32 v46, v34, v30
  v_mul_f32 v47, v34, v31
  v_fma_f32 v32, -v33, v29, v44
  v_fma_f32 v33, v33, v28, v45
  v_fma_f32 v34, -v35, v31, v46
  v_fma_f32 v35, v35, v30, v47
  v_cvt_pk_f16_f32 v48, v32, v33
  v_cvt_pk_f16_f32 v49, v34, v35
  ds_write_b32 v228, v48 offset:17952
  ds_write_b32 v228, v49 offset:18208
  v_mul_f32 v44, v32, v28
  v_mul_f32 v45, v32, v29
  v_mul_f32 v46, v34, v30
  v_mul_f32 v47, v34, v31
  v_fma_f32 v32, -v33, v29, v44
  v_fma_f32 v33, v33, v28, v45
  v_fma_f32 v34, -v35, v31, v46
  v_fma_f32 v35, v35, v30, v47
  v_cvt_pk_f16_f32 v50, v32, v33
  v_cvt_pk_f16_f32 v51, v34, v35
  ds_write_b32 v228, v50 offset:18480
  ds_write_b32 v228, v51 offset:18736
  v_mul_f32 v44, v32, v28
  v_mul_f32 v45, v32, v29
  v_mul_f32 v46, v34, v30
  v_mul_f32 v47, v34, v31
  v_fma_f32 v32, -v33, v29, v44
  v_fma_f32 v33, v33, v28, v45
  v_fma_f32 v34, -v35, v31, v46
  v_fma_f32 v35, v35, v30, v47
  v_cvt_pk_f16_f32 v48, v32, v33
  v_cvt_pk_f16_f32 v49, v34, v35
  ds_write_b32 v228, v48 offset:19008
  ds_write_b32 v228, v49 offset:19264
  v_mul_f32 v44, v32, v28
  v_mul_f32 v45, v32, v29
  v_mul_f32 v46, v34, v30
  v_mul_f32 v47, v34, v31
  v_fma_f32 v32, -v33, v29, v44
  v_fma_f32 v33, v33, v28, v45
  v_fma_f32 v34, -v35, v31, v46
  v_fma_f32 v35, v35, v30, v47
  v_cvt_pk_f16_f32 v50, v32, v33
  v_cvt_pk_f16_f32 v51, v34, v35
  ds_write_b32 v228, v50 offset:19536
  ds_write_b32 v228, v51 offset:19792
  v_mul_f32 v44, v32, v28
  v_mul_f32 v45, v32, v29
  v_mul_f32 v46, v34, v30
  v_mul_f32 v47, v34, v31
  v_fma_f32 v32, -v33, v29, v44
  v_fma_f32 v33, v33, v28, v45
  v_fma_f32 v34, -v35, v31, v46
  v_fma_f32 v35, v35, v30, v47
  v_cvt_pk_f16_f32 v48, v32, v33
  v_cvt_pk_f16_f32 v49, v34, v35
  ds_write_b32 v228, v48 offset:20064
  ds_write_b32 v228, v49 offset:20320
  v_mul_f32 v44, v32, v28
  v_mul_f32 v45, v32, v29
  v_mul_f32 v46, v34, v30
  v_mul_f32 v47, v34, v31
  v_fma_f32 v32, -v33, v29, v44
  v_fma_f32 v33, v33, v28, v45
  v_fma_f32 v34, -v35, v31, v46
  v_fma_f32 v35, v35, v30, v47
  v_cvt_pk_f16_f32 v50, v32, v33
  v_cvt_pk_f16_f32 v51, v34, v35
  ds_write_b32 v228, v50 offset:20592
  ds_write_b32 v228, v51 offset:20848
  v_mul_f32 v44, v32, v28
  v_mul_f32 v45, v32, v29
  v_mul_f32 v46, v34, v30
  v_mul_f32 v47, v34, v31
  v_fma_f32 v32, -v33, v29, v44
  v_fma_f32 v33, v33, v28, v45
  v_fma_f32 v34, -v35, v31, v46
  v_fma_f32 v35, v35, v30, v47
  v_cvt_pk_f16_f32 v48, v32, v33
  v_cvt_pk_f16_f32 v49, v34, v35
  ds_write_b32 v228, v48 offset:21120
  ds_write_b32 v228, v49 offset:21376
kw_30:
  v_mov_b32 v40, 0
  v_mov_b32 v41, 0
  v_mov_b32 v42, 0
  v_mov_b32 v43, 0
  s_waitcnt lgkmcnt(0)
  s_barrier
  s_cmp_eq_u32 s35, 3
  s_cbranch_scc1 kgend_31
  ds_read_b128 v[64:67], v230 offset:0
  ds_read_b128 v[68:71], v229 offset:0
  ds_read_b128 v[72:75], v230 offset:64
  ds_read_b128 v[76:79], v229 offset:64
  ds_read_b128 v[80:83], v230 offset:128
  ds_read_b128 v[84:87], v229 offset:128
  ds_read_b128 v[88:91], v230 offset:192
  ds_read_b128 v[92:95], v229 offset:192
  ds_read_b128 v[96:99], v230 offset:256
  ds_read_b128 v[100:103], v229 offset:256
  ds_read_b128 v[104:107], v230 offset:320
  ds_read_b128 v[108:111], v229 offset:320
  ds_read_b128 v[112:115], v230 offset:384
  ds_read_b128 v[116:119], v229 offset:384
  ds_read_b128 v[120:123], v230 offset:448
  ds_read_b128 v[124:127], v229 offset:448
  s_waitcnt lgkmcnt(14)
  v_mfma_f32_16x16x32_f16 v[40:43], v[64:67], v[68:71], v[40:43]
  s_waitcnt lgkmcnt(12)
  v_mfma_f32_16x16x32_f16 v[40:43], v[72:75], v[76:79], v[40:43]
  s_waitcnt lgkmcnt(10)
  v_mfma_f32_16x16x32_f16 v[40:43], v[80:83], v[84:87], v[40:43]
  s_waitcnt lgkmcnt(8)
  v_mfma_f32_16x16x32_f16 v[40:43], v[88:91], v[92:95], v[40:43]
  s_waitcnt lgkmcnt(6)
  v_mfma_f32_16x16x32_f16 v[40:43], v[96:99], v[100:103], v[40:43]
  s_waitcnt lgkmcnt(4)
  v_mfma_f32_16x16x32_f16 v[40:43], v[104:107], v[108:111], v[40:43]
  s_waitcnt lgkmcnt(2)
  v_mfma_f32_16x16x32_f16 v[40:43], v[112:115], v[116:119], v[40:43]
  s_waitcnt lgkmcnt(0)
  v_mfma_f32_16x16x32_f16 v[40:43], v[120:123], v[124:127], v[40:43]
  s_nop 7
  v_cvt_pk_f16_f32 v44, v40, v41
  v_cvt_pk_f16_f32 v45, v42, v43
  v_lshlrev_b32 v5, 5, v3
  v_lshl_add_u32 v5, v4, 3, v5
  s_lshl_b32 s97, s35, 9
  v_add_u32 v5, s97, v5
  ds_write_b64 v5, v[44:45] offset:50688
kgend_31:
  s_cmp_lt_u32 s70, 576
  s_cbranch_scc1 fv_32
  s_waitcnt vmcnt(0)
  s_branch fv_33
fv_32:
  s_waitcnt vmcnt(11)
fv_33:
  s_waitcnt lgkmcnt(0)
  s_barrier
  s_cmp_eq_u32 s35, 0
  s_cbranch_scc0 pf_34
  s_mov_b64 s[56:57], exec
  s_mov_b64 exec, 1
  v_mov_b32 v249, 1
  s_cmp_eq_u32 s66, -1
  s_cbranch_scc1 pf_35
  v_mov_b32 v248, s66
  buffer_atomic_add v249, v248, s[44:47], 0 offen sc1
pf_35:
  s_cmp_eq_u32 s67, -1
  s_cbranch_scc1 pf_36
  v_mov_b32 v248, s67
  buffer_atomic_add v249, v248, s[44:47], 0 offen sc1
pf_36:
  s_mov_b64 exec, s[56:57]
pf_34:
  s_mov_b32 s66, -1
  s_mov_b32 s67, -1
  ds_read_u16 v24, v220
  ds_read_u16 v25, v221
  ds_read_u16 v26, v222
  ds_read_u16 v27, v223
  ds_read_u16 v28, v224
  ds_read_u16 v29, v225
  ds_read_u16 v30, v226
  ds_read_u16 v31, v227
  v_lshrrev_b32 v5, 2, v0
  v_mul_u32_u24 v5, 4160, v5
  v_and_b32 v6, 3, v0
  v_lshl_add_u32 v5, v6, 4, v5
  v_cmp_gt_u32 vcc, 32, v0
  s_and_saveexec_b64 s[56:57], vcc
  ds_write_b128 v5, v[240:243] offset:4096
  s_mov_b64 exec, s[56:57]
  s_waitcnt lgkmcnt(0)
  v_lshl_or_b32 v32, v25, 16, v24
  v_lshl_or_b32 v33, v27, 16, v26
  v_lshl_or_b32 v34, v29, 16, v28
  v_lshl_or_b32 v35, v31, 16, v30
  ds_write_b128 v233, v[32:35]
  s_waitcnt lgkmcnt(0)
  s_barrier
  ds_read_b128 v[28:31], v233 offset:16
  v_mov_b32 v24, v32
  v_mov_b32 v25, v33
  v_mov_b32 v26, v34
  v_mov_b32 v27, v35
  s_waitcnt lgkmcnt(0)
  v_alignbit_b32 v36, v25, v24, 16
  v_alignbit_b32 v37, v26, v25, 16
  v_alignbit_b32 v38, v27, v26, 16
  v_alignbit_b32 v39, v28, v27, 16
  v_alignbit_b32 v40, v29, v28, 16
  v_alignbit_b32 v41, v30, v29, 16
  v_alignbit_b32 v42, v31, v30, 16
  ds_write_b128 v233, v[36:39] offset:4160
  v_add_u32 v5, 8320, v233
  ds_write2_b32 v5, v25, v26 offset0:0 offset1:1
  ds_write2_b32 v5, v27, v28 offset0:2 offset1:3
  v_add_u32 v5, 12480, v233
  ds_write2_b32 v5, v37, v38 offset0:0 offset1:1
  ds_write2_b32 v5, v39, v40 offset0:2 offset1:3
  ds_write_b128 v233, v[26:29] offset:16640
  ds_write_b128 v233, v[38:41] offset:20800
  v_add_u32 v5, 24960, v233
  ds_write2_b32 v5, v27, v28 offset0:0 offset1:1
  ds_write2_b32 v5, v29, v30 offset0:2 offset1:3
  v_add_u32 v5, 29120, v233
  ds_write2_b32 v5, v39, v40 offset0:0 offset1:1
  ds_write2_b32 v5, v41, v42 offset0:2 offset1:3
  v_mov_b32 v10, v234
  v_mov_b32 v11, v235
  v_mov_b32 v44, 0
  v_mov_b32 v45, 0
  v_mov_b32 v46, 0
  v_mov_b32 v47, 0
  v_mov_b32 v48, 0
  v_mov_b32 v49, 0
  v_mov_b32 v50, 0
  v_mov_b32 v51, 0
  v_mov_b32 v52, 0
  v_mov_b32 v53, 0
  v_mov_b32 v54, 0
  v_mov_b32 v55, 0
  v_mov_b32 v56, 0
  v_mov_b32 v57, 0
  v_mov_b32 v58, 0
  v_mov_b32 v59, 0
  v_mov_b32 v60, 0
  v_mov_b32 v61, 0
  v_mov_b32 v62, 0
  v_mov_b32 v63, 0
  v_mov_b32 v64, 0
  v_mov_b32 v65, 0
  v_mov_b32 v66, 0
  v_mov_b32 v67, 0
  v_mov_b32 v68, 0
  v_mov_b32 v69, 0
  v_mov_b32 v70, 0
  v_mov_b32 v71, 0
  v_mov_b32 v72, 0
  v_mov_b32 v73, 0
  v_mov_b32 v74, 0
  v_mov_b32 v75, 0
  s_waitcnt lgkmcnt(0)
  s_barrier
  ds_read_b128 v[76:79], v10 offset:32
  ds_read_b128 v[80:83], v10
  ds_read_b128 v[84:87], v11 offset:0
  ds_read_b128 v[88:91], v11 offset:1536
  ds_read_b128 v[92:95], v11 offset:3072
  ds_read_b128 v[96:99], v11 offset:4608
  v_subrev_u32 v10, 256, v10
  v_subrev_u32 v11, 384, v11
  ds_read_b128 v[100:103], v10 offset:32
  ds_read_b128 v[104:107], v10
  ds_read_b128 v[108:111], v11 offset:0
  ds_read_b128 v[112:115], v11 offset:1536
  ds_read_b128 v[116:119], v11 offset:3072
  ds_read_b128 v[120:123], v11 offset:4608
  v_subrev_u32 v10, 256, v10
  v_subrev_u32 v11, 384, v11
  s_waitcnt lgkmcnt(6)
  v_mfma_f32_16x16x32_f16 v[44:47], v[76:79], v[84:87], v[44:47]
  v_mfma_f32_16x16x32_f16 v[48:51], v[80:83], v[84:87], v[48:51]
  v_mfma_f32_16x16x32_f16 v[52:55], v[76:79], v[88:91], v[52:55]
  v_mfma_f32_16x16x32_f16 v[56:59], v[80:83], v[88:91], v[56:59]
  v_mfma_f32_16x16x32_f16 v[60:63], v[76:79], v[92:95], v[60:63]
  v_mfma_f32_16x16x32_f16 v[64:67], v[80:83], v[92:95], v[64:67]
  v_mfma_f32_16x16x32_f16 v[68:71], v[76:79], v[96:99], v[68:71]
  v_mfma_f32_16x16x32_f16 v[72:75], v[80:83], v[96:99], v[72:75]
  ds_read_b128 v[76:79], v10 offset:32
  ds_read_b128 v[80:83], v10
  ds_read_b128 v[84:87], v11 offset:0
  ds_read_b128 v[88:91], v11 offset:1536
  ds_read_b128 v[92:95], v11 offset:3072
  ds_read_b128 v[96:99], v11 offset:4608
  v_subrev_u32 v10, 256, v10
  v_subrev_u32 v11, 384, v11
  s_waitcnt lgkmcnt(6)
  v_mfma_f32_16x16x32_f16 v[44:47], v[100:103], v[108:111], v[44:47]
  v_mfma_f32_16x16x32_f16 v[48:51], v[104:107], v[108:111], v[48:51]
  v_mfma_f32_16x16x32_f16 v[52:55], v[100:103], v[112:115], v[52:55]
  v_mfma_f32_16x16x32_f16 v[56:59], v[104:107], v[112:115], v[56:59]
  v_mfma_f32_16x16x32_f16 v[60:63], v[100:103], v[116:119], v[60:63]
  v_mfma_f32_16x16x32_f16 v[64:67], v[104:107], v[116:119], v[64:67]
  v_mfma_f32_16x16x32_f16 v[68:71], v[100:103], v[120:123], v[68:71]
  v_mfma_f32_16x16x32_f16 v[72:75], v[104:107], v[120:123], v[72:75]
  ds_read_b128 v[100:103], v10 offset:32
  ds_read_b128 v[104:107], v10
  ds_read_b128 v[108:111], v11 offset:0
  ds_read_b128 v[112:115], v11 offset:1536
  ds_read_b128 v[116:119], v11 offset:3072
  ds_read_b128 v[120:123], v11 offset:4608
  v_subrev_u32 v10, 256, v10
  v_add_u32 v11, 1152, v11
  s_waitcnt lgkmcnt(6)
  v_mfma_f32_16x16x32_f16 v[44:47], v[76:79], v[84:87], v[44:47]
  v_mfma_f32_16x16x32_f16 v[48:51], v[80:83], v[84:87], v[48:51]
  v_mfma_f32_16x16x32_f16 v[52:55], v[76:79], v[88:91], v[52:55]
  v_mfma_f32_16x16x32_f16 v[56:59], v[80:83], v[88:91], v[56:59]
  v_mfma_f32_16x16x32_f16 v[60:63], v[76:79], v[92:95], v[60:63]
  v_mfma_f32_16x16x32_f16 v[64:67], v[80:83], v[92:95], v[64:67]
  v_mfma_f32_16x16x32_f16 v[68:71], v[76:79], v[96:99], v[68:71]
  v_mfma_f32_16x16x32_f16 v[72:75], v[80:83], v[96:99], v[72:75]
  ds_read_b128 v[76:79], v10 offset:32
  ds_read_b128 v[80:83], v10
  ds_read_b128 v[88:91], v11 offset:0
  ds_read_b128 v[92:95], v11 offset:1536
  ds_read_b128 v[96:99], v11 offset:3072
  v_subrev_u32 v10, 256, v10
  v_subrev_u32 v11, 384, v11
  s_waitcnt lgkmcnt(5)
  v_mfma_f32_16x16x32_f16 v[44:47], v[100:103], v[108:111], v[44:47]
  v_mfma_f32_16x16x32_f16 v[48:51], v[104:107], v[108:111], v[48:51]
  v_mfma_f32_16x16x32_f16 v[52:55], v[100:103], v[112:115], v[52:55]
  v_mfma_f32_16x16x32_f16 v[56:59], v[104:107], v[112:115], v[56:59]
  v_mfma_f32_16x16x32_f16 v[60:63], v[100:103], v[116:119], v[60:63]
  v_mfma_f32_16x16x32_f16 v[64:67], v[104:107], v[116:119], v[64:67]
  v_mfma_f32_16x16x32_f16 v[68:71], v[100:103], v[120:123], v[68:71]
  v_mfma_f32_16x16x32_f16 v[72:75], v[104:107], v[120:123], v[72:75]
  ds_read_b128 v[100:103], v10 offset:32
  ds_read_b128 v[104:107], v10
  ds_read_b128 v[112:115], v11 offset:0
  ds_read_b128 v[116:119], v11 offset:1536
  ds_read_b128 v[120:123], v11 offset:3072
  v_subrev_u32 v10, 256, v10
  v_subrev_u32 v11, 384, v11
  s_waitcnt lgkmcnt(5)
  v_mfma_f32_16x16x32_f16 v[52:55], v[76:79], v[88:91], v[52:55]
  v_mfma_f32_16x16x32_f16 v[56:59], v[80:83], v[88:91], v[56:59]
  v_mfma_f32_16x16x32_f16 v[60:63], v[76:79], v[92:95], v[60:63]
  v_mfma_f32_16x16x32_f16 v[64:67], v[80:83], v[92:95], v[64:67]
  v_mfma_f32_16x16x32_f16 v[68:71], v[76:79], v[96:99], v[68:71]
  v_mfma_f32_16x16x32_f16 v[72:75], v[80:83], v[96:99], v[72:75]
  ds_read_b128 v[76:79], v10 offset:32
  ds_read_b128 v[80:83], v10
  ds_read_b128 v[88:91], v11 offset:0
  ds_read_b128 v[92:95], v11 offset:1536
  ds_read_b128 v[96:99], v11 offset:3072
  v_subrev_u32 v10, 256, v10
  v_subrev_u32 v11, 384, v11
  s_waitcnt lgkmcnt(5)
  v_mfma_f32_16x16x32_f16 v[52:55], v[100:103], v[112:115], v[52:55]
  v_mfma_f32_16x16x32_f16 v[56:59], v[104:107], v[112:115], v[56:59]
  v_mfma_f32_16x16x32_f16 v[60:63], v[100:103], v[116:119], v[60:63]
  v_mfma_f32_16x16x32_f16 v[64:67], v[104:107], v[116:119], v[64:67]
  v_mfma_f32_16x16x32_f16 v[68:71], v[100:103], v[120:123], v[68:71]
  v_mfma_f32_16x16x32_f16 v[72:75], v[104:107], v[120:123], v[72:75]
  ds_read_b128 v[100:103], v10 offset:32
  ds_read_b128 v[104:107], v10
  ds_read_b128 v[112:115], v11 offset:0
  ds_read_b128 v[116:119], v11 offset:1536
  ds_read_b128 v[120:123], v11 offset:3072
  v_subrev_u32 v10, 256, v10
  v_add_u32 v11, 1152, v11
  s_waitcnt lgkmcnt(5)
  v_mfma_f32_16x16x32_f16 v[52:55], v[76:79], v[88:91], v[52:55]
  v_mfma_f32_16x16x32_f16 v[56:59], v[80:83], v[88:91], v[56:59]
  v_mfma_f32_16x16x32_f16 v[60:63], v[76:79], v[92:95], v[60:63]
  v_mfma_f32_16x16x32_f16 v[64:67], v[80:83], v[92:95], v[64:67]
  v_mfma_f32_16x16x32_f16 v[68:71], v[76:79], v[96:99], v[68:71]
  v_mfma_f32_16x16x32_f16 v[72:75], v[80:83], v[96:99], v[72:75]
  ds_read_b128 v[76:79], v10 offset:32
  ds_read_b128 v[80:83], v10
  ds_read_b128 v[92:95], v11 offset:0
  ds_read_b128 v[96:99], v11 offset:1536
  v_subrev_u32 v10, 256, v10
  v_subrev_u32 v11, 384, v11
  s_waitcnt lgkmcnt(4)
  v_mfma_f32_16x16x32_f16 v[52:55], v[100:103], v[112:115], v[52:55]
  v_mfma_f32_16x16x32_f16 v[56:59], v[104:107], v[112:115], v[56:59]
  v_mfma_f32_16x16x32_f16 v[60:63], v[100:103], v[116:119], v[60:63]
  v_mfma_f32_16x16x32_f16 v[64:67], v[104:107], v[116:119], v[64:67]
  v_mfma_f32_16x16x32_f16 v[68:71], v[100:103], v[120:123], v[68:71]
  v_mfma_f32_16x16x32_f16 v[72:75], v[104:107], v[120:123], v[72:75]
  ds_read_b128 v[100:103], v10 offset:32
  ds_read_b128 v[104:107], v10
  ds_read_b128 v[116:119], v11 offset:0
  ds_read_b128 v[120:123], v11 offset:1536
  v_subrev_u32 v10, 256, v10
  v_subrev_u32 v11, 384, v11
  s_waitcnt lgkmcnt(4)
  v_mfma_f32_16x16x32_f16 v[60:63], v[76:79], v[92:95], v[60:63]
  v_mfma_f32_16x16x32_f16 v[64:67], v[80:83], v[92:95], v[64:67]
  v_mfma_f32_16x16x32_f16 v[68:71], v[76:79], v[96:99], v[68:71]
  v_mfma_f32_16x16x32_f16 v[72:75], v[80:83], v[96:99], v[72:75]
  ds_read_b128 v[76:79], v10 offset:32
  ds_read_b128 v[80:83], v10
  ds_read_b128 v[92:95], v11 offset:0
  ds_read_b128 v[96:99], v11 offset:1536
  v_subrev_u32 v10, 256, v10
  v_subrev_u32 v11, 384, v11
  s_waitcnt lgkmcnt(4)
  v_mfma_f32_16x16x32_f16 v[60:63], v[100:103], v[116:119], v[60:63]
  v_mfma_f32_16x16x32_f16 v[64:67], v[104:107], v[116:119], v[64:67]
  v_mfma_f32_16x16x32_f16 v[68:71], v[100:103], v[120:123], v[68:71]
  v_mfma_f32_16x16x32_f16 v[72:75], v[104:107], v[120:123], v[72:75]
  ds_read_b128 v[100:103], v10 offset:32
  ds_read_b128 v[104:107], v10
  ds_read_b128 v[116:119], v11 offset:0
  ds_read_b128 v[120:123], v11 offset:1536
  v_subrev_u32 v10, 256, v10
  v_add_u32 v11, 1152, v11
  s_waitcnt lgkmcnt(4)
  v_mfma_f32_16x16x32_f16 v[60:63], v[76:79], v[92:95], v[60:63]
  v_mfma_f32_16x16x32_f16 v[64:67], v[80:83], v[92:95], v[64:67]
  v_mfma_f32_16x16x32_f16 v[68:71], v[76:79], v[96:99], v[68:71]
  v_mfma_f32_16x16x32_f16 v[72:75], v[80:83], v[96:99], v[72:75]
  ds_read_b128 v[76:79], v10 offset:32
  ds_read_b128 v[80:83], v10
  ds_read_b128 v[96:99], v11 offset:0
  v_subrev_u32 v10, 256, v10
  v_subrev_u32 v11, 384, v11
  s_waitcnt lgkmcnt(3)
  v_mfma_f32_16x16x32_f16 v[60:63], v[100:103], v[116:119], v[60:63]
  v_mfma_f32_16x16x32_f16 v[64:67], v[104:107], v[116:119], v[64:67]
  v_mfma_f32_16x16x32_f16 v[68:71], v[100:103], v[120:123], v[68:71]
  v_mfma_f32_16x16x32_f16 v[72:75], v[104:107], v[120:123], v[72:75]
  ds_read_b128 v[100:103], v10 offset:32
  ds_read_b128 v[104:107], v10
  ds_read_b128 v[120:123], v11 offset:0
  v_subrev_u32 v10, 256, v10
  v_subrev_u32 v11, 384, v11
  s_waitcnt lgkmcnt(3)
  v_mfma_f32_16x16x32_f16 v[68:71], v[76:79], v[96:99], v[68:71]
  v_mfma_f32_16x16x32_f16 v[72:75], v[80:83], v[96:99], v[72:75]
  ds_read_b128 v[76:79], v10 offset:32
  ds_read_b128 v[80:83], v10
  ds_read_b128 v[96:99], v11 offset:0
  v_subrev_u32 v10, 256, v10
  v_subrev_u32 v11, 384, v11
  s_waitcnt lgkmcnt(3)
  v_mfma_f32_16x16x32_f16 v[68:71], v[100:103], v[120:123], v[68:71]
  v_mfma_f32_16x16x32_f16 v[72:75], v[104:107], v[120:123], v[72:75]
  ds_read_b128 v[100:103], v10 offset:32
  ds_read_b128 v[104:107], v10
  ds_read_b128 v[120:123], v11 offset:0
  v_subrev_u32 v10, 256, v10
  v_add_u32 v11, 1152, v11
  s_waitcnt lgkmcnt(3)
  v_mfma_f32_16x16x32_f16 v[68:71], v[76:79], v[96:99], v[68:71]
  v_mfma_f32_16x16x32_f16 v[72:75], v[80:83], v[96:99], v[72:75]
  s_waitcnt lgkmcnt(0)
  v_mfma_f32_16x16x32_f16 v[68:71], v[100:103], v[120:123], v[68:71]
  v_mfma_f32_16x16x32_f16 v[72:75], v[104:107], v[120:123], v[72:75]
  s_barrier
  s_lshl_b32 s96, s35, 13
  v_lshlrev_b32 v10, 4, v2
  v_add_u32 v11, s96, v10
  s_nop 4
  ds_write_b128 v11, v[44:47] offset:0
  ds_write_b128 v11, v[48:51] offset:1024
  ds_write_b128 v11, v[52:55] offset:2048
  ds_write_b128 v11, v[56:59] offset:3072
  ds_write_b128 v11, v[60:63] offset:4096
  ds_write_b128 v11, v[64:67] offset:5120
  ds_write_b128 v11, v[68:71] offset:6144
  ds_write_b128 v11, v[72:75] offset:7168
  s_waitcnt lgkmcnt(0)
  s_barrier
  s_lshl_b32 s96, s35, 11
  v_add_u32 v11, s96, v10
  ds_read_b128 v[76:79], v11 offset:0
  ds_read_b128 v[80:83], v11 offset:1024
  ds_read_b128 v[84:87], v11 offset:8192
  ds_read_b128 v[88:91], v11 offset:9216
  ds_read_b128 v[92:95], v11 offset:16384
  ds_read_b128 v[96:99], v11 offset:17408
  ds_read_b128 v[100:103], v11 offset:24576
  ds_read_b128 v[104:107], v11 offset:25600
  s_lshl_b32 s96, s35, 4
  v_add_u32 v11, s96, v3
  v_add_u32 v11, 16, v11
  v_mul_u32_u24 v11, 96, v11
  v_lshl_add_u32 v11, v4, 3, v11
  v_add_u32 v11, 55296, v11
  ds_read_b64 v[44:45], v11
  ds_read_b64 v[46:47], v11 offset:32
  s_waitcnt lgkmcnt(0)
  v_add_f32 v76, v76, v84
  v_add_f32 v92, v92, v100
  v_add_f32 v77, v77, v85
  v_add_f32 v93, v93, v101
  v_add_f32 v78, v78, v86
  v_add_f32 v94, v94, v102
  v_add_f32 v79, v79, v87
  v_add_f32 v95, v95, v103
  v_add_f32 v80, v80, v88
  v_add_f32 v96, v96, v104
  v_add_f32 v81, v81, v89
  v_add_f32 v97, v97, v105
  v_add_f32 v82, v82, v90
  v_add_f32 v98, v98, v106
  v_add_f32 v83, v83, v91
  v_add_f32 v99, v99, v107
  v_add_f32 v76, v76, v92
  v_cvt_f32_f16 v48, v44
  v_add_f32 v77, v77, v93
  v_cvt_f32_f16_sdwa v49, v44 dst_sel:DWORD dst_unused:UNUSED_PAD src0_sel:WORD_1
  v_add_f32 v78, v78, v94
  v_cvt_f32_f16 v50, v45
  v_add_f32 v79, v79, v95
  v_cvt_f32_f16_sdwa v51, v45 dst_sel:DWORD dst_unused:UNUSED_PAD src0_sel:WORD_1
  v_add_f32 v80, v80, v96
  v_cvt_f32_f16 v52, v46
  v_add_f32 v81, v81, v97
  v_cvt_f32_f16_sdwa v53, v46 dst_sel:DWORD dst_unused:UNUSED_PAD src0_sel:WORD_1
  v_add_f32 v82, v82, v98
  v_cvt_f32_f16 v54, v47
  v_add_f32 v83, v83, v99
  v_cvt_f32_f16_sdwa v55, v47 dst_sel:DWORD dst_unused:UNUSED_PAD src0_sel:WORD_1
  v_mul_f32 v76, v76, v8
  v_mul_f32 v48, v48, v9
  v_mul_f32 v77, v77, v8
  v_mul_f32 v49, v49, v9
  v_mul_f32 v78, v78, v8
  v_mul_f32 v50, v50, v9
  v_mul_f32 v79, v79, v8
  v_mul_f32 v51, v51, v9
  v_mul_f32 v80, v80, v8
  v_mul_f32 v52, v52, v9
  v_mul_f32 v81, v81, v8
  v_mul_f32 v53, v53, v9
  v_mul_f32 v82, v82, v8
  v_mul_f32 v54, v54, v9
  v_mul_f32 v83, v83, v8
  v_mul_f32 v55, v55, v9
  v_cvt_pk_bf16_f32 v56, v76, v77
  v_cvt_pk_bf16_f32 v57, v48, v49
  v_lshlrev_b32 v76, 16, v56
  v_and_b32 v77, 0xffff0000, v56
  v_lshlrev_b32 v48, 16, v57
  v_and_b32 v49, 0xffff0000, v57
  v_add_f32 v76, v76, v48
  v_add_f32 v77, v77, v49
  v_cvt_pk_bf16_f32 v60, v76, v77
  v_cvt_pk_bf16_f32 v56, v78, v79
  v_cvt_pk_bf16_f32 v57, v50, v51
  v_lshlrev_b32 v78, 16, v56
  v_and_b32 v79, 0xffff0000, v56
  v_lshlrev_b32 v50, 16, v57
  v_and_b32 v51, 0xffff0000, v57
  v_add_f32 v78, v78, v50
  v_add_f32 v79, v79, v51
  v_cvt_pk_bf16_f32 v61, v78, v79
  v_cvt_pk_bf16_f32 v56, v80, v81
  v_cvt_pk_bf16_f32 v57, v52, v53
  v_lshlrev_b32 v80, 16, v56
  v_and_b32 v81, 0xffff0000, v56
  v_lshlrev_b32 v52, 16, v57
  v_and_b32 v53, 0xffff0000, v57
  v_add_f32 v80, v80, v52
  v_add_f32 v81, v81, v53
  v_cvt_pk_bf16_f32 v62, v80, v81
  v_cvt_pk_bf16_f32 v56, v82, v83
  v_cvt_pk_bf16_f32 v57, v54, v55
  v_lshlrev_b32 v82, 16, v56
  v_and_b32 v83, 0xffff0000, v56
  v_lshlrev_b32 v54, 16, v57
  v_and_b32 v55, 0xffff0000, v57
  v_add_f32 v82, v82, v54
  v_add_f32 v83, v83, v55
  v_cvt_pk_bf16_f32 v63, v82, v83
  s_lshl_b32 s96, s69, 12
  s_lshl_b32 s97, s35, 10
  s_add_u32 s96, s96, s97
  v_lshlrev_b32 v11, 6, v3
  v_lshl_add_u32 v11, v4, 3, v11
  buffer_store_dwordx2 v[60:61], v11, s[20:23], s96 offen sc1
  buffer_store_dwordx2 v[62:63], v11, s[20:23], s96 offen offset:32 sc1
  s_mul_i32 s66, s69, 911
  s_lshr_b32 s66, s66, 16
  s_lshl_b32 s66, s66, 8
  s_add_u32 s66, s66, 8192
  s_cmp_lt_u32 s70, 576
  s_cbranch_scc1 chl_25
  s_waitcnt vmcnt(0)
  s_barrier
  s_cmp_eq_u32 s35, 0
  s_cbranch_scc0 pf_37
  s_mov_b64 s[56:57], exec
  s_mov_b64 exec, 1
  v_mov_b32 v249, 1
  s_cmp_eq_u32 s66, -1
  s_cbranch_scc1 pf_38
  v_mov_b32 v248, s66
  buffer_atomic_add v249, v248, s[44:47], 0 offen sc1
pf_38:
  s_cmp_eq_u32 s67, -1
  s_cbranch_scc1 pf_39
  v_mov_b32 v248, s67
  buffer_atomic_add v249, v248, s[44:47], 0 offen sc1
pf_39:
  s_mov_b64 exec, s[56:57]
pf_37:
  s_mov_b32 s66, -1
  s_mov_b32 s67, -1
km_kernel_end:
  s_endpgm
km_kernel_codeend:
.section .rodata,"a"
.p2align 6
.amdhsa_kernel k0_kernel
  .amdhsa_next_free_vgpr 80
  .amdhsa_next_free_sgpr 102
  .amdhsa_accum_offset 80
  .amdhsa_group_segment_fixed_size 0
  .amdhsa_kernarg_size 120
  .amdhsa_user_sgpr_count 2
  .amdhsa_user_sgpr_kernarg_segment_ptr 1
  .amdhsa_system_sgpr_workgroup_id_x 1
  .amdhsa_float_denorm_mode_32 3
.end_amdhsa_kernel
.section .rodata,"a"
.p2align 6
.amdhsa_kernel km_kernel
  .amdhsa_next_free_vgpr 256
  .amdhsa_next_free_sgpr 102
  .amdhsa_accum_offset 256
  .amdhsa_group_segment_fixed_size 0
  .amdhsa_kernarg_size 120
  .amdhsa_user_sgpr_count 2
  .amdhsa_user_sgpr_kernarg_segment_ptr 1
  .amdhsa_system_sgpr_workgroup_id_x 1
  .amdhsa_float_denorm_mode_32 3
.end_amdhsa_kernel
```
